```python
import torch

def _softmax(x, axis=-1):
    return torch.softmax(x, dim=axis)
def _gelu(x):
    return torch.nn.functional.gelu(x, approximate="tanh")
def _silu(x):
    return torch.nn.functional.silu(x)
def _sigmoid(x):
    return torch.sigmoid(x)
def _layernorm(x, axis=-1, eps=1e-5):
    m = x.mean(dim=axis, keepdim=True)
    v = x.var(dim=axis, keepdim=True, unbiased=False)
    return (x - m) / torch.sqrt(v + eps)
def _scatter_add(tgt, idx, src, axis=0):
    return tgt.clone().index_add_(axis, idx, src)
def _segment_sum(src, seg, n):
    out = torch.zeros((n,) + src.shape[1:], dtype=src.dtype)
    return out.index_add_(0, seg, src)
def _pad(x, pw):
    flat = tuple(v for pair in reversed(pw) for v in pair)
    return torch.nn.functional.pad(x, flat)

kernel_name = 'gated_mix__ssm_conv_s4__glu_gated_bilinear__prompt'

def setup_inputs():

    _w = (lambda a: (lambda t: t.to(torch.bfloat16) if t.is_floating_point() else t)(torch.as_tensor(a)))
    def _A_setup():
        B, L, D, N = 1, 2048, 576, 128
        A_re = -(lambda _x: torch.exp(torch.as_tensor(_x)))((lambda *s: torch.randn(*s, dtype=torch.bfloat16) * 3.2)(D, N))
        A_im = torch.pi * (lambda *s: torch.randn(*s, dtype=torch.bfloat16) * 0.05)(D, N)
        B_re = (lambda *s: torch.randn(*s, dtype=torch.bfloat16) * 0.1)(D, N)
        B_im = (lambda *s: torch.randn(*s, dtype=torch.bfloat16) * 0.1)(D, N)
        C_re = (lambda *s: torch.randn(*s, dtype=torch.bfloat16) * 0.1)(D, N)
        C_im = (lambda *s: torch.randn(*s, dtype=torch.bfloat16) * 0.1)(D, N)
        log_dt = (lambda *s: torch.randn(*s, dtype=torch.bfloat16) * 0.05)(D) * 0.5 - 4.0
        Dskip = (lambda *s: torch.randn(*s, dtype=torch.bfloat16) * 0.05)(D)
        return {
            "u": _w((lambda *s: torch.randn(*s, dtype=torch.bfloat16) * 0.05)(B, L, D)),
            "A_re": _w(A_re),
            "A_im": _w(A_im),
            "B_re": _w(B_re),
            "B_im": _w(B_im),
            "C_re": _w(C_re),
            "C_im": _w(C_im),
            "log_dt": _w(log_dt),
            "Dskip": _w(Dskip),
        }
    _A_in = _A_setup()

    def _B_setup():
        B, S, D, F = 1, 2048, 576, 4608
        return {
            "x": _w((lambda *s: torch.randn(*s, dtype=torch.bfloat16) * 0.05)(B, S, D)),
            "w_gate": _w((lambda *s: torch.randn(*s, dtype=torch.bfloat16) * 0.8)(D, F) * (D ** -0.5)),
            "w_up": _w((lambda *s: torch.randn(*s, dtype=torch.bfloat16) * 0.8)(D, F) * (D ** -0.5)),
            "w_down": _w((lambda *s: torch.randn(*s, dtype=torch.bfloat16) * 0.8)(F, D) * (F ** -0.5)),
        }
    _B_in = _B_setup()

    return {
        "A_u": _A_in["u"],
        "A_A_re": _A_in["A_re"],
        "A_A_im": _A_in["A_im"],
        "A_B_re": _A_in["B_re"],
        "A_B_im": _A_in["B_im"],
        "A_C_re": _A_in["C_re"],
        "A_C_im": _A_in["C_im"],
        "A_log_dt": _A_in["log_dt"],
        "A_Dskip": _A_in["Dskip"],
        "B_x": _B_in["x"],
        "B_w_gate": _B_in["w_gate"],
        "B_w_up": _B_in["w_up"],
        "B_w_down": _B_in["w_down"],
        "gate_w": _w((lambda *s: torch.randn(*s, dtype=torch.bfloat16) * 0.05)(576) * 16.0),
    }

def reference(A_u, A_A_re, A_A_im, A_B_re, A_B_im, A_C_re, A_C_im, A_log_dt, A_Dskip, B_x, B_w_gate, B_w_up, B_w_down, gate_w):
    def _A_ref(u, A_re, A_im, B_re, B_im, C_re, C_im, log_dt, Dskip):
        Bsz, L, D = u.shape
        dt = torch.exp(log_dt)[:, None]
        A = A_re + 1j * A_im
        Bc = B_re + 1j * B_im
        Cc = C_re + 1j * C_im
        logdA = dt * A
        dB = dt * Bc
        l = (lambda x, dt: x.to(dt))(torch.arange(L), A_re.dtype)
        P = torch.exp(logdA[:, :, None] * l[None, None, :])
        K = torch.einsum("dn,dnl,dn->dl", Cc, P, dB).real
        L2 = 2 * L
        Kp = _pad(K, ((0, 0), (0, L)))
        up = (lambda x, *d: x.permute(*d))(u, 0, 2, 1)
        up = _pad(up, ((0, 0), (0, 0), (0, L)))
        Kf = (lambda x, axes=(-2,-1): torch.fft.rfft2(x.float(), dim=axes))(Kp[:, None, :], axes=(-2, -1))
        Uf = (lambda x, axes=(-2,-1): torch.fft.rfft2(x.float(), dim=axes))(up[:, :, None, :], axes=(-2, -1))
        Yf = Uf * Kf[None, :, :, :]
        y = (lambda x, s, axes=(-2,-1): torch.fft.irfft2(x, s=s, dim=axes).to(torch.bfloat16))(Yf, (1, L2), axes=(-2, -1))[:, :, 0, :L]
        y = (lambda x, *d: x.permute(*d))(y, 0, 2, 1) + u * Dskip[None, None, :]
        return y

    def _B_ref(x, w_gate, w_up, w_down):
        g = torch.einsum("bsd,df->bsf", x, w_gate)
        u = torch.einsum("bsd,df->bsf", x, w_up)
        h = g * u
        return torch.einsum("bsf,fd->bsd", h, w_down)

    x = A_u
    g = _sigmoid((x * gate_w).sum(-1, keepdims=True))
    a = _A_ref(x, A_A_re, A_A_im, A_B_re, A_B_im, A_C_re, A_C_im, A_log_dt, A_Dskip)
    b = _B_ref(x, B_w_gate, B_w_up, B_w_down)
    return g * a + (1 - g) * b
```

```asm
; @launch grid=(256,1,1) block=(256,1,1) lds=163840
.amdgcn_target "amdgcn-amd-amdhsa--gfx950"
.text
.globl gated_mix__ssm_conv_s4__glu_gated_bilinear__prompt_kernel
.p2align 8
.type gated_mix__ssm_conv_s4__glu_gated_bilinear__prompt_kernel,@function
gated_mix__ssm_conv_s4__glu_gated_bilinear__prompt_kernel:
    s_cmp_ge_u32 s2, 256
    s_cbranch_scc1 gated_mix__ssm_conv_s4__glu_gated_bilinear__prompt_kernel_end
    s_load_dwordx16 s[36:51], s[0:1], 8
    s_load_dwordx2 s[6:7], s[0:1], 0
    s_load_dwordx4 s[28:31], s[0:1], 80
    s_load_dwordx2 s[4:5], s[0:1], 128
    s_load_dwordx8 s[52:59], s[0:1], 96
    s_load_dwordx2 s[64:65], s[0:1], 104
    v_lshrrev_b32 v251, 6, v0
    v_and_b32 v252, 63, v0
    s_lshr_b32 s13, s2, 3
    v_readfirstlane_b32 s17, v251
    s_and_b32 s14, s13, 3
    s_and_b32 s71, s2, 63
    s_cmp_eq_u32 s17, 3
    s_cbranch_scc1 gated_mix__ssm_conv_s4__glu_gated_bilinear__prompt_kernel_pre3
    s_lshl_b32 s73, s17, 8
    s_cmp_lt_u32 s17, 2
    s_cselect_b32 s71, s2, s71
    s_add_u32 s73, s73, s71
    s_lshl_b32 s71, s73, 8
    v_lshlrev_b32 v2, 2, v252
    v_add_u32 v2, s71, v2
    s_lshl_b32 s71, s73, 1
    v_mov_b32 v3, s71
    v_mov_b32 v14, 0
    s_waitcnt lgkmcnt(0)
    global_load_short_d16_hi v14, v3, s[48:49]
    global_load_dword v8, v2, s[36:37]
    global_load_dword v9, v2, s[38:39]
    global_load_dword v10, v2, s[40:41]
    global_load_dword v11, v2, s[42:43]
    global_load_dword v12, v2, s[44:45]
    global_load_dword v13, v2, s[46:47]
    s_branch gated_mix__ssm_conv_s4__glu_gated_bilinear__prompt_kernel_prec
gated_mix__ssm_conv_s4__glu_gated_bilinear__prompt_kernel_pre3:
    s_getpc_b64 s[76:77]
gated_mix__ssm_conv_s4__glu_gated_bilinear__prompt_kernel_pc:
    v_lshlrev_b32 v16, 7, v252
    s_lshl_b32 s35, s13, 13
    v_add_u32 v16, s35, v16
    v_min_u32 v16, gated_mix__ssm_conv_s4__glu_gated_bilinear__prompt_kernel_end-gated_mix__ssm_conv_s4__glu_gated_bilinear__prompt_kernel_pc, v16
    global_load_dword v241, v16, s[76:77]
    v_mov_b32 v8, 0
    v_mov_b32 v9, 0
    v_mov_b32 v10, 0
    v_mov_b32 v11, 0
    s_lshl_b32 s71, s2, 11
    s_add_u32 s71, s71, 65536
    v_lshl_add_u32 v12, v252, 7, s71
    s_lshr_b32 s73, s2, 1
    s_lshl_b32 s73, s73, 5
    s_and_b32 s74, s2, 1
    s_add_u32 s73, s73, s74
    s_lshl_b32 s73, s73, 8
    s_add_u32 s73, s73, 196352
    v_lshl_add_u32 v13, v252, 4, s73
    s_lshl_b32 s73, s2, 6
    s_add_u32 s73, s73, 130560
    v_min_u32 v14, 35, v252
    v_lshl_add_u32 v14, v14, 4, s73
    v_cmp_gt_u32 vcc, 32, v252
    s_cmp_lt_u32 s2, 16
    s_cselect_b32 s79, 0, 0x80000000
    v_cndmask_b32 v13, v14, v13, vcc
    v_cmp_gt_u32 vcc, 16, v252
    s_or_b32 s80, s79, s2
    s_nop 0
    v_cndmask_b32 v12, v13, v12, vcc
    s_waitcnt lgkmcnt(0)
    s_add_u32 s36, s4, 0
    s_addc_u32 s37, s5, 0
    s_mov_b32 s38, 44040192
    s_mov_b32 s39, 0x20000
    buffer_store_dwordx4 v[8:11], v12, s[36:39], s79 offen sc1
gated_mix__ssm_conv_s4__glu_gated_bilinear__prompt_kernel_prec:
    s_and_b32 s71, s2, 1
    s_lshl_b32 s15, s71, 2
    s_lshr_b32 s72, s2, 6
    s_add_u32 s15, s15, s72
    s_lshr_b32 s33, s14, 1
    v_and_b32 v255, 7, v252
    v_lshrrev_b32 v253, 3, v252
    v_mul_u32_u24 v253, 1152, v253
    v_lshrrev_b32 v254, 4, v252
    v_xor_b32 v254, v254, v255
    v_lshlrev_b32 v254, 4, v254
    v_add_u32 v242, v253, v254
    v_xor_b32 v254, 64, v254
    v_add_u32 v243, v253, v254
    v_add_u32 v243, 8192, v243
    v_add_u32 v244, 16384, v242
    v_add_u32 v245, 16384, v243
    s_bfe_u32 s12, s2, 0x10005
    s_lshl_b32 s71, s12, 1
    s_add_u32 s71, s71, s72
    s_add_u32 s71, s71, s14
    s_mul_i32 s72, s71, 11
    s_lshr_b32 s72, s72, 5
    s_mul_i32 s72, s72, 3
    s_sub_u32 s75, s71, s72
    s_mul_i32 s97, s75, 384
    s_lshl_b32 s71, s15, 8
    s_lshl_b32 s72, s17, 6
    s_add_u32 s71, s71, s72
    s_lshl_b32 s72, s33, 5
    s_add_u32 s68, s71, s72
    s_mul_i32 s68, s68, 1152
    s_xor_b32 s72, s72, 32
    s_add_u32 s69, s71, s72
    s_mul_i32 s69, s69, 1152
    s_lshl_b32 s70, s17, 13
    s_add_u32 s70, s70, 0
    s_mov_b32 s8, s6
    s_mov_b32 s9, s7
    s_mov_b32 s10, 2359296
    s_mov_b32 s11, 0x20000
    s_add_u32 m0, s70, 0
    s_add_u32 s66, s68, s97
    buffer_load_dwordx4 v242, s[8:11], s66 offen offset:0 lds
    buffer_load_dwordx4 v243, s[8:11], s66 offen offset:1024 lds
    buffer_load_dwordx4 v244, s[8:11], s66 offen offset:2048 lds
    buffer_load_dwordx4 v245, s[8:11], s66 offen offset:3072 lds
    s_add_u32 m0, s70, 4096
    s_add_u32 s66, s69, s97
    buffer_load_dwordx4 v242, s[8:11], s66 offen offset:0 lds
    buffer_load_dwordx4 v243, s[8:11], s66 offen offset:1024 lds
    buffer_load_dwordx4 v244, s[8:11], s66 offen offset:2048 lds
    buffer_load_dwordx4 v245, s[8:11], s66 offen offset:3072 lds
    s_bfe_u32 s16, s2, 0x20001
    s_lshl_b32 s35, s16, 1
    s_add_u32 s12, s12, s35
    s_mul_i32 s35, s12, 9
    s_lshl_b32 s18, s14, 1
    s_add_u32 s18, s18, s35
    s_add_u32 s19, s35, 8
    s_lshr_b32 s35, s14, 1
    s_cmp_eq_u32 s12, 3
    s_cselect_b32 s35, s35, 0
    s_cselect_b32 s71, 4, 0
    s_add_u32 s18, s18, s35
    s_sub_u32 s19, s19, s71
    v_lshrrev_b32 v253, 3, v252
    v_mul_u32_u24 v253, 9216, v253
    v_bfe_u32 v254, v252, 4, 1
    v_lshlrev_b32 v254, 1, v254
    s_and_b32 s71, s17, 1
    s_lshl_b32 s71, s71, 2
    v_or_b32 v254, s71, v254
    v_xor_b32 v254, v254, v255
    v_lshlrev_b32 v254, 4, v254
    v_add_u32 v248, v253, v254
    s_mul_i32 s71, s17, 73728
    v_add_u32 v248, s71, v248
    s_mul_i32 s94, s75, 1769472
    s_lshr_b32 s100, s17, 1
    s_lshl_b32 s100, s100, 9
    s_lshl_b32 s101, s2, 1
    s_add_u32 s100, s100, s101
    s_and_b32 s100, s100, 0x3fc
    s_and_b32 s101, s101, 124
    s_add_u32 s101, s101, 1024
    s_load_dword s100, s[50:51], s100
    s_load_dword s101, s[50:51], s101
    s_mov_b32 s20, s28
    s_mov_b32 s21, s29
    s_mov_b32 s22, 5308416
    s_mov_b32 s23, 0x20000
    s_sub_u32 s24, s30, 1024
    s_subb_u32 s25, s31, 0
    s_mov_b32 s26, 5309440
    s_mov_b32 s27, 0x20000
    s_lshl_b32 s48, s18, 7
    s_lshl_b32 s51, s17, 11
    s_add_u32 s72, s75, 1
    s_cmp_eq_u32 s75, 2
    s_cselect_b32 s72, 0, s72
    s_sub_u32 s74, 3, s75
    s_sub_u32 s74, s74, s72
    s_mul_i32 s95, s72, 1769472
    s_mul_i32 s96, s74, 1769472
    s_mul_i32 s98, s72, 384
    s_mul_i32 s99, s74, 384
    s_cmp_lt_u32 s17, 2
    s_cselect_b32 s40, s28, s30
    s_cselect_b32 s41, s29, s31
    s_mov_b32 s42, 5308416
    s_mov_b32 s43, 0x20000
    s_add_u32 s36, s4, 0
    s_addc_u32 s37, s5, 0
    s_mov_b32 s38, 44040192
    s_mov_b32 s39, 0x20000
    s_mov_b32 s30, 0x3f803f80
    s_mov_b32 s31, 0xffff0000
    v_and_b32 v253, 15, v252
    v_lshrrev_b32 v254, 1, v253
    v_lshlrev_b32 v253, 7, v253
    v_lshrrev_b32 v255, 4, v252
    v_xor_b32 v254, v254, v255
    v_lshlrev_b32 v254, 4, v254
    v_add_u32 v253, v253, v254
    v_add_u32 v246, s70, v253
    v_xor_b32 v247, 64, v246
    v_lshrrev_b32 v253, 4, v252
    v_lshlrev_b32 v253, 11, v253
    v_bfe_u32 v254, v252, 2, 2
    v_lshlrev_b32 v254, 7, v254
    v_add_u32 v253, v253, v254
    v_and_b32 v254, 3, v252
    v_lshlrev_b32 v254, 3, v254
    v_add_u32 v253, v253, v254
    v_bfe_u32 v254, v252, 3, 2
    v_lshlrev_b32 v254, 5, v254
    v_xor_b32 v255, 0, v254
    v_add_u32 v224, v253, v255
    v_add_u32 v228, 61440, v224
    v_add_u32 v232, 122880, v224
    v_xor_b32 v255, 32, v254
    v_add_u32 v225, v253, v255
    v_add_u32 v229, 61440, v225
    v_add_u32 v233, 122880, v225
    v_xor_b32 v255, 64, v254
    v_add_u32 v226, v253, v255
    v_add_u32 v230, 61440, v226
    v_add_u32 v234, 122880, v226
    v_xor_b32 v255, 96, v254
    v_add_u32 v227, v253, v255
    v_add_u32 v231, 61440, v227
    v_add_u32 v235, 122880, v227
    s_cmp_eq_u32 s16, 1
    s_cselect_b32 s71, 26, 17
    v_min_u32 v237, s71, v252
    v_mul_u32_u24 v236, 57, v237
    v_lshrrev_b32 v236, 9, v236
    v_mul_u32_u24 v237, 9216, v237
    v_mul_u32_u24 v236, 81920, v236
    v_sub_u32 v237, v237, v236
    s_lshl_b32 s71, s13, 1
    s_and_b32 s72, s17, 1
    s_add_u32 s71, s71, s72
    s_mul_i32 s71, s71, 82944
    s_lshl_b32 s72, s16, 1
    s_sub_u32 s74, 3, s72
    s_and_b32 s74, s74, 7
    s_mul_i32 s72, s16, 18
    s_add_u32 s72, s72, s74
    s_lshl_b32 s72, s72, 7
    s_add_u32 s71, s71, s72
    v_add_u32 v237, s71, v237
    s_cmp_eq_u32 s17, 3
    s_cbranch_scc1 gated_mix__ssm_conv_s4__glu_gated_bilinear__prompt_kernel_w3
    s_mul_i32 s71, s17, 9216
    s_add_u32 s71, s71, 65536
    s_lshl_b32 s72, s17, 8
    s_add_u32 s72, s72, s2
    s_mul_i32 s72, s72, 4352
    s_add_u32 s72, s72, 35651712
    v_mul_u32_u24 v16, 144, v252
    v_add_u32 v16, s71, v16
    v_lshrrev_b32 v24, 4, v252
    v_and_b32 v25, 15, v252
    v_and_b32 v26, 1, v24
    v_lshrrev_b32 v27, 1, v24
    v_lshl_add_u32 v26, v26, 3, v27
    v_mul_u32_u24 v17, 144, v26
    v_lshlrev_b32 v26, 3, v25
    v_add_u32 v17, v17, v26
    v_add_u32 v17, s71, v17
    v_lshlrev_b32 v26, 5, v25
    v_lshl_add_u32 v18, v24, 3, v26
    v_lshl_add_u32 v20, v24, 9, v26
    v_and_b32 v27, 1, v24
    v_lshl_add_u32 v19, v27, 4, v26
    v_lshrrev_b32 v27, 1, v24
    v_lshl_add_u32 v19, v27, 9, v19
    v_mov_b32 v24, 0
    v_mov_b32 v25, 0
    s_sub_u32 s71, s72, 8
    buffer_store_dwordx2 v[24:25], off, s[36:39], s71
    s_waitcnt vmcnt(9) lgkmcnt(0)
    v_mul_f32 v24, 0x3fb8aa3b, v14
    s_add_u32 m0, s51, 114688
    s_add_u32 s66, s48, s94
    buffer_load_dwordx4 v248, s[20:23], s66 offen lds
    v_mov_b32 v26, 0x3fb8aa3b
    v_fma_f32 v25, v14, v26, -v24
    v_mov_b32 v26, 0x32a57060
    v_exp_f32 v24, v24
    v_fma_f32 v25, v14, v26, v25
    v_mul_f32 v25, 0x3f317218, v25
    v_fma_f32 v24, v24, v25, v24
    v_cvt_pk_bf16_f32 v24, v24, v24
    v_lshlrev_b32 v21, 16, v24
    v_lshlrev_b32 v32, 16, v8
    v_and_b32 v34, s31, v8
    v_lshlrev_b32 v33, 16, v9
    v_and_b32 v35, s31, v9
    v_lshlrev_b32 v70, 16, v10
    v_and_b32 v72, s31, v10
    v_lshlrev_b32 v71, 16, v11
    v_and_b32 v73, s31, v11
    v_lshlrev_b32 v74, 16, v12
    v_and_b32 v76, s31, v12
    v_lshlrev_b32 v75, 16, v13
    buffer_load_dwordx4 v248, s[24:27], s66 offen offset:1024 lds
    v_and_b32 v77, s31, v13
    v_mov_b32 v24, 0x3fb8aa3b
    v_mov_b32 v25, 0x3e22f983
    v_pk_mul_f32 v[32:33], v[32:33], v[20:21] op_sel:[0,1] op_sel_hi:[1,1]
    v_pk_mul_f32 v[70:71], v[70:71], v[20:21] op_sel:[0,1] op_sel_hi:[1,1]
    v_pk_mul_f32 v[34:35], v[34:35], v[20:21] op_sel:[0,1] op_sel_hi:[1,1]
    v_pk_mul_f32 v[72:73], v[72:73], v[20:21] op_sel:[0,1] op_sel_hi:[1,1]
    v_pk_mul_f32 v[32:33], v[32:33], v[24:25]
    v_pk_mul_f32 v[34:35], v[34:35], v[24:25]
    v_mov_b32 v68, 1.0
    v_mov_b32 v69, 0
    v_mul_f32 v24, 0x41800000, v32
    v_mul_f32 v25, 0xc1800000, v33
    v_exp_f32 v24, v24
    v_fract_f32 v25, v25
    v_mul_f32 v28, 0x41800000, v34
    v_mul_f32 v29, 0xc1800000, v35
    v_exp_f32 v28, v28
    v_fract_f32 v29, v29
    v_cos_f32 v26, v25
    s_add_u32 m0, s51, 122880
    s_add_u32 s66, s66, 294912
    buffer_load_dwordx4 v248, s[20:23], s66 offen lds
    v_sin_f32 v27, v25
    v_cos_f32 v30, v29
    v_sin_f32 v31, v29
    v_exp_f32 v60, v32
    v_fract_f32 v61, v33
    v_exp_f32 v64, v34
    v_fract_f32 v65, v35
    v_cos_f32 v62, v61
    v_sin_f32 v63, v61
    v_cos_f32 v66, v65
    v_sin_f32 v67, v65
    v_pk_mul_f32 v[78:79], v[26:27], v[24:25] op_sel_hi:[1,0]
    v_pk_mul_f32 v[80:81], v[30:31], v[28:29] op_sel_hi:[1,0]
    v_pk_mul_f32 v[86:87], v[74:75], v[70:71] op_sel_hi:[0,1]
    v_pk_mul_f32 v[88:89], v[76:77], v[72:73] op_sel_hi:[0,1]
    v_pk_fma_f32 v[86:87], v[74:75], v[70:71], v[86:87] op_sel:[1,1,0] op_sel_hi:[1,0,1] neg_lo:[1,0,0]
    v_pk_fma_f32 v[88:89], v[76:77], v[72:73], v[88:89] op_sel:[1,1,0] op_sel_hi:[1,0,1] neg_lo:[1,0,0]
    v_pk_mul_f32 v[82:83], v[62:63], v[60:61] op_sel_hi:[1,0]
    v_pk_mul_f32 v[84:85], v[66:67], v[64:65] op_sel_hi:[1,0]
    v_mul_f32 v36, 0x43800000, v32
    buffer_load_dwordx4 v248, s[24:27], s66 offen offset:1024 lds
    v_mul_f32 v37, 0x43800000, v33
    v_exp_f32 v36, v36
    v_fract_f32 v37, v37
    v_mul_f32 v40, 0x43800000, v34
    v_mul_f32 v41, 0x43800000, v35
    v_exp_f32 v40, v40
    v_fract_f32 v41, v41
    v_cos_f32 v38, v37
    v_sin_f32 v39, v37
    v_cos_f32 v42, v41
    v_sin_f32 v43, v41
    v_pk_mul_f32 v[94:95], v[78:79], v[78:79] op_sel_hi:[0,1]
    v_pk_mul_f32 v[96:97], v[80:81], v[80:81] op_sel_hi:[0,1]
    v_pk_fma_f32 v[94:95], v[78:79], v[78:79], v[94:95] op_sel:[1,1,0] op_sel_hi:[1,0,1] neg_lo:[1,0,0]
    v_pk_fma_f32 v[96:97], v[80:81], v[80:81], v[96:97] op_sel:[1,1,0] op_sel_hi:[1,0,1] neg_lo:[1,0,0]
    v_pk_mul_f32 v[90:91], v[38:39], v[36:37] op_sel_hi:[1,0]
    v_pk_mul_f32 v[92:93], v[42:43], v[40:41] op_sel_hi:[1,0]
    v_pk_mul_f32 v[98:99], v[94:95], v[78:79] op_sel_hi:[0,1]
    v_pk_mul_f32 v[100:101], v[96:97], v[80:81] op_sel_hi:[0,1]
    v_pk_fma_f32 v[98:99], v[94:95], v[78:79], v[98:99] op_sel:[1,1,0] op_sel_hi:[1,0,1] neg_lo:[1,0,0]
    s_add_u32 m0, s51, 131072
    s_add_u32 s66, s66, 294912
    buffer_load_dwordx4 v248, s[20:23], s66 offen lds
    v_pk_fma_f32 v[100:101], v[96:97], v[80:81], v[100:101] op_sel:[1,1,0] op_sel_hi:[1,0,1] neg_lo:[1,0,0]
    v_pk_mul_f32 v[102:103], v[94:95], v[94:95] op_sel_hi:[0,1]
    v_pk_mul_f32 v[104:105], v[96:97], v[96:97] op_sel_hi:[0,1]
    v_pk_fma_f32 v[102:103], v[94:95], v[94:95], v[102:103] op_sel:[1,1,0] op_sel_hi:[1,0,1] neg_lo:[1,0,0]
    v_pk_fma_f32 v[104:105], v[96:97], v[96:97], v[104:105] op_sel:[1,1,0] op_sel_hi:[1,0,1] neg_lo:[1,0,0]
    v_pk_mul_f32 v[106:107], v[102:103], v[78:79] op_sel_hi:[0,1]
    v_pk_mul_f32 v[108:109], v[104:105], v[80:81] op_sel_hi:[0,1]
    v_pk_fma_f32 v[106:107], v[102:103], v[78:79], v[106:107] op_sel:[1,1,0] op_sel_hi:[1,0,1] neg_lo:[1,0,0]
    v_pk_fma_f32 v[108:109], v[104:105], v[80:81], v[108:109] op_sel:[1,1,0] op_sel_hi:[1,0,1] neg_lo:[1,0,0]
    v_pk_mul_f32 v[110:111], v[102:103], v[94:95] op_sel_hi:[0,1]
    v_pk_mul_f32 v[112:113], v[104:105], v[96:97] op_sel_hi:[0,1]
    v_pk_fma_f32 v[110:111], v[102:103], v[94:95], v[110:111] op_sel:[1,1,0] op_sel_hi:[1,0,1] neg_lo:[1,0,0]
    v_pk_fma_f32 v[112:113], v[104:105], v[96:97], v[112:113] op_sel:[1,1,0] op_sel_hi:[1,0,1] neg_lo:[1,0,0]
    v_pk_mul_f32 v[114:115], v[102:103], v[98:99] op_sel_hi:[0,1]
    v_pk_mul_f32 v[116:117], v[104:105], v[100:101] op_sel_hi:[0,1]
    v_pk_fma_f32 v[114:115], v[102:103], v[98:99], v[114:115] op_sel:[1,1,0] op_sel_hi:[1,0,1] neg_lo:[1,0,0]
    v_pk_fma_f32 v[116:117], v[104:105], v[100:101], v[116:117] op_sel:[1,1,0] op_sel_hi:[1,0,1] neg_lo:[1,0,0]
    v_pk_mul_f32 v[118:119], v[102:103], v[102:103] op_sel_hi:[0,1]
    v_pk_mul_f32 v[120:121], v[104:105], v[104:105] op_sel_hi:[0,1]
    v_pk_fma_f32 v[118:119], v[102:103], v[102:103], v[118:119] op_sel:[1,1,0] op_sel_hi:[1,0,1] neg_lo:[1,0,0]
    buffer_load_dwordx4 v248, s[24:27], s66 offen offset:1024 lds
    v_pk_fma_f32 v[120:121], v[104:105], v[104:105], v[120:121] op_sel:[1,1,0] op_sel_hi:[1,0,1] neg_lo:[1,0,0]
    v_pk_mul_f32 v[122:123], v[82:83], v[82:83] op_sel_hi:[0,1]
    v_pk_mul_f32 v[124:125], v[84:85], v[84:85] op_sel_hi:[0,1]
    v_pk_fma_f32 v[122:123], v[82:83], v[82:83], v[122:123] op_sel:[1,1,0] op_sel_hi:[1,0,1] neg_lo:[1,0,0]
    v_pk_fma_f32 v[124:125], v[84:85], v[84:85], v[124:125] op_sel:[1,1,0] op_sel_hi:[1,0,1] neg_lo:[1,0,0]
    v_pk_mul_f32 v[126:127], v[118:119], v[78:79] op_sel_hi:[0,1]
    v_pk_mul_f32 v[128:129], v[120:121], v[80:81] op_sel_hi:[0,1]
    v_pk_fma_f32 v[126:127], v[118:119], v[78:79], v[126:127] op_sel:[1,1,0] op_sel_hi:[1,0,1] neg_lo:[1,0,0]
    v_pk_fma_f32 v[128:129], v[120:121], v[80:81], v[128:129] op_sel:[1,1,0] op_sel_hi:[1,0,1] neg_lo:[1,0,0]
    v_pk_mul_f32 v[130:131], v[118:119], v[94:95] op_sel_hi:[0,1]
    v_pk_mul_f32 v[132:133], v[120:121], v[96:97] op_sel_hi:[0,1]
    v_pk_fma_f32 v[130:131], v[118:119], v[94:95], v[130:131] op_sel:[1,1,0] op_sel_hi:[1,0,1] neg_lo:[1,0,0]
    v_pk_fma_f32 v[132:133], v[120:121], v[96:97], v[132:133] op_sel:[1,1,0] op_sel_hi:[1,0,1] neg_lo:[1,0,0]
    v_pk_mul_f32 v[134:135], v[118:119], v[98:99] op_sel_hi:[0,1]
    v_pk_mul_f32 v[136:137], v[120:121], v[100:101] op_sel_hi:[0,1]
    v_pk_fma_f32 v[134:135], v[118:119], v[98:99], v[134:135] op_sel:[1,1,0] op_sel_hi:[1,0,1] neg_lo:[1,0,0]
    v_pk_fma_f32 v[136:137], v[120:121], v[100:101], v[136:137] op_sel:[1,1,0] op_sel_hi:[1,0,1] neg_lo:[1,0,0]
    v_pk_mul_f32 v[138:139], v[118:119], v[102:103] op_sel_hi:[0,1]
    v_pk_mul_f32 v[140:141], v[120:121], v[104:105] op_sel_hi:[0,1]
    v_pk_fma_f32 v[138:139], v[118:119], v[102:103], v[138:139] op_sel:[1,1,0] op_sel_hi:[1,0,1] neg_lo:[1,0,0]
    s_add_u32 m0, s70, 32768
    s_add_u32 s66, s68, s97
    s_add_u32 s66, s66, 128
    buffer_load_dwordx4 v242, s[8:11], s66 offen offset:0 lds
    v_pk_fma_f32 v[140:141], v[120:121], v[104:105], v[140:141] op_sel:[1,1,0] op_sel_hi:[1,0,1] neg_lo:[1,0,0]
    v_pk_mul_f32 v[142:143], v[118:119], v[106:107] op_sel_hi:[0,1]
    v_pk_mul_f32 v[144:145], v[120:121], v[108:109] op_sel_hi:[0,1]
    v_pk_fma_f32 v[142:143], v[118:119], v[106:107], v[142:143] op_sel:[1,1,0] op_sel_hi:[1,0,1] neg_lo:[1,0,0]
    v_pk_fma_f32 v[144:145], v[120:121], v[108:109], v[144:145] op_sel:[1,1,0] op_sel_hi:[1,0,1] neg_lo:[1,0,0]
    v_pk_mul_f32 v[146:147], v[118:119], v[110:111] op_sel_hi:[0,1]
    v_pk_mul_f32 v[148:149], v[120:121], v[112:113] op_sel_hi:[0,1]
    v_pk_fma_f32 v[146:147], v[118:119], v[110:111], v[146:147] op_sel:[1,1,0] op_sel_hi:[1,0,1] neg_lo:[1,0,0]
    v_pk_fma_f32 v[148:149], v[120:121], v[112:113], v[148:149] op_sel:[1,1,0] op_sel_hi:[1,0,1] neg_lo:[1,0,0]
    v_pk_mul_f32 v[150:151], v[118:119], v[114:115] op_sel_hi:[0,1]
    v_pk_mul_f32 v[152:153], v[120:121], v[116:117] op_sel_hi:[0,1]
    v_pk_fma_f32 v[150:151], v[118:119], v[114:115], v[150:151] op_sel:[1,1,0] op_sel_hi:[1,0,1] neg_lo:[1,0,0]
    v_pk_fma_f32 v[152:153], v[120:121], v[116:117], v[152:153] op_sel:[1,1,0] op_sel_hi:[1,0,1] neg_lo:[1,0,0]
    v_cvt_pk_bf16_f32 v36, v68, v78
    v_cvt_pk_bf16_f32 v37, v94, v98
    v_cvt_pk_bf16_f32 v38, v102, v106
    v_cvt_pk_bf16_f32 v39, v110, v114
    v_cvt_pk_bf16_f32 v40, v69, v79
    v_cvt_pk_bf16_f32 v41, v95, v99
    v_cvt_pk_bf16_f32 v42, v103, v107
    buffer_load_dwordx4 v243, s[8:11], s66 offen offset:1024 lds
    v_cvt_pk_bf16_f32 v43, v111, v115
    ds_write_b128 v16, v[36:39] offset:0
    v_cvt_pk_bf16_f32 v44, v68, v80
    v_cvt_pk_bf16_f32 v45, v96, v100
    v_cvt_pk_bf16_f32 v46, v104, v108
    v_cvt_pk_bf16_f32 v47, v112, v116
    ds_write_b128 v16, v[40:43] offset:32
    v_cvt_pk_bf16_f32 v48, v69, v81
    v_cvt_pk_bf16_f32 v49, v97, v101
    v_cvt_pk_bf16_f32 v50, v105, v109
    v_cvt_pk_bf16_f32 v51, v113, v117
    ds_write_b128 v16, v[44:47] offset:64
    v_cvt_pk_bf16_f32 v36, v118, v126
    v_cvt_pk_bf16_f32 v37, v130, v134
    v_cvt_pk_bf16_f32 v38, v138, v142
    v_cvt_pk_bf16_f32 v39, v146, v150
    ds_write_b128 v16, v[48:51] offset:96
    v_cvt_pk_bf16_f32 v40, v119, v127
    v_cvt_pk_bf16_f32 v41, v131, v135
    v_cvt_pk_bf16_f32 v42, v139, v143
    buffer_load_dwordx4 v244, s[8:11], s66 offen offset:2048 lds
    v_cvt_pk_bf16_f32 v43, v147, v151
    ds_write_b128 v16, v[36:39] offset:16
    v_cvt_pk_bf16_f32 v44, v120, v128
    v_cvt_pk_bf16_f32 v45, v132, v136
    v_cvt_pk_bf16_f32 v46, v140, v144
    v_cvt_pk_bf16_f32 v47, v148, v152
    ds_write_b128 v16, v[40:43] offset:48
    v_cvt_pk_bf16_f32 v48, v121, v129
    v_cvt_pk_bf16_f32 v49, v133, v137
    v_cvt_pk_bf16_f32 v50, v141, v145
    v_cvt_pk_bf16_f32 v51, v149, v153
    ds_write_b128 v16, v[44:47] offset:80
    ds_write_b128 v16, v[48:51] offset:112
    ds_read_b64_tr_b16 a[224:225], v17 offset:0
    ds_read_b64_tr_b16 a[226:227], v17 offset:288
    ds_read_b64_tr_b16 a[228:229], v17 offset:576
    ds_read_b64_tr_b16 a[230:231], v17 offset:864
    ds_read_b64_tr_b16 a[232:233], v17 offset:2304
    ds_read_b64_tr_b16 a[234:235], v17 offset:2592
    ds_read_b64_tr_b16 a[236:237], v17 offset:2880
    buffer_load_dwordx4 v245, s[8:11], s66 offen offset:3072 lds
    ds_read_b64_tr_b16 a[238:239], v17 offset:3168
    ds_read_b64_tr_b16 a[240:241], v17 offset:4608
    ds_read_b64_tr_b16 a[242:243], v17 offset:4896
    ds_read_b64_tr_b16 a[244:245], v17 offset:5184
    ds_read_b64_tr_b16 a[246:247], v17 offset:5472
    ds_read_b64_tr_b16 a[248:249], v17 offset:6912
    ds_read_b64_tr_b16 a[250:251], v17 offset:7200
    ds_read_b64_tr_b16 a[252:253], v17 offset:7488
    ds_read_b64_tr_b16 a[254:255], v17 offset:7776
    v_pk_mul_f32 v[154:155], v[122:123], v[122:123] op_sel_hi:[0,1]
    v_pk_mul_f32 v[156:157], v[124:125], v[124:125] op_sel_hi:[0,1]
    v_pk_fma_f32 v[154:155], v[122:123], v[122:123], v[154:155] op_sel:[1,1,0] op_sel_hi:[1,0,1] neg_lo:[1,0,0]
    v_pk_fma_f32 v[156:157], v[124:125], v[124:125], v[156:157] op_sel:[1,1,0] op_sel_hi:[1,0,1] neg_lo:[1,0,0]
    v_pk_mul_f32 v[70:71], v[86:87], v[82:83] op_sel_hi:[0,1]
    v_pk_mul_f32 v[72:73], v[88:89], v[84:85] op_sel_hi:[0,1]
    v_pk_fma_f32 v[70:71], v[86:87], v[82:83], v[70:71] op_sel:[1,1,0] op_sel_hi:[1,0,1] neg_lo:[1,0,0]
    v_pk_fma_f32 v[72:73], v[88:89], v[84:85], v[72:73] op_sel:[1,1,0] op_sel_hi:[1,0,1] neg_lo:[1,0,0]
    v_pk_mul_f32 v[74:75], v[86:87], v[122:123] op_sel_hi:[0,1]
    v_pk_mul_f32 v[76:77], v[88:89], v[124:125] op_sel_hi:[0,1]
    v_pk_fma_f32 v[74:75], v[86:87], v[122:123], v[74:75] op_sel:[1,1,0] op_sel_hi:[1,0,1] neg_lo:[1,0,0]
    s_add_u32 m0, s70, 36864
    s_add_u32 s66, s69, s97
    s_add_u32 s66, s66, 128
    buffer_load_dwordx4 v242, s[8:11], s66 offen offset:0 lds
    v_pk_fma_f32 v[76:77], v[88:89], v[124:125], v[76:77] op_sel:[1,1,0] op_sel_hi:[1,0,1] neg_lo:[1,0,0]
    v_pk_mul_f32 v[98:99], v[70:71], v[122:123] op_sel_hi:[0,1]
    v_pk_mul_f32 v[100:101], v[72:73], v[124:125] op_sel_hi:[0,1]
    v_pk_fma_f32 v[98:99], v[70:71], v[122:123], v[98:99] op_sel:[1,1,0] op_sel_hi:[1,0,1] neg_lo:[1,0,0]
    v_pk_fma_f32 v[100:101], v[72:73], v[124:125], v[100:101] op_sel:[1,1,0] op_sel_hi:[1,0,1] neg_lo:[1,0,0]
    v_pk_mul_f32 v[114:115], v[154:155], v[154:155] op_sel_hi:[0,1]
    v_pk_mul_f32 v[116:117], v[156:157], v[156:157] op_sel_hi:[0,1]
    v_pk_fma_f32 v[114:115], v[154:155], v[154:155], v[114:115] op_sel:[1,1,0] op_sel_hi:[1,0,1] neg_lo:[1,0,0]
    v_pk_fma_f32 v[116:117], v[156:157], v[156:157], v[116:117] op_sel:[1,1,0] op_sel_hi:[1,0,1] neg_lo:[1,0,0]
    v_pk_mul_f32 v[110:111], v[86:87], v[154:155] op_sel_hi:[0,1]
    v_pk_mul_f32 v[112:113], v[88:89], v[156:157] op_sel_hi:[0,1]
    v_pk_fma_f32 v[110:111], v[86:87], v[154:155], v[110:111] op_sel:[1,1,0] op_sel_hi:[1,0,1] neg_lo:[1,0,0]
    v_pk_fma_f32 v[112:113], v[88:89], v[156:157], v[112:113] op_sel:[1,1,0] op_sel_hi:[1,0,1] neg_lo:[1,0,0]
    v_pk_mul_f32 v[102:103], v[70:71], v[154:155] op_sel_hi:[0,1]
    v_pk_mul_f32 v[104:105], v[72:73], v[156:157] op_sel_hi:[0,1]
    v_pk_fma_f32 v[102:103], v[70:71], v[154:155], v[102:103] op_sel:[1,1,0] op_sel_hi:[1,0,1] neg_lo:[1,0,0]
    v_pk_fma_f32 v[104:105], v[72:73], v[156:157], v[104:105] op_sel:[1,1,0] op_sel_hi:[1,0,1] neg_lo:[1,0,0]
    v_pk_mul_f32 v[78:79], v[74:75], v[154:155] op_sel_hi:[0,1]
    v_pk_mul_f32 v[80:81], v[76:77], v[156:157] op_sel_hi:[0,1]
    v_pk_fma_f32 v[78:79], v[74:75], v[154:155], v[78:79] op_sel:[1,1,0] op_sel_hi:[1,0,1] neg_lo:[1,0,0]
    buffer_load_dwordx4 v243, s[8:11], s66 offen offset:1024 lds
    v_pk_fma_f32 v[80:81], v[76:77], v[156:157], v[80:81] op_sel:[1,1,0] op_sel_hi:[1,0,1] neg_lo:[1,0,0]
    v_pk_mul_f32 v[94:95], v[98:99], v[154:155] op_sel_hi:[0,1]
    v_pk_mul_f32 v[96:97], v[100:101], v[156:157] op_sel_hi:[0,1]
    v_pk_fma_f32 v[94:95], v[98:99], v[154:155], v[94:95] op_sel:[1,1,0] op_sel_hi:[1,0,1] neg_lo:[1,0,0]
    v_pk_fma_f32 v[96:97], v[100:101], v[156:157], v[96:97] op_sel:[1,1,0] op_sel_hi:[1,0,1] neg_lo:[1,0,0]
    v_pk_mul_f32 v[106:107], v[86:87], v[114:115] op_sel_hi:[0,1]
    v_pk_mul_f32 v[108:109], v[88:89], v[116:117] op_sel_hi:[0,1]
    v_pk_fma_f32 v[106:107], v[86:87], v[114:115], v[106:107] op_sel:[1,1,0] op_sel_hi:[1,0,1] neg_lo:[1,0,0]
    v_pk_fma_f32 v[108:109], v[88:89], v[116:117], v[108:109] op_sel:[1,1,0] op_sel_hi:[1,0,1] neg_lo:[1,0,0]
    v_pk_mul_f32 v[134:135], v[70:71], v[114:115] op_sel_hi:[0,1]
    v_pk_mul_f32 v[136:137], v[72:73], v[116:117] op_sel_hi:[0,1]
    v_pk_fma_f32 v[134:135], v[70:71], v[114:115], v[134:135] op_sel:[1,1,0] op_sel_hi:[1,0,1] neg_lo:[1,0,0]
    v_pk_fma_f32 v[136:137], v[72:73], v[116:117], v[136:137] op_sel:[1,1,0] op_sel_hi:[1,0,1] neg_lo:[1,0,0]
    v_pk_mul_f32 v[118:119], v[74:75], v[114:115] op_sel_hi:[0,1]
    v_pk_mul_f32 v[120:121], v[76:77], v[116:117] op_sel_hi:[0,1]
    v_pk_fma_f32 v[118:119], v[74:75], v[114:115], v[118:119] op_sel:[1,1,0] op_sel_hi:[1,0,1] neg_lo:[1,0,0]
    v_pk_fma_f32 v[120:121], v[76:77], v[116:117], v[120:121] op_sel:[1,1,0] op_sel_hi:[1,0,1] neg_lo:[1,0,0]
    v_pk_mul_f32 v[130:131], v[98:99], v[114:115] op_sel_hi:[0,1]
    v_pk_mul_f32 v[132:133], v[100:101], v[116:117] op_sel_hi:[0,1]
    v_pk_fma_f32 v[130:131], v[98:99], v[114:115], v[130:131] op_sel:[1,1,0] op_sel_hi:[1,0,1] neg_lo:[1,0,0]
    buffer_load_dwordx4 v244, s[8:11], s66 offen offset:2048 lds
    v_pk_fma_f32 v[132:133], v[100:101], v[116:117], v[132:133] op_sel:[1,1,0] op_sel_hi:[1,0,1] neg_lo:[1,0,0]
    v_pk_mul_f32 v[150:151], v[110:111], v[114:115] op_sel_hi:[0,1]
    v_pk_mul_f32 v[152:153], v[112:113], v[116:117] op_sel_hi:[0,1]
    v_pk_fma_f32 v[150:151], v[110:111], v[114:115], v[150:151] op_sel:[1,1,0] op_sel_hi:[1,0,1] neg_lo:[1,0,0]
    v_pk_fma_f32 v[152:153], v[112:113], v[116:117], v[152:153] op_sel:[1,1,0] op_sel_hi:[1,0,1] neg_lo:[1,0,0]
    v_pk_mul_f32 v[142:143], v[102:103], v[114:115] op_sel_hi:[0,1]
    v_pk_mul_f32 v[144:145], v[104:105], v[116:117] op_sel_hi:[0,1]
    v_pk_fma_f32 v[142:143], v[102:103], v[114:115], v[142:143] op_sel:[1,1,0] op_sel_hi:[1,0,1] neg_lo:[1,0,0]
    v_pk_fma_f32 v[144:145], v[104:105], v[116:117], v[144:145] op_sel:[1,1,0] op_sel_hi:[1,0,1] neg_lo:[1,0,0]
    v_pk_mul_f32 v[138:139], v[78:79], v[114:115] op_sel_hi:[0,1]
    v_pk_mul_f32 v[140:141], v[80:81], v[116:117] op_sel_hi:[0,1]
    v_pk_fma_f32 v[138:139], v[78:79], v[114:115], v[138:139] op_sel:[1,1,0] op_sel_hi:[1,0,1] neg_lo:[1,0,0]
    v_pk_fma_f32 v[140:141], v[80:81], v[116:117], v[140:141] op_sel:[1,1,0] op_sel_hi:[1,0,1] neg_lo:[1,0,0]
    v_pk_mul_f32 v[126:127], v[94:95], v[114:115] op_sel_hi:[0,1]
    v_pk_mul_f32 v[128:129], v[96:97], v[116:117] op_sel_hi:[0,1]
    v_pk_fma_f32 v[126:127], v[94:95], v[114:115], v[126:127] op_sel:[1,1,0] op_sel_hi:[1,0,1] neg_lo:[1,0,0]
    v_pk_fma_f32 v[128:129], v[96:97], v[116:117], v[128:129] op_sel:[1,1,0] op_sel_hi:[1,0,1] neg_lo:[1,0,0]
    v_cvt_pk_bf16_f32 v36, v86, v70
    v_cvt_pk_bf16_f32 v37, v74, v98
    v_cvt_pk_bf16_f32 v38, v110, v102
    buffer_load_dwordx4 v245, s[8:11], s66 offen offset:3072 lds
    v_cvt_pk_bf16_f32 v39, v78, v94
    v_cvt_pk_bf16_f32 v40, v87, v71
    v_cvt_pk_bf16_f32 v41, v75, v99
    v_cvt_pk_bf16_f32 v42, v111, v103
    v_cvt_pk_bf16_f32 v43, v79, v95
    ds_write_b128 v16, v[36:39] offset:0
    v_cvt_pk_bf16_f32 v44, v88, v72
    v_cvt_pk_bf16_f32 v45, v76, v100
    v_cvt_pk_bf16_f32 v46, v112, v104
    v_cvt_pk_bf16_f32 v47, v80, v96
    ds_write_b128 v16, v[40:43] offset:32
    v_cvt_pk_bf16_f32 v48, v89, v73
    v_cvt_pk_bf16_f32 v49, v77, v101
    v_cvt_pk_bf16_f32 v50, v113, v105
    v_cvt_pk_bf16_f32 v51, v81, v97
    ds_write_b128 v16, v[44:47] offset:64
    v_cvt_pk_bf16_f32 v36, v106, v134
    v_cvt_pk_bf16_f32 v37, v118, v130
    v_cvt_pk_bf16_f32 v38, v150, v142
    v_cvt_pk_bf16_f32 v39, v138, v126
    s_add_u32 m0, s51, 139264
    s_add_u32 s66, s48, s94
    s_add_u32 s66, s66, 884736
    buffer_load_dwordx4 v248, s[20:23], s66 offen lds
    ds_write_b128 v16, v[48:51] offset:96
    v_cvt_pk_bf16_f32 v40, v107, v135
    v_cvt_pk_bf16_f32 v41, v119, v131
    v_cvt_pk_bf16_f32 v42, v151, v143
    v_cvt_pk_bf16_f32 v43, v139, v127
    ds_write_b128 v16, v[36:39] offset:16
    v_cvt_pk_bf16_f32 v44, v108, v136
    v_cvt_pk_bf16_f32 v45, v120, v132
    v_cvt_pk_bf16_f32 v46, v152, v144
    v_cvt_pk_bf16_f32 v47, v140, v128
    ds_write_b128 v16, v[40:43] offset:48
    v_cvt_pk_bf16_f32 v48, v109, v137
    v_cvt_pk_bf16_f32 v49, v121, v133
    v_cvt_pk_bf16_f32 v50, v153, v145
    v_cvt_pk_bf16_f32 v51, v141, v129
    ds_write_b128 v16, v[44:47] offset:80
    ds_write_b128 v16, v[48:51] offset:112
    ds_read_b64_tr_b16 v[192:193], v17 offset:0
    ds_read_b64_tr_b16 v[194:195], v17 offset:288
    ds_read_b64_tr_b16 v[196:197], v17 offset:576
    buffer_load_dwordx4 v248, s[24:27], s66 offen offset:1024 lds
    ds_read_b64_tr_b16 v[198:199], v17 offset:864
    ds_read_b64_tr_b16 v[200:201], v17 offset:2304
    ds_read_b64_tr_b16 v[202:203], v17 offset:2592
    ds_read_b64_tr_b16 v[204:205], v17 offset:2880
    ds_read_b64_tr_b16 v[206:207], v17 offset:3168
    ds_read_b64_tr_b16 v[208:209], v17 offset:4608
    ds_read_b64_tr_b16 v[210:211], v17 offset:4896
    ds_read_b64_tr_b16 v[212:213], v17 offset:5184
    ds_read_b64_tr_b16 v[214:215], v17 offset:5472
    ds_read_b64_tr_b16 v[216:217], v17 offset:6912
    ds_read_b64_tr_b16 v[218:219], v17 offset:7200
    ds_read_b64_tr_b16 v[220:221], v17 offset:7488
    ds_read_b64_tr_b16 v[222:223], v17 offset:7776
    v_pk_mul_f32 v[146:147], v[86:87], v[90:91] op_sel_hi:[0,1]
    v_pk_mul_f32 v[148:149], v[88:89], v[92:93] op_sel_hi:[0,1]
    v_pk_fma_f32 v[146:147], v[86:87], v[90:91], v[146:147] op_sel:[1,1,0] op_sel_hi:[1,0,1] neg_lo:[1,0,0]
    v_pk_fma_f32 v[148:149], v[88:89], v[92:93], v[148:149] op_sel:[1,1,0] op_sel_hi:[1,0,1] neg_lo:[1,0,0]
    v_pk_mul_f32 v[82:83], v[74:75], v[90:91] op_sel_hi:[0,1]
    v_pk_mul_f32 v[84:85], v[76:77], v[92:93] op_sel_hi:[0,1]
    v_pk_fma_f32 v[82:83], v[74:75], v[90:91], v[82:83] op_sel:[1,1,0] op_sel_hi:[1,0,1] neg_lo:[1,0,0]
    s_add_u32 m0, s51, 147456
    s_add_u32 s66, s66, 294912
    buffer_load_dwordx4 v248, s[20:23], s66 offen lds
    v_pk_fma_f32 v[84:85], v[76:77], v[92:93], v[84:85] op_sel:[1,1,0] op_sel_hi:[1,0,1] neg_lo:[1,0,0]
    v_pk_mul_f32 v[122:123], v[146:147], v[90:91] op_sel_hi:[0,1]
    v_pk_mul_f32 v[124:125], v[148:149], v[92:93] op_sel_hi:[0,1]
    v_pk_fma_f32 v[122:123], v[146:147], v[90:91], v[122:123] op_sel:[1,1,0] op_sel_hi:[1,0,1] neg_lo:[1,0,0]
    v_pk_fma_f32 v[124:125], v[148:149], v[92:93], v[124:125] op_sel:[1,1,0] op_sel_hi:[1,0,1] neg_lo:[1,0,0]
    v_pk_mul_f32 v[154:155], v[110:111], v[90:91] op_sel_hi:[0,1]
    v_pk_mul_f32 v[156:157], v[112:113], v[92:93] op_sel_hi:[0,1]
    v_pk_fma_f32 v[154:155], v[110:111], v[90:91], v[154:155] op_sel:[1,1,0] op_sel_hi:[1,0,1] neg_lo:[1,0,0]
    v_pk_fma_f32 v[156:157], v[112:113], v[92:93], v[156:157] op_sel:[1,1,0] op_sel_hi:[1,0,1] neg_lo:[1,0,0]
    v_pk_mul_f32 v[102:103], v[122:123], v[90:91] op_sel_hi:[0,1]
    v_pk_mul_f32 v[104:105], v[124:125], v[92:93] op_sel_hi:[0,1]
    v_pk_fma_f32 v[102:103], v[122:123], v[90:91], v[102:103] op_sel:[1,1,0] op_sel_hi:[1,0,1] neg_lo:[1,0,0]
    v_pk_fma_f32 v[104:105], v[124:125], v[92:93], v[104:105] op_sel:[1,1,0] op_sel_hi:[1,0,1] neg_lo:[1,0,0]
    v_pk_mul_f32 v[94:95], v[78:79], v[90:91] op_sel_hi:[0,1]
    v_pk_mul_f32 v[96:97], v[80:81], v[92:93] op_sel_hi:[0,1]
    v_pk_fma_f32 v[94:95], v[78:79], v[90:91], v[94:95] op_sel:[1,1,0] op_sel_hi:[1,0,1] neg_lo:[1,0,0]
    v_pk_fma_f32 v[96:97], v[80:81], v[92:93], v[96:97] op_sel:[1,1,0] op_sel_hi:[1,0,1] neg_lo:[1,0,0]
    v_pk_mul_f32 v[70:71], v[102:103], v[90:91] op_sel_hi:[0,1]
    v_pk_mul_f32 v[72:73], v[104:105], v[92:93] op_sel_hi:[0,1]
    v_pk_fma_f32 v[70:71], v[102:103], v[90:91], v[70:71] op_sel:[1,1,0] op_sel_hi:[1,0,1] neg_lo:[1,0,0]
    buffer_load_dwordx4 v248, s[24:27], s66 offen offset:1024 lds
    v_pk_fma_f32 v[72:73], v[104:105], v[92:93], v[72:73] op_sel:[1,1,0] op_sel_hi:[1,0,1] neg_lo:[1,0,0]
    v_pk_mul_f32 v[98:99], v[106:107], v[90:91] op_sel_hi:[0,1]
    v_pk_mul_f32 v[100:101], v[108:109], v[92:93] op_sel_hi:[0,1]
    v_pk_fma_f32 v[98:99], v[106:107], v[90:91], v[98:99] op_sel:[1,1,0] op_sel_hi:[1,0,1] neg_lo:[1,0,0]
    v_pk_fma_f32 v[100:101], v[108:109], v[92:93], v[100:101] op_sel:[1,1,0] op_sel_hi:[1,0,1] neg_lo:[1,0,0]
    v_pk_mul_f32 v[126:127], v[70:71], v[90:91] op_sel_hi:[0,1]
    v_pk_mul_f32 v[128:129], v[72:73], v[92:93] op_sel_hi:[0,1]
    v_pk_fma_f32 v[126:127], v[70:71], v[90:91], v[126:127] op_sel:[1,1,0] op_sel_hi:[1,0,1] neg_lo:[1,0,0]
    v_pk_fma_f32 v[128:129], v[72:73], v[92:93], v[128:129] op_sel:[1,1,0] op_sel_hi:[1,0,1] neg_lo:[1,0,0]
    v_pk_mul_f32 v[130:131], v[118:119], v[90:91] op_sel_hi:[0,1]
    v_pk_mul_f32 v[132:133], v[120:121], v[92:93] op_sel_hi:[0,1]
    v_pk_fma_f32 v[130:131], v[118:119], v[90:91], v[130:131] op_sel:[1,1,0] op_sel_hi:[1,0,1] neg_lo:[1,0,0]
    v_pk_fma_f32 v[132:133], v[120:121], v[92:93], v[132:133] op_sel:[1,1,0] op_sel_hi:[1,0,1] neg_lo:[1,0,0]
    v_pk_mul_f32 v[134:135], v[126:127], v[90:91] op_sel_hi:[0,1]
    v_pk_mul_f32 v[136:137], v[128:129], v[92:93] op_sel_hi:[0,1]
    v_pk_fma_f32 v[134:135], v[126:127], v[90:91], v[134:135] op_sel:[1,1,0] op_sel_hi:[1,0,1] neg_lo:[1,0,0]
    v_pk_fma_f32 v[136:137], v[128:129], v[92:93], v[136:137] op_sel:[1,1,0] op_sel_hi:[1,0,1] neg_lo:[1,0,0]
    v_pk_mul_f32 v[142:143], v[150:151], v[90:91] op_sel_hi:[0,1]
    v_pk_mul_f32 v[144:145], v[152:153], v[92:93] op_sel_hi:[0,1]
    v_pk_fma_f32 v[142:143], v[150:151], v[90:91], v[142:143] op_sel:[1,1,0] op_sel_hi:[1,0,1] neg_lo:[1,0,0]
    s_add_u32 m0, s51, 155648
    s_add_u32 s66, s66, 294912
    buffer_load_dwordx4 v248, s[20:23], s66 offen lds
    v_pk_fma_f32 v[144:145], v[152:153], v[92:93], v[144:145] op_sel:[1,1,0] op_sel_hi:[1,0,1] neg_lo:[1,0,0]
    v_pk_mul_f32 v[86:87], v[134:135], v[90:91] op_sel_hi:[0,1]
    v_pk_mul_f32 v[88:89], v[136:137], v[92:93] op_sel_hi:[0,1]
    v_pk_fma_f32 v[86:87], v[134:135], v[90:91], v[86:87] op_sel:[1,1,0] op_sel_hi:[1,0,1] neg_lo:[1,0,0]
    v_pk_fma_f32 v[88:89], v[136:137], v[92:93], v[88:89] op_sel:[1,1,0] op_sel_hi:[1,0,1] neg_lo:[1,0,0]
    v_pk_mul_f32 v[74:75], v[138:139], v[90:91] op_sel_hi:[0,1]
    v_pk_mul_f32 v[76:77], v[140:141], v[92:93] op_sel_hi:[0,1]
    v_pk_fma_f32 v[74:75], v[138:139], v[90:91], v[74:75] op_sel:[1,1,0] op_sel_hi:[1,0,1] neg_lo:[1,0,0]
    v_pk_fma_f32 v[76:77], v[140:141], v[92:93], v[76:77] op_sel:[1,1,0] op_sel_hi:[1,0,1] neg_lo:[1,0,0]
    v_pk_mul_f32 v[110:111], v[98:99], v[114:115] op_sel_hi:[0,1]
    v_pk_mul_f32 v[112:113], v[100:101], v[116:117] op_sel_hi:[0,1]
    v_pk_fma_f32 v[110:111], v[98:99], v[114:115], v[110:111] op_sel:[1,1,0] op_sel_hi:[1,0,1] neg_lo:[1,0,0]
    v_pk_fma_f32 v[112:113], v[100:101], v[116:117], v[112:113] op_sel:[1,1,0] op_sel_hi:[1,0,1] neg_lo:[1,0,0]
    s_waitcnt lgkmcnt(0)
    v_cvt_pk_bf16_f32 v36, v146, v82
    v_cvt_pk_bf16_f32 v37, v154, v70
    v_cvt_pk_bf16_f32 v38, v154, v94
    v_cvt_pk_bf16_f32 v39, v98, v126
    v_mfma_f32_16x16x32_bf16 v[56:59], v[192:195], a[224:227], 0
    v_cvt_pk_bf16_f32 v40, v147, v83
    buffer_load_dwordx4 v248, s[24:27], s66 offen offset:1024 lds
    v_cvt_pk_bf16_f32 v41, v155, v71
    v_cvt_pk_bf16_f32 v42, v155, v95
    v_cvt_pk_bf16_f32 v43, v99, v127
    v_mfma_f32_16x16x32_bf16 v[56:59], v[196:199], a[228:231], v[56:59]
    ds_write_b128 v16, v[36:39] offset:0
    v_cvt_pk_bf16_f32 v44, v148, v84
    v_cvt_pk_bf16_f32 v45, v156, v72
    v_cvt_pk_bf16_f32 v46, v156, v96
    v_cvt_pk_bf16_f32 v47, v100, v128
    v_mfma_f32_16x16x32_bf16 v[56:59], v[200:203], a[232:235], v[56:59]
    ds_write_b128 v16, v[40:43] offset:32
    v_cvt_pk_bf16_f32 v48, v149, v85
    v_cvt_pk_bf16_f32 v49, v157, v73
    v_cvt_pk_bf16_f32 v50, v157, v97
    v_cvt_pk_bf16_f32 v51, v101, v129
    v_mfma_f32_16x16x32_bf16 v[56:59], v[204:207], a[236:239], v[56:59]
    ds_write_b128 v16, v[44:47] offset:64
    v_cvt_pk_bf16_f32 v36, v98, v130
    v_cvt_pk_bf16_f32 v37, v142, v134
    v_cvt_pk_bf16_f32 v38, v142, v74
    buffer_load_dword v241, v237, s[40:43], 0 offen
    v_cvt_pk_bf16_f32 v39, v110, v86
    v_mfma_f32_16x16x32_bf16 v[56:59], v[208:211], a[240:243], v[56:59]
    ds_write_b128 v16, v[48:51] offset:96
    v_cvt_pk_bf16_f32 v40, v99, v131
    v_cvt_pk_bf16_f32 v41, v143, v135
    v_cvt_pk_bf16_f32 v42, v143, v75
    v_cvt_pk_bf16_f32 v43, v111, v87
    v_mfma_f32_16x16x32_bf16 v[56:59], v[212:215], a[244:247], v[56:59]
    ds_write_b128 v16, v[36:39] offset:16
    v_cvt_pk_bf16_f32 v44, v100, v132
    v_cvt_pk_bf16_f32 v45, v144, v136
    v_cvt_pk_bf16_f32 v46, v144, v76
    v_cvt_pk_bf16_f32 v47, v112, v88
    v_mfma_f32_16x16x32_bf16 v[56:59], v[216:219], a[248:251], v[56:59]
    ds_write_b128 v16, v[40:43] offset:48
    v_cvt_pk_bf16_f32 v48, v101, v133
    v_cvt_pk_bf16_f32 v49, v145, v137
    v_cvt_pk_bf16_f32 v50, v145, v77
    v_cvt_pk_bf16_f32 v51, v113, v89
    v_mfma_f32_16x16x32_bf16 v[56:59], v[220:223], a[252:255], v[56:59]
    s_waitcnt vmcnt(22)
    ds_read_b128 a[0:3], v246 offset:0
    ds_write_b128 v16, v[44:47] offset:80
    ds_write_b128 v16, v[48:51] offset:112
    ds_read_b128 a[4:7], v246 offset:2048
    ds_read_b64_tr_b16 v[160:161], v17 offset:0
    ds_read_b64_tr_b16 v[162:163], v17 offset:288
    ds_read_b128 a[8:11], v246 offset:4096
    ds_read_b64_tr_b16 v[164:165], v17 offset:576
    ds_read_b64_tr_b16 v[166:167], v17 offset:864
    ds_read_b128 a[12:15], v246 offset:6144
    ds_read_b64_tr_b16 v[168:169], v17 offset:2304
    ds_read_b64_tr_b16 v[170:171], v17 offset:2592
    ds_read_b128 a[16:19], v247 offset:0
    ds_read_b64_tr_b16 v[172:173], v17 offset:2880
    ds_read_b64_tr_b16 v[174:175], v17 offset:3168
    ds_read_b128 a[20:23], v247 offset:2048
    ds_read_b64_tr_b16 v[176:177], v17 offset:4608
    ds_read_b64_tr_b16 v[178:179], v17 offset:4896
    ds_read_b128 a[24:27], v247 offset:4096
    ds_read_b64_tr_b16 v[180:181], v17 offset:5184
    ds_read_b64_tr_b16 v[182:183], v17 offset:5472
    ds_read_b128 a[28:31], v247 offset:6144
    ds_read_b64_tr_b16 v[184:185], v17 offset:6912
    ds_read_b64_tr_b16 v[186:187], v17 offset:7200
    s_waitcnt lgkmcnt(2)
    s_add_u32 m0, s70, 0
    s_add_u32 s66, s68, s97
    s_add_u32 s66, s66, 256
    buffer_load_dwordx4 v242, s[8:11], s66 offen offset:0 lds
    ds_read_b64_tr_b16 v[188:189], v17 offset:7488
    ds_read_b64_tr_b16 v[190:191], v17 offset:7776
    v_pk_mul_f32 v[78:79], v[154:155], v[90:91] op_sel_hi:[0,1]
    v_pk_mul_f32 v[80:81], v[156:157], v[92:93] op_sel_hi:[0,1]
    v_cvt_pk_bf16_f32 v60, v56, v57
    v_pk_fma_f32 v[78:79], v[154:155], v[90:91], v[78:79] op_sel:[1,1,0] op_sel_hi:[1,0,1] neg_lo:[1,0,0]
    v_pk_fma_f32 v[80:81], v[156:157], v[92:93], v[80:81] op_sel:[1,1,0] op_sel_hi:[1,0,1] neg_lo:[1,0,0]
    v_cvt_pk_bf16_f32 v61, v58, v59
    v_pk_mul_f32 v[106:107], v[98:99], v[90:91] op_sel_hi:[0,1]
    v_pk_mul_f32 v[108:109], v[100:101], v[92:93] op_sel_hi:[0,1]
    v_pk_fma_f32 v[106:107], v[98:99], v[90:91], v[106:107] op_sel:[1,1,0] op_sel_hi:[1,0,1] neg_lo:[1,0,0]
    v_pk_fma_f32 v[108:109], v[100:101], v[92:93], v[108:109] op_sel:[1,1,0] op_sel_hi:[1,0,1] neg_lo:[1,0,0]
    v_pk_mul_f32 v[118:119], v[142:143], v[90:91] op_sel_hi:[0,1]
    v_pk_mul_f32 v[120:121], v[144:145], v[92:93] op_sel_hi:[0,1]
    v_mul_f32 v158, v86, v90
    v_pk_fma_f32 v[118:119], v[142:143], v[90:91], v[118:119] op_sel:[1,1,0] op_sel_hi:[1,0,1] neg_lo:[1,0,0]
    v_pk_fma_f32 v[120:121], v[144:145], v[92:93], v[120:121] op_sel:[1,1,0] op_sel_hi:[1,0,1] neg_lo:[1,0,0]
    v_pk_mul_f32 v[150:151], v[110:111], v[90:91] op_sel_hi:[0,1]
    v_pk_mul_f32 v[152:153], v[112:113], v[92:93] op_sel_hi:[0,1]
    v_mul_f32 v159, v88, v92
    buffer_load_dwordx4 v243, s[8:11], s66 offen offset:1024 lds
    v_pk_fma_f32 v[150:151], v[110:111], v[90:91], v[150:151] op_sel:[1,1,0] op_sel_hi:[1,0,1] neg_lo:[1,0,0]
    v_pk_fma_f32 v[152:153], v[112:113], v[92:93], v[152:153] op_sel:[1,1,0] op_sel_hi:[1,0,1] neg_lo:[1,0,0]
    v_pk_mul_f32 v[138:139], v[78:79], v[90:91] op_sel_hi:[0,1]
    v_pk_mul_f32 v[140:141], v[80:81], v[92:93] op_sel_hi:[0,1]
    v_fma_f32 v158, -v87, v91, v158
    v_pk_fma_f32 v[138:139], v[78:79], v[90:91], v[138:139] op_sel:[1,1,0] op_sel_hi:[1,0,1] neg_lo:[1,0,0]
    v_pk_fma_f32 v[140:141], v[80:81], v[92:93], v[140:141] op_sel:[1,1,0] op_sel_hi:[1,0,1] neg_lo:[1,0,0]
    v_fma_f32 v159, -v89, v93, v159
    v_pk_mul_f32 v[146:147], v[106:107], v[90:91] op_sel_hi:[0,1]
    v_pk_mul_f32 v[148:149], v[108:109], v[92:93] op_sel_hi:[0,1]
    v_pk_fma_f32 v[146:147], v[106:107], v[90:91], v[146:147] op_sel:[1,1,0] op_sel_hi:[1,0,1] neg_lo:[1,0,0]
    v_pk_fma_f32 v[148:149], v[108:109], v[92:93], v[148:149] op_sel:[1,1,0] op_sel_hi:[1,0,1] neg_lo:[1,0,0]
    v_add_f32 v158, v158, v159
    v_pk_mul_f32 v[94:95], v[118:119], v[90:91] op_sel_hi:[0,1]
    v_pk_mul_f32 v[96:97], v[120:121], v[92:93] op_sel_hi:[0,1]
    v_pk_fma_f32 v[94:95], v[118:119], v[90:91], v[94:95] op_sel:[1,1,0] op_sel_hi:[1,0,1] neg_lo:[1,0,0]
    v_pk_fma_f32 v[96:97], v[120:121], v[92:93], v[96:97] op_sel:[1,1,0] op_sel_hi:[1,0,1] neg_lo:[1,0,0]
    v_add_f32_dpp v158, v158, v158 row_shr:1 row_mask:0xf bank_mask:0xf bound_ctrl:0
    v_pk_mul_f32 v[82:83], v[150:151], v[90:91] op_sel_hi:[0,1]
    v_pk_mul_f32 v[84:85], v[152:153], v[92:93] op_sel_hi:[0,1]
    buffer_load_dwordx4 v244, s[8:11], s66 offen offset:2048 lds
    v_add_f32_dpp v158, v158, v158 row_shr:2 row_mask:0xf bank_mask:0xf bound_ctrl:0
    v_pk_fma_f32 v[82:83], v[150:151], v[90:91], v[82:83] op_sel:[1,1,0] op_sel_hi:[1,0,1] neg_lo:[1,0,0]
    v_pk_fma_f32 v[84:85], v[152:153], v[92:93], v[84:85] op_sel:[1,1,0] op_sel_hi:[1,0,1] neg_lo:[1,0,0]
    v_pk_mul_f32 v[130:131], v[70:71], v[114:115] op_sel_hi:[0,1]
    v_pk_mul_f32 v[132:133], v[72:73], v[116:117] op_sel_hi:[0,1]
    v_add_f32_dpp v158, v158, v158 row_shr:4 row_mask:0xf bank_mask:0xf bound_ctrl:0
    v_pk_fma_f32 v[130:131], v[70:71], v[114:115], v[130:131] op_sel:[1,1,0] op_sel_hi:[1,0,1] neg_lo:[1,0,0]
    v_pk_fma_f32 v[132:133], v[72:73], v[116:117], v[132:133] op_sel:[1,1,0] op_sel_hi:[1,0,1] neg_lo:[1,0,0]
    v_pk_mul_f32 v[74:75], v[126:127], v[114:115] op_sel_hi:[0,1]
    v_pk_mul_f32 v[76:77], v[128:129], v[116:117] op_sel_hi:[0,1]
    v_add_f32_dpp v158, v158, v158 row_shr:8 row_mask:0xf bank_mask:0xf bound_ctrl:0
    v_pk_fma_f32 v[74:75], v[126:127], v[114:115], v[74:75] op_sel:[1,1,0] op_sel_hi:[1,0,1] neg_lo:[1,0,0]
    v_pk_fma_f32 v[76:77], v[128:129], v[116:117], v[76:77] op_sel:[1,1,0] op_sel_hi:[1,0,1] neg_lo:[1,0,0]
    v_add_f32_dpp v158, v158, v158 row_bcast:15 row_mask:0xa bank_mask:0xf
    v_pk_mul_f32 v[154:155], v[134:135], v[114:115] op_sel_hi:[0,1]
    v_pk_mul_f32 v[156:157], v[136:137], v[116:117] op_sel_hi:[0,1]
    v_pk_fma_f32 v[154:155], v[134:135], v[114:115], v[154:155] op_sel:[1,1,0] op_sel_hi:[1,0,1] neg_lo:[1,0,0]
    v_pk_fma_f32 v[156:157], v[136:137], v[116:117], v[156:157] op_sel:[1,1,0] op_sel_hi:[1,0,1] neg_lo:[1,0,0]
    v_add_f32_dpp v158, v158, v158 row_bcast:31 row_mask:0xc bank_mask:0xf
    v_pk_mul_f32 v[98:99], v[86:87], v[114:115] op_sel_hi:[0,1]
    buffer_load_dwordx4 v245, s[8:11], s66 offen offset:3072 lds
    v_pk_mul_f32 v[100:101], v[88:89], v[116:117] op_sel_hi:[0,1]
    v_pk_fma_f32 v[98:99], v[86:87], v[114:115], v[98:99] op_sel:[1,1,0] op_sel_hi:[1,0,1] neg_lo:[1,0,0]
    v_pk_fma_f32 v[100:101], v[88:89], v[116:117], v[100:101] op_sel:[1,1,0] op_sel_hi:[1,0,1] neg_lo:[1,0,0]
    s_waitcnt lgkmcnt(0)
    v_cvt_pk_bf16_f32 v36, v122, v78
    v_cvt_pk_bf16_f32 v37, v106, v130
    v_cvt_pk_bf16_f32 v38, v106, v118
    v_cvt_pk_bf16_f32 v39, v150, v74
    v_mfma_f32_16x16x32_bf16 v[52:55], v[160:163], a[224:227], 0
    v_cvt_pk_bf16_f32 v40, v123, v79
    v_cvt_pk_bf16_f32 v41, v107, v131
    v_cvt_pk_bf16_f32 v42, v107, v119
    v_cvt_pk_bf16_f32 v43, v151, v75
    v_mfma_f32_16x16x32_bf16 v[52:55], v[164:167], a[228:231], v[52:55]
    ds_write_b128 v16, v[36:39] offset:0
    v_cvt_pk_bf16_f32 v44, v124, v80
    v_cvt_pk_bf16_f32 v45, v108, v132
    v_cvt_pk_bf16_f32 v46, v108, v120
    v_cvt_pk_bf16_f32 v47, v152, v76
    v_mfma_f32_16x16x32_bf16 v[52:55], v[168:171], a[232:235], v[52:55]
    s_add_u32 m0, s70, 4096
    s_add_u32 s66, s69, s97
    s_add_u32 s66, s66, 256
    buffer_load_dwordx4 v242, s[8:11], s66 offen offset:0 lds
    ds_write_b128 v16, v[40:43] offset:32
    v_cvt_pk_bf16_f32 v48, v125, v81
    v_cvt_pk_bf16_f32 v49, v109, v133
    v_cvt_pk_bf16_f32 v50, v109, v121
    v_cvt_pk_bf16_f32 v51, v153, v77
    v_mfma_f32_16x16x32_bf16 v[52:55], v[172:175], a[236:239], v[52:55]
    ds_write_b128 v16, v[44:47] offset:64
    v_cvt_pk_bf16_f32 v36, v102, v138
    v_cvt_pk_bf16_f32 v37, v146, v154
    v_cvt_pk_bf16_f32 v38, v146, v94
    v_cvt_pk_bf16_f32 v39, v82, v98
    v_mfma_f32_16x16x32_bf16 v[52:55], v[176:179], a[240:243], v[52:55]
    ds_write_b128 v16, v[48:51] offset:96
    v_cvt_pk_bf16_f32 v40, v103, v139
    v_cvt_pk_bf16_f32 v41, v147, v155
    v_cvt_pk_bf16_f32 v42, v147, v95
    v_cvt_pk_bf16_f32 v43, v83, v99
    v_mfma_f32_16x16x32_bf16 v[52:55], v[180:183], a[244:247], v[52:55]
    ds_write_b128 v16, v[36:39] offset:16
    v_cvt_pk_bf16_f32 v44, v104, v140
    buffer_load_dwordx4 v243, s[8:11], s66 offen offset:1024 lds
    v_cvt_pk_bf16_f32 v45, v148, v156
    v_cvt_pk_bf16_f32 v46, v148, v96
    v_cvt_pk_bf16_f32 v47, v84, v100
    v_mfma_f32_16x16x32_bf16 v[52:55], v[184:187], a[248:251], v[52:55]
    ds_write_b128 v16, v[40:43] offset:48
    v_cvt_pk_bf16_f32 v48, v105, v141
    v_cvt_pk_bf16_f32 v49, v149, v157
    v_cvt_pk_bf16_f32 v50, v149, v97
    v_cvt_pk_bf16_f32 v51, v85, v101
    v_mfma_f32_16x16x32_bf16 v[52:55], v[188:191], a[252:255], v[52:55]
    ds_write_b128 v16, v[44:47] offset:80
    ds_write_b128 v16, v[48:51] offset:112
    ds_read_b64_tr_b16 v[192:193], v17 offset:0
    ds_read_b64_tr_b16 v[194:195], v17 offset:288
    ds_read_b64_tr_b16 v[196:197], v17 offset:576
    ds_read_b64_tr_b16 v[198:199], v17 offset:864
    ds_read_b64_tr_b16 v[200:201], v17 offset:2304
    ds_read_b64_tr_b16 v[202:203], v17 offset:2592
    ds_read_b64_tr_b16 v[204:205], v17 offset:2880
    ds_read_b64_tr_b16 v[206:207], v17 offset:3168
    buffer_load_dwordx4 v244, s[8:11], s66 offen offset:2048 lds
    ds_read_b64_tr_b16 v[208:209], v17 offset:4608
    ds_read_b64_tr_b16 v[210:211], v17 offset:4896
    ds_read_b64_tr_b16 v[212:213], v17 offset:5184
    ds_read_b64_tr_b16 v[214:215], v17 offset:5472
    ds_read_b64_tr_b16 v[216:217], v17 offset:6912
    ds_read_b64_tr_b16 v[218:219], v17 offset:7200
    ds_read_b64_tr_b16 v[220:221], v17 offset:7488
    ds_read_b64_tr_b16 v[222:223], v17 offset:7776
    v_cvt_pk_bf16_f32 v62, v52, v52
    v_cvt_pk_bf16_f32 v63, v53, v54
    v_mov_b32_dpp v158, v55 wave_shl:1 row_mask:0xf bank_mask:0xf
    v_cvt_pk_bf16_f32 v24, v55, v55
    v_cvt_pk_bf16_f32 v25, v55, v55
    v_cvt_pk_bf16_f32 v30, v158, v158
    v_cvt_pk_bf16_f32 v31, v158, v158
    s_waitcnt lgkmcnt(14)
    v_mfma_f32_16x16x32_bf16 v[56:59], v[192:195], a[224:227], 0
    s_waitcnt lgkmcnt(12)
    v_mfma_f32_16x16x32_bf16 v[56:59], v[196:199], a[228:231], v[56:59]
    s_waitcnt lgkmcnt(10)
    buffer_load_dwordx4 v245, s[8:11], s66 offen offset:3072 lds
    v_mfma_f32_16x16x32_bf16 v[56:59], v[200:203], a[232:235], v[56:59]
    s_waitcnt lgkmcnt(8)
    v_mfma_f32_16x16x32_bf16 v[56:59], v[204:207], a[236:239], v[56:59]
    s_waitcnt lgkmcnt(6)
    v_mfma_f32_16x16x32_bf16 v[56:59], v[208:211], a[240:243], v[56:59]
    s_waitcnt lgkmcnt(4)
    v_mfma_f32_16x16x32_bf16 v[56:59], v[212:215], a[244:247], v[56:59]
    s_waitcnt lgkmcnt(2)
    v_mfma_f32_16x16x32_bf16 v[56:59], v[216:219], a[248:251], v[56:59]
    s_waitcnt lgkmcnt(0)
    v_mfma_f32_16x16x32_bf16 v[56:59], v[220:223], a[252:255], v[56:59]
    s_nop 7
    v_cvt_pk_bf16_f32 v26, v55, v59
    v_cvt_pk_bf16_f32 v27, v59, v59
    v_cvt_pk_bf16_f32 v28, v59, v59
    v_cvt_pk_bf16_f32 v29, v59, v59
    v_cvt_pk_bf16_f32 v64, v56, v56
    v_cvt_pk_bf16_f32 v65, v56, v57
    v_cvt_pk_bf16_f32 v66, v57, v57
    v_cvt_pk_bf16_f32 v67, v58, v58
    buffer_store_dwordx2 v[60:61], v18, s[36:39], s72 offen
    buffer_store_dwordx2 v[62:63], v18, s[36:39], s72 offen offset:512
    buffer_store_dwordx4 v[24:27], v20, s[36:39], s72 offen offset:2048
    buffer_store_dwordx4 v[28:31], v20, s[36:39], s72 offen offset:2064
    buffer_store_dwordx4 v[64:67], v19, s[36:39], s72 offen offset:1024
    s_waitcnt lgkmcnt(0)
    s_branch gated_mix__ssm_conv_s4__glu_gated_bilinear__prompt_kernel_join
gated_mix__ssm_conv_s4__glu_gated_bilinear__prompt_kernel_w3:
    v_lshrrev_b32 v4, 4, v252
    v_mul_u32_u24 v4, 1152, v4
    v_and_b32 v6, 7, v252
    v_lshlrev_b32 v6, 4, v6
    v_and_b32 v5, 15, v252
    v_lshl_add_u32 v4, v5, 4, v4
    v_lshrrev_b32 v17, 1, v252
    v_mul_u32_u24 v17, 1152, v17
    v_and_b32 v5, 1, v252
    v_lshl_add_u32 v17, v5, 4, v17
    v_lshrrev_b32 v5, 3, v252
    v_mul_u32_u24 v5, 1152, v5
    v_add_u32 v5, v5, v6
    s_and_b32 s74, s2, 1
    s_lshl_b32 s74, s74, 5
    s_add_u32 s74, s74, s13
    s_mul_i32 s78, s74, 36864
    s_lshl_b32 s60, s16, 8
    s_add_u32 s60, s60, s78
    s_mul_i32 s72, s16, 9216
    s_add_u32 s72, s72, s78
    s_mov_b32 m0, 94208
    s_nop 0
    buffer_load_dwordx4 v4, s[8:11], s60 offen lds
    s_mov_b32 m0, 95232
    s_add_u32 s60, s60, 4608
    buffer_load_dwordx4 v4, s[8:11], s60 offen lds
    s_mov_b32 m0, 96256
    s_add_u32 s60, s60, 4608
    buffer_load_dwordx4 v4, s[8:11], s60 offen lds
    s_mov_b32 m0, 97280
    s_add_u32 s60, s60, 4608
    buffer_load_dwordx4 v4, s[8:11], s60 offen lds
    s_mov_b32 m0, 98304
    s_add_u32 s60, s60, 4608
    buffer_load_dwordx4 v4, s[8:11], s60 offen lds
    s_mov_b32 m0, 99328
    s_add_u32 s60, s60, 4608
    buffer_load_dwordx4 v4, s[8:11], s60 offen lds
    s_mov_b32 m0, 100352
    s_add_u32 s60, s60, 4608
    buffer_load_dwordx4 v4, s[8:11], s60 offen lds
    s_mov_b32 m0, 101376
    s_add_u32 s60, s60, 4608
    buffer_load_dwordx4 v4, s[8:11], s60 offen lds
    s_mov_b32 m0, 102400
    s_lshl_b32 s60, s16, 5
    s_add_u32 s60, s60, s78
    buffer_load_dwordx4 v17, s[8:11], s60 offen offset:1024 lds
    buffer_load_dwordx4 v[48:51], v5, s[8:11], s72 offen offset:0
    buffer_load_dwordx4 v[52:55], v5, s[8:11], s72 offen offset:128
    buffer_load_dwordx4 v[56:59], v5, s[8:11], s72 offen offset:256
    buffer_load_dwordx4 v[60:63], v5, s[8:11], s72 offen offset:384
    buffer_load_dwordx4 v[64:67], v5, s[8:11], s72 offen offset:512
    buffer_load_dwordx4 v[68:71], v5, s[8:11], s72 offen offset:640
    buffer_load_dwordx4 v[72:75], v5, s[8:11], s72 offen offset:768
    buffer_load_dwordx4 v[76:79], v5, s[8:11], s72 offen offset:896
    buffer_load_dwordx4 v[80:83], v5, s[8:11], s72 offen offset:1024
    global_load_dwordx4 v[84:87], v6, s[64:65] offset:0
    global_load_dwordx4 v[88:91], v6, s[64:65] offset:128
    global_load_dwordx4 v[92:95], v6, s[64:65] offset:256
    global_load_dwordx4 v[96:99], v6, s[64:65] offset:384
    global_load_dwordx4 v[100:103], v6, s[64:65] offset:512
    global_load_dwordx4 v[104:107], v6, s[64:65] offset:640
    global_load_dwordx4 v[108:111], v6, s[64:65] offset:768
    global_load_dwordx4 v[112:115], v6, s[64:65] offset:896
    global_load_dwordx4 v[116:119], v6, s[64:65] offset:1024
    v_lshrrev_b32 v2, 4, v252
    v_and_b32 v3, 15, v252
    v_and_b32 v5, 3, v252
    v_lshlrev_b32 v7, 3, v5
    v_bfe_u32 v5, v252, 2, 2
    v_lshl_add_u32 v4, v2, 11, v7
    v_lshl_add_u32 v4, v5, 8, v4
    v_add_u32 v4, 94208, v4
    v_lshl_add_u32 v7, v2, 8, v7
    v_lshl_add_u32 v7, v5, 5, v7
    v_add_u32 v7, 103424, v7
    v_lshlrev_b32 v2, 4, v2
    v_lshl_add_u32 v3, v3, 12, v2
    s_lshl_b32 s71, s16, 19
    s_lshl_b32 s72, s74, 6
    s_add_u32 s71, s71, s72
    s_add_u32 s71, s71, 20971520
    s_lshl_b32 s60, s16, 16
    s_add_u32 s60, s60, s72
    s_add_u32 s60, s60, 23068672
    s_add_u32 m0, s51, 114688
    s_add_u32 s66, s48, s94
    buffer_load_dwordx4 v248, s[20:23], s66 offen lds
    buffer_load_dwordx4 v248, s[24:27], s66 offen offset:1024 lds
    s_add_u32 m0, s51, 122880
    s_add_u32 s66, s66, 294912
    buffer_load_dwordx4 v248, s[20:23], s66 offen lds
    buffer_load_dwordx4 v248, s[24:27], s66 offen offset:1024 lds
    s_add_u32 m0, s51, 131072
    s_add_u32 s66, s66, 294912
    buffer_load_dwordx4 v248, s[20:23], s66 offen lds
    buffer_load_dwordx4 v248, s[24:27], s66 offen offset:1024 lds
    s_waitcnt vmcnt(24)
    s_waitcnt lgkmcnt(0)
    v_mov_b32 v10, 1
    s_mov_b32 s44, s58
    s_mov_b32 s45, s59
    s_mov_b32 s46, 256
    s_mov_b32 s47, 0x20000
    buffer_store_byte v10, off, s[44:47], s80 sc1
    ds_read_b64_tr_b16 v[12:13], v4 offset:0
    ds_read_b64_tr_b16 v[14:15], v4 offset:1024
    ds_read_b64_tr_b16 v[16:17], v4 offset:32
    ds_read_b64_tr_b16 v[18:19], v4 offset:1056
    ds_read_b64_tr_b16 v[20:21], v4 offset:64
    ds_read_b64_tr_b16 v[22:23], v4 offset:1088
    ds_read_b64_tr_b16 v[24:25], v4 offset:96
    ds_read_b64_tr_b16 v[26:27], v4 offset:1120
    ds_read_b64_tr_b16 v[28:29], v4 offset:128
    ds_read_b64_tr_b16 v[30:31], v4 offset:1152
    ds_read_b64_tr_b16 v[32:33], v4 offset:160
    ds_read_b64_tr_b16 v[34:35], v4 offset:1184
    ds_read_b64_tr_b16 v[36:37], v4 offset:192
    ds_read_b64_tr_b16 v[38:39], v4 offset:1216
    ds_read_b64_tr_b16 v[40:41], v4 offset:224
    ds_read_b64_tr_b16 v[42:43], v4 offset:1248
    ds_read_b64_tr_b16 v[44:45], v7 offset:0
    ds_read_b64_tr_b16 v[46:47], v7 offset:128
    s_waitcnt lgkmcnt(15)
    buffer_store_dwordx4 v[12:15], v3, s[36:39], s71 offen sc1
    s_add_u32 s71, s71, 65536
    s_waitcnt lgkmcnt(14)
    buffer_store_dwordx4 v[16:19], v3, s[36:39], s71 offen sc1
    s_add_u32 s71, s71, 65536
    s_waitcnt lgkmcnt(12)
    buffer_store_dwordx4 v[20:23], v3, s[36:39], s71 offen sc1
    s_add_u32 s71, s71, 65536
    s_waitcnt lgkmcnt(10)
    buffer_store_dwordx4 v[24:27], v3, s[36:39], s71 offen sc1
    s_add_u32 s71, s71, 65536
    s_waitcnt lgkmcnt(8)
    buffer_store_dwordx4 v[28:31], v3, s[36:39], s71 offen sc1
    s_add_u32 s71, s71, 65536
    s_waitcnt lgkmcnt(6)
    buffer_store_dwordx4 v[32:35], v3, s[36:39], s71 offen sc1
    s_add_u32 s71, s71, 65536
    s_waitcnt lgkmcnt(4)
    buffer_store_dwordx4 v[36:39], v3, s[36:39], s71 offen sc1
    s_add_u32 s71, s71, 65536
    s_waitcnt lgkmcnt(2)
    buffer_store_dwordx4 v[40:43], v3, s[36:39], s71 offen sc1
    s_waitcnt lgkmcnt(0)
    buffer_store_dwordx4 v[44:47], v3, s[36:39], s60 offen sc1
    s_waitcnt vmcnt(16)
    v_mov_b32 v128, 0
    s_add_u32 m0, s70, 32768
    s_add_u32 s66, s68, s97
    s_add_u32 s66, s66, 128
    buffer_load_dwordx4 v242, s[8:11], s66 offen offset:0 lds
    v_mov_b32 v129, 0
    v_lshlrev_b32 v120, 16, v48
    v_and_b32 v121, s31, v48
    v_lshlrev_b32 v122, 16, v84
    v_and_b32 v123, s31, v84
    v_pk_mul_f32 v[120:121], v[120:121], v[122:123]
    v_cvt_pk_bf16_f32 v120, v120, v121
    v_dot2_f32_bf16 v128, v120, s30, v128
    v_lshlrev_b32 v124, 16, v49
    v_and_b32 v125, s31, v49
    v_lshlrev_b32 v126, 16, v85
    v_and_b32 v127, s31, v85
    v_pk_mul_f32 v[124:125], v[124:125], v[126:127]
    v_cvt_pk_bf16_f32 v124, v124, v125
    buffer_load_dwordx4 v243, s[8:11], s66 offen offset:1024 lds
    v_dot2_f32_bf16 v129, v124, s30, v129
    v_lshlrev_b32 v120, 16, v50
    v_and_b32 v121, s31, v50
    v_lshlrev_b32 v122, 16, v86
    v_and_b32 v123, s31, v86
    v_pk_mul_f32 v[120:121], v[120:121], v[122:123]
    v_cvt_pk_bf16_f32 v120, v120, v121
    v_dot2_f32_bf16 v128, v120, s30, v128
    v_lshlrev_b32 v124, 16, v51
    v_and_b32 v125, s31, v51
    v_lshlrev_b32 v126, 16, v87
    v_and_b32 v127, s31, v87
    v_pk_mul_f32 v[124:125], v[124:125], v[126:127]
    v_cvt_pk_bf16_f32 v124, v124, v125
    buffer_load_dwordx4 v244, s[8:11], s66 offen offset:2048 lds
    v_dot2_f32_bf16 v129, v124, s30, v129
    v_lshlrev_b32 v120, 16, v52
    v_and_b32 v121, s31, v52
    v_lshlrev_b32 v122, 16, v88
    v_and_b32 v123, s31, v88
    v_pk_mul_f32 v[120:121], v[120:121], v[122:123]
    v_cvt_pk_bf16_f32 v120, v120, v121
    v_dot2_f32_bf16 v128, v120, s30, v128
    v_lshlrev_b32 v124, 16, v53
    v_and_b32 v125, s31, v53
    v_lshlrev_b32 v126, 16, v89
    v_and_b32 v127, s31, v89
    v_pk_mul_f32 v[124:125], v[124:125], v[126:127]
    v_cvt_pk_bf16_f32 v124, v124, v125
    buffer_load_dwordx4 v245, s[8:11], s66 offen offset:3072 lds
    v_dot2_f32_bf16 v129, v124, s30, v129
    v_lshlrev_b32 v120, 16, v54
    v_and_b32 v121, s31, v54
    v_lshlrev_b32 v122, 16, v90
    v_and_b32 v123, s31, v90
    v_pk_mul_f32 v[120:121], v[120:121], v[122:123]
    v_cvt_pk_bf16_f32 v120, v120, v121
    v_dot2_f32_bf16 v128, v120, s30, v128
    v_lshlrev_b32 v124, 16, v55
    v_and_b32 v125, s31, v55
    v_lshlrev_b32 v126, 16, v91
    v_and_b32 v127, s31, v91
    v_pk_mul_f32 v[124:125], v[124:125], v[126:127]
    v_cvt_pk_bf16_f32 v124, v124, v125
    s_add_u32 m0, s70, 36864
    s_add_u32 s66, s69, s97
    s_add_u32 s66, s66, 128
    buffer_load_dwordx4 v242, s[8:11], s66 offen offset:0 lds
    v_dot2_f32_bf16 v129, v124, s30, v129
    v_lshlrev_b32 v120, 16, v56
    v_and_b32 v121, s31, v56
    v_lshlrev_b32 v122, 16, v92
    v_and_b32 v123, s31, v92
    v_pk_mul_f32 v[120:121], v[120:121], v[122:123]
    v_cvt_pk_bf16_f32 v120, v120, v121
    v_dot2_f32_bf16 v128, v120, s30, v128
    v_lshlrev_b32 v124, 16, v57
    v_and_b32 v125, s31, v57
    v_lshlrev_b32 v126, 16, v93
    v_and_b32 v127, s31, v93
    v_pk_mul_f32 v[124:125], v[124:125], v[126:127]
    v_cvt_pk_bf16_f32 v124, v124, v125
    buffer_load_dwordx4 v243, s[8:11], s66 offen offset:1024 lds
    v_dot2_f32_bf16 v129, v124, s30, v129
    v_lshlrev_b32 v120, 16, v58
    v_and_b32 v121, s31, v58
    v_lshlrev_b32 v122, 16, v94
    v_and_b32 v123, s31, v94
    v_pk_mul_f32 v[120:121], v[120:121], v[122:123]
    v_cvt_pk_bf16_f32 v120, v120, v121
    v_dot2_f32_bf16 v128, v120, s30, v128
    v_lshlrev_b32 v124, 16, v59
    v_and_b32 v125, s31, v59
    v_lshlrev_b32 v126, 16, v95
    v_and_b32 v127, s31, v95
    v_pk_mul_f32 v[124:125], v[124:125], v[126:127]
    v_cvt_pk_bf16_f32 v124, v124, v125
    buffer_load_dwordx4 v244, s[8:11], s66 offen offset:2048 lds
    v_dot2_f32_bf16 v129, v124, s30, v129
    v_lshlrev_b32 v120, 16, v60
    v_and_b32 v121, s31, v60
    v_lshlrev_b32 v122, 16, v96
    v_and_b32 v123, s31, v96
    v_pk_mul_f32 v[120:121], v[120:121], v[122:123]
    v_cvt_pk_bf16_f32 v120, v120, v121
    v_dot2_f32_bf16 v128, v120, s30, v128
    v_lshlrev_b32 v124, 16, v61
    v_and_b32 v125, s31, v61
    v_lshlrev_b32 v126, 16, v97
    v_and_b32 v127, s31, v97
    v_pk_mul_f32 v[124:125], v[124:125], v[126:127]
    v_cvt_pk_bf16_f32 v124, v124, v125
    buffer_load_dwordx4 v245, s[8:11], s66 offen offset:3072 lds
    v_dot2_f32_bf16 v129, v124, s30, v129
    v_lshlrev_b32 v120, 16, v62
    v_and_b32 v121, s31, v62
    v_lshlrev_b32 v122, 16, v98
    v_and_b32 v123, s31, v98
    v_pk_mul_f32 v[120:121], v[120:121], v[122:123]
    v_cvt_pk_bf16_f32 v120, v120, v121
    v_dot2_f32_bf16 v128, v120, s30, v128
    v_lshlrev_b32 v124, 16, v63
    v_and_b32 v125, s31, v63
    v_lshlrev_b32 v126, 16, v99
    v_and_b32 v127, s31, v99
    v_pk_mul_f32 v[124:125], v[124:125], v[126:127]
    v_cvt_pk_bf16_f32 v124, v124, v125
    s_add_u32 m0, s51, 139264
    s_add_u32 s66, s48, s94
    s_add_u32 s66, s66, 884736
    buffer_load_dwordx4 v248, s[20:23], s66 offen lds
    v_dot2_f32_bf16 v129, v124, s30, v129
    v_lshlrev_b32 v120, 16, v64
    v_and_b32 v121, s31, v64
    v_lshlrev_b32 v122, 16, v100
    v_and_b32 v123, s31, v100
    v_pk_mul_f32 v[120:121], v[120:121], v[122:123]
    v_cvt_pk_bf16_f32 v120, v120, v121
    v_dot2_f32_bf16 v128, v120, s30, v128
    v_lshlrev_b32 v124, 16, v65
    v_and_b32 v125, s31, v65
    v_lshlrev_b32 v126, 16, v101
    v_and_b32 v127, s31, v101
    v_pk_mul_f32 v[124:125], v[124:125], v[126:127]
    v_cvt_pk_bf16_f32 v124, v124, v125
    buffer_load_dwordx4 v248, s[24:27], s66 offen offset:1024 lds
    v_dot2_f32_bf16 v129, v124, s30, v129
    v_lshlrev_b32 v120, 16, v66
    v_and_b32 v121, s31, v66
    v_lshlrev_b32 v122, 16, v102
    v_and_b32 v123, s31, v102
    v_pk_mul_f32 v[120:121], v[120:121], v[122:123]
    v_cvt_pk_bf16_f32 v120, v120, v121
    v_dot2_f32_bf16 v128, v120, s30, v128
    v_lshlrev_b32 v124, 16, v67
    v_and_b32 v125, s31, v67
    v_lshlrev_b32 v126, 16, v103
    v_and_b32 v127, s31, v103
    v_pk_mul_f32 v[124:125], v[124:125], v[126:127]
    v_cvt_pk_bf16_f32 v124, v124, v125
    s_add_u32 m0, s51, 147456
    s_add_u32 s66, s66, 294912
    buffer_load_dwordx4 v248, s[20:23], s66 offen lds
    v_dot2_f32_bf16 v129, v124, s30, v129
    v_lshlrev_b32 v120, 16, v68
    v_and_b32 v121, s31, v68
    v_lshlrev_b32 v122, 16, v104
    v_and_b32 v123, s31, v104
    v_pk_mul_f32 v[120:121], v[120:121], v[122:123]
    v_cvt_pk_bf16_f32 v120, v120, v121
    v_dot2_f32_bf16 v128, v120, s30, v128
    v_lshlrev_b32 v124, 16, v69
    v_and_b32 v125, s31, v69
    v_lshlrev_b32 v126, 16, v105
    v_and_b32 v127, s31, v105
    v_pk_mul_f32 v[124:125], v[124:125], v[126:127]
    v_cvt_pk_bf16_f32 v124, v124, v125
    buffer_load_dwordx4 v248, s[24:27], s66 offen offset:1024 lds
    v_dot2_f32_bf16 v129, v124, s30, v129
    v_lshlrev_b32 v120, 16, v70
    v_and_b32 v121, s31, v70
    v_lshlrev_b32 v122, 16, v106
    v_and_b32 v123, s31, v106
    v_pk_mul_f32 v[120:121], v[120:121], v[122:123]
    v_cvt_pk_bf16_f32 v120, v120, v121
    v_dot2_f32_bf16 v128, v120, s30, v128
    v_lshlrev_b32 v124, 16, v71
    v_and_b32 v125, s31, v71
    v_lshlrev_b32 v126, 16, v107
    v_and_b32 v127, s31, v107
    v_pk_mul_f32 v[124:125], v[124:125], v[126:127]
    v_cvt_pk_bf16_f32 v124, v124, v125
    s_add_u32 m0, s51, 155648
    s_add_u32 s66, s66, 294912
    buffer_load_dwordx4 v248, s[20:23], s66 offen lds
    v_dot2_f32_bf16 v129, v124, s30, v129
    v_lshlrev_b32 v120, 16, v72
    v_and_b32 v121, s31, v72
    v_lshlrev_b32 v122, 16, v108
    v_and_b32 v123, s31, v108
    v_pk_mul_f32 v[120:121], v[120:121], v[122:123]
    v_cvt_pk_bf16_f32 v120, v120, v121
    v_dot2_f32_bf16 v128, v120, s30, v128
    v_lshlrev_b32 v124, 16, v73
    v_and_b32 v125, s31, v73
    v_lshlrev_b32 v126, 16, v109
    v_and_b32 v127, s31, v109
    v_pk_mul_f32 v[124:125], v[124:125], v[126:127]
    v_cvt_pk_bf16_f32 v124, v124, v125
    buffer_load_dwordx4 v248, s[24:27], s66 offen offset:1024 lds
    v_dot2_f32_bf16 v129, v124, s30, v129
    v_lshlrev_b32 v120, 16, v74
    v_and_b32 v121, s31, v74
    v_lshlrev_b32 v122, 16, v110
    v_and_b32 v123, s31, v110
    v_pk_mul_f32 v[120:121], v[120:121], v[122:123]
    v_cvt_pk_bf16_f32 v120, v120, v121
    v_dot2_f32_bf16 v128, v120, s30, v128
    v_lshlrev_b32 v124, 16, v75
    v_and_b32 v125, s31, v75
    v_lshlrev_b32 v126, 16, v111
    v_and_b32 v127, s31, v111
    v_pk_mul_f32 v[124:125], v[124:125], v[126:127]
    v_cvt_pk_bf16_f32 v124, v124, v125
    buffer_load_dword v241, v237, s[40:43], 0 offen
    v_dot2_f32_bf16 v129, v124, s30, v129
    v_lshlrev_b32 v120, 16, v76
    v_and_b32 v121, s31, v76
    v_lshlrev_b32 v122, 16, v112
    v_and_b32 v123, s31, v112
    v_pk_mul_f32 v[120:121], v[120:121], v[122:123]
    v_cvt_pk_bf16_f32 v120, v120, v121
    v_dot2_f32_bf16 v128, v120, s30, v128
    v_lshlrev_b32 v124, 16, v77
    v_and_b32 v125, s31, v77
    v_lshlrev_b32 v126, 16, v113
    v_and_b32 v127, s31, v113
    v_pk_mul_f32 v[124:125], v[124:125], v[126:127]
    v_cvt_pk_bf16_f32 v124, v124, v125
    ds_read_b128 a[0:3], v246 offset:0
    v_dot2_f32_bf16 v129, v124, s30, v129
    v_lshlrev_b32 v120, 16, v78
    ds_read_b128 a[4:7], v246 offset:2048
    v_and_b32 v121, s31, v78
    v_lshlrev_b32 v122, 16, v114
    ds_read_b128 a[8:11], v246 offset:4096
    v_and_b32 v123, s31, v114
    v_pk_mul_f32 v[120:121], v[120:121], v[122:123]
    ds_read_b128 a[12:15], v246 offset:6144
    v_cvt_pk_bf16_f32 v120, v120, v121
    v_dot2_f32_bf16 v128, v120, s30, v128
    ds_read_b128 a[16:19], v247 offset:0
    v_lshlrev_b32 v124, 16, v79
    v_and_b32 v125, s31, v79
    ds_read_b128 a[20:23], v247 offset:2048
    v_lshlrev_b32 v126, 16, v115
    v_and_b32 v127, s31, v115
    ds_read_b128 a[24:27], v247 offset:4096
    v_pk_mul_f32 v[124:125], v[124:125], v[126:127]
    v_cvt_pk_bf16_f32 v124, v124, v125
    ds_read_b128 a[28:31], v247 offset:6144
    v_dot2_f32_bf16 v129, v124, s30, v129
    v_lshlrev_b32 v120, 16, v80
    s_waitcnt lgkmcnt(0)
    s_add_u32 m0, s70, 0
    s_add_u32 s66, s68, s97
    s_add_u32 s66, s66, 256
    buffer_load_dwordx4 v242, s[8:11], s66 offen offset:0 lds
    v_and_b32 v121, s31, v80
    v_lshlrev_b32 v122, 16, v116
    v_and_b32 v123, s31, v116
    v_pk_mul_f32 v[120:121], v[120:121], v[122:123]
    v_cvt_pk_bf16_f32 v120, v120, v121
    v_dot2_f32_bf16 v128, v120, s30, v128
    v_lshlrev_b32 v124, 16, v81
    v_and_b32 v125, s31, v81
    v_lshlrev_b32 v126, 16, v117
    v_and_b32 v127, s31, v117
    v_pk_mul_f32 v[124:125], v[124:125], v[126:127]
    v_cvt_pk_bf16_f32 v124, v124, v125
    v_dot2_f32_bf16 v129, v124, s30, v129
    v_lshlrev_b32 v120, 16, v82
    buffer_load_dwordx4 v243, s[8:11], s66 offen offset:1024 lds
    v_and_b32 v121, s31, v82
    v_lshlrev_b32 v122, 16, v118
    v_and_b32 v123, s31, v118
    v_pk_mul_f32 v[120:121], v[120:121], v[122:123]
    v_cvt_pk_bf16_f32 v120, v120, v121
    v_dot2_f32_bf16 v128, v120, s30, v128
    v_lshlrev_b32 v124, 16, v83
    v_and_b32 v125, s31, v83
    v_lshlrev_b32 v126, 16, v119
    v_and_b32 v127, s31, v119
    v_pk_mul_f32 v[124:125], v[124:125], v[126:127]
    v_cvt_pk_bf16_f32 v124, v124, v125
    v_dot2_f32_bf16 v129, v124, s30, v129
    s_nop 2
    buffer_load_dwordx4 v244, s[8:11], s66 offen offset:2048 lds
    v_add_f32 v128, v128, v129
    s_nop 1
    v_add_f32_dpp v128, v128, v128 quad_perm:[1,0,3,2] row_mask:0xf bank_mask:0xf
    s_nop 1
    v_add_f32_dpp v128, v128, v128 quad_perm:[2,3,0,1] row_mask:0xf bank_mask:0xf
    s_nop 1
    v_add_f32_dpp v128, v128, v128 row_half_mirror row_mask:0xf bank_mask:0xf
    v_cvt_pk_bf16_f32 v128, v128, v128
    v_lshlrev_b32 v128, 16, v128
    v_mul_f32 v128, -1.4426950408889634, v128
    v_exp_f32 v128, v128
    s_nop 0
    v_add_f32 v128, 1.0, v128
    v_rcp_f32 v128, v128
    buffer_load_dwordx4 v245, s[8:11], s66 offen offset:3072 lds
    s_nop 0
    v_cvt_pk_bf16_f32 v128, v128, v128
    v_lshlrev_b32 v128, 16, v128
    v_lshrrev_b32 v120, 3, v252
    v_lshlrev_b32 v120, 2, v120
    s_lshl_b32 s72, s74, 7
    s_lshl_b32 s73, s16, 5
    s_add_u32 s72, s72, s73
    s_add_u32 s72, s72, 27262976
    buffer_store_dword v128, v120, s[36:39], s72 offen sc1
    s_add_u32 m0, s70, 4096
    s_add_u32 s66, s69, s97
    s_add_u32 s66, s66, 256
    buffer_load_dwordx4 v242, s[8:11], s66 offen offset:0 lds
    buffer_load_dwordx4 v243, s[8:11], s66 offen offset:1024 lds
    buffer_load_dwordx4 v244, s[8:11], s66 offen offset:2048 lds
    buffer_load_dwordx4 v245, s[8:11], s66 offen offset:3072 lds
    s_waitcnt lgkmcnt(0)
gated_mix__ssm_conv_s4__glu_gated_bilinear__prompt_kernel_join:
    s_waitcnt vmcnt(28)
    s_barrier
    ds_read_b64_tr_b16 v[160:161], v228 offset:53248
    ds_read_b64_tr_b16 v[162:163], v228 offset:53760
    ds_read_b64_tr_b16 v[164:165], v228 offset:54272
    ds_read_b64_tr_b16 v[166:167], v228 offset:54784
    ds_read_b64_tr_b16 v[168:169], v229 offset:53248
    ds_read_b64_tr_b16 v[170:171], v229 offset:53760
    ds_read_b64_tr_b16 v[172:173], v229 offset:54272
    ds_read_b64_tr_b16 v[174:175], v229 offset:54784
    ds_read_b64_tr_b16 v[176:177], v230 offset:53248
    ds_read_b64_tr_b16 v[178:179], v230 offset:53760
    ds_read_b64_tr_b16 v[180:181], v230 offset:54272
    ds_read_b64_tr_b16 v[182:183], v230 offset:54784
    ds_read_b64_tr_b16 v[184:185], v231 offset:53248
    ds_read_b64_tr_b16 v[186:187], v231 offset:53760
    ds_read_b64_tr_b16 v[188:189], v231 offset:54272
    ds_read_b64_tr_b16 v[190:191], v231 offset:54784
    s_waitcnt lgkmcnt(14)
    v_mfma_f32_16x16x32_bf16 v[0:3], v[160:163], a[0:3], 0
    s_waitcnt vmcnt(16)
    ds_read_b128 a[32:35], v246 offset:32768
    s_waitcnt lgkmcnt(13)
    v_mfma_f32_16x16x32_bf16 v[16:19], v[164:167], a[0:3], 0
    ds_read_b128 a[36:39], v246 offset:34816
    s_waitcnt lgkmcnt(12)
    v_mfma_f32_16x16x32_bf16 v[32:35], v[168:171], a[0:3], 0
    ds_read_b128 a[40:43], v246 offset:36864
    s_waitcnt lgkmcnt(11)
    v_mfma_f32_16x16x32_bf16 v[48:51], v[172:175], a[0:3], 0
    ds_read_b128 a[44:47], v246 offset:38912
    v_mfma_f32_16x16x32_bf16 v[4:7], v[160:163], a[4:7], 0
    ds_read_b64_tr_b16 v[192:193], v232 offset:0
    s_add_u32 m0, s51, 65536
    v_mfma_f32_16x16x32_bf16 v[20:23], v[164:167], a[4:7], 0
    ds_read_b64_tr_b16 v[194:195], v232 offset:512
    s_add_u32 s66, s48, s95
    v_mfma_f32_16x16x32_bf16 v[36:39], v[168:171], a[4:7], 0
    buffer_load_dwordx4 v248, s[20:23], s66 offen lds
    s_mov_b32 s44, s58
    v_mfma_f32_16x16x32_bf16 v[52:55], v[172:175], a[4:7], 0
    ds_read_b64_tr_b16 v[196:197], v232 offset:1024
    s_mov_b32 s45, s59
    v_mfma_f32_16x16x32_bf16 v[8:11], v[160:163], a[8:11], 0
    ds_read_b64_tr_b16 v[198:199], v232 offset:1536
    s_mov_b32 s46, 256
    v_mfma_f32_16x16x32_bf16 v[24:27], v[164:167], a[8:11], 0
    ds_read_b128 a[48:51], v247 offset:32768
    buffer_load_dwordx4 v248, s[24:27], s66 offen offset:1024 lds
    v_mfma_f32_16x16x32_bf16 v[40:43], v[168:171], a[8:11], 0
    ds_read_b128 a[52:55], v247 offset:34816
    s_mov_b32 s47, 0x20000
    v_mfma_f32_16x16x32_bf16 v[56:59], v[172:175], a[8:11], 0
    ds_read_b128 a[56:59], v247 offset:36864
    s_add_u32 m0, s51, 73728
    v_mfma_f32_16x16x32_bf16 v[12:15], v[160:163], a[12:15], 0
    ds_read_b128 a[60:63], v247 offset:38912
    s_add_u32 s66, s66, 294912
    v_mfma_f32_16x16x32_bf16 v[28:31], v[164:167], a[12:15], 0
    buffer_load_dwordx4 v248, s[20:23], s66 offen lds
    s_lshl_b32 s67, s17, 10
    v_mfma_f32_16x16x32_bf16 v[44:47], v[168:171], a[12:15], 0
    ds_read_b64_tr_b16 v[200:201], v233 offset:0
    s_and_b32 s32, s14, 1
    v_mfma_f32_16x16x32_bf16 v[60:63], v[172:175], a[12:15], 0
    ds_read_b64_tr_b16 v[202:203], v233 offset:512
    s_lshl_b32 s49, s18, 7
    s_waitcnt lgkmcnt(6)
    v_mfma_f32_16x16x32_bf16 v[64:67], v[176:179], a[0:3], 0
    ds_read_b64_tr_b16 v[204:205], v233 offset:1024
    v_mfma_f32_16x16x32_bf16 v[80:83], v[180:183], a[0:3], 0
    ds_read_b64_tr_b16 v[206:207], v233 offset:1536
    s_add_u32 s49, s49, 128
    v_mfma_f32_16x16x32_bf16 v[96:99], v[184:187], a[0:3], 0
    ds_read_b64_tr_b16 v[208:209], v234 offset:0
    buffer_load_dwordx4 v248, s[24:27], s66 offen offset:1024 lds
    v_mfma_f32_16x16x32_bf16 v[112:115], v[188:191], a[0:3], 0
    ds_read_b64_tr_b16 v[210:211], v234 offset:512
    s_lshl_b32 s50, s19, 7
    v_mfma_f32_16x16x32_bf16 v[68:71], v[176:179], a[4:7], 0
    s_add_u32 m0, s51, 81920
    s_add_u32 s66, s66, 294912
    v_mfma_f32_16x16x32_bf16 v[84:87], v[180:183], a[4:7], 0
    ds_read_b64_tr_b16 v[212:213], v234 offset:1024
    s_lshl_b32 s71, s32, 6
    v_mfma_f32_16x16x32_bf16 v[100:103], v[184:187], a[4:7], 0
    ds_read_b64_tr_b16 v[214:215], v234 offset:1536
    buffer_load_dwordx4 v248, s[20:23], s66 offen lds
    v_mfma_f32_16x16x32_bf16 v[116:119], v[188:191], a[4:7], 0
    ds_read_b64_tr_b16 v[216:217], v235 offset:0
    s_add_u32 s50, s50, s71
    v_mfma_f32_16x16x32_bf16 v[72:75], v[176:179], a[8:11], 0
    ds_read_b64_tr_b16 v[218:219], v235 offset:512
    v_lshrrev_b32 v253, 2, v252
    v_mfma_f32_16x16x32_bf16 v[88:91], v[180:183], a[8:11], 0
    ds_read_b64_tr_b16 v[220:221], v235 offset:1024
    v_mul_u32_u24 v253, 9216, v253
    v_mfma_f32_16x16x32_bf16 v[104:107], v[184:187], a[8:11], 0
    ds_read_b64_tr_b16 v[222:223], v235 offset:1536
    v_lshrrev_b32 v254, 5, v252
    v_mfma_f32_16x16x32_bf16 v[120:123], v[188:191], a[8:11], 0
    buffer_load_dwordx4 v248, s[24:27], s66 offen offset:1024 lds
    v_lshlrev_b32 v254, 1, v254
    v_mfma_f32_16x16x32_bf16 v[76:79], v[176:179], a[12:15], 0
    v_and_b32 v255, 3, v252
    v_xor_b32 v254, v254, v255
    v_mfma_f32_16x16x32_bf16 v[92:95], v[180:183], a[12:15], 0
    s_waitcnt lgkmcnt(4)
    s_add_u32 m0, s70, 32768
    v_mfma_f32_16x16x32_bf16 v[108:111], v[184:187], a[12:15], 0
    s_add_u32 s66, s68, s98
    v_lshlrev_b32 v254, 4, v254
    v_mfma_f32_16x16x32_bf16 v[124:127], v[188:191], a[12:15], 0
    buffer_load_dwordx4 v242, s[8:11], s66 offen offset:0 lds
    v_add_u32 v249, v253, v254
    v_mfma_f32_16x16x32_bf16 v[0:3], v[192:195], a[16:19], v[0:3]
    s_waitcnt vmcnt(7)
    ds_read_b128 a[64:67], v246 offset:0
    v_mfma_f32_16x16x32_bf16 v[4:7], v[192:195], a[20:23], v[4:7]
    ds_read_b128 a[68:71], v246 offset:2048
    s_and_b32 s71, s17, 1
    v_mfma_f32_16x16x32_bf16 v[8:11], v[192:195], a[24:27], v[8:11]
    ds_read_b128 a[72:75], v246 offset:4096
    s_mul_i32 s71, s71, 147456
    v_mfma_f32_16x16x32_bf16 v[12:15], v[192:195], a[28:31], v[12:15]
    ds_read_b128 a[76:79], v246 offset:6144
    v_add_u32 v249, s71, v249
    v_mfma_f32_16x16x32_bf16 v[16:19], v[196:199], a[16:19], v[16:19]
    ds_read_b64_tr_b16 v[160:161], v232 offset:8192
    buffer_load_dwordx4 v243, s[8:11], s66 offen offset:1024 lds
    v_mfma_f32_16x16x32_bf16 v[20:23], v[196:199], a[20:23], v[20:23]
    ds_read_b64_tr_b16 v[162:163], v232 offset:8704
    v_lshlrev_b32 v253, 4, v252
    v_mfma_f32_16x16x32_bf16 v[24:27], v[196:199], a[24:27], v[24:27]
    s_lshl_b32 s71, s15, 14
    s_lshl_b32 s72, s17, 12
    v_mfma_f32_16x16x32_bf16 v[28:31], v[196:199], a[28:31], v[28:31]
    ds_read_b64_tr_b16 v[164:165], v232 offset:9216
    s_add_u32 s71, s71, s72
    v_mfma_f32_16x16x32_bf16 v[32:35], v[200:203], a[16:19], v[32:35]
    ds_read_b64_tr_b16 v[166:167], v232 offset:9728
    buffer_load_dwordx4 v244, s[8:11], s66 offen offset:2048 lds
    v_mfma_f32_16x16x32_bf16 v[36:39], v[200:203], a[20:23], v[36:39]
    ds_read_b128 a[80:83], v247 offset:0
    s_lshl_b32 s72, s33, 11
    v_mfma_f32_16x16x32_bf16 v[40:43], v[200:203], a[24:27], v[40:43]
    ds_read_b128 a[84:87], v247 offset:2048
    s_add_u32 s3, s71, s72
    v_mfma_f32_16x16x32_bf16 v[44:47], v[200:203], a[28:31], v[44:47]
    ds_read_b128 a[88:91], v247 offset:4096
    v_add_u32 v250, s3, v253
    v_mfma_f32_16x16x32_bf16 v[48:51], v[204:207], a[16:19], v[48:51]
    ds_read_b128 a[92:95], v247 offset:6144
    s_xor_b32 s72, s72, 2048
    v_mfma_f32_16x16x32_bf16 v[52:55], v[204:207], a[20:23], v[52:55]
    buffer_load_dwordx4 v245, s[8:11], s66 offen offset:3072 lds
    s_add_u32 s72, s71, s72
    v_mfma_f32_16x16x32_bf16 v[56:59], v[204:207], a[24:27], v[56:59]
    ds_read_b64_tr_b16 v[168:169], v233 offset:8192
    v_add_u32 v251, s72, v253
    v_mfma_f32_16x16x32_bf16 v[60:63], v[204:207], a[28:31], v[60:63]
    ds_read_b64_tr_b16 v[170:171], v233 offset:8704
    s_add_u32 m0, s70, 36864
    v_mfma_f32_16x16x32_bf16 v[64:67], v[208:211], a[16:19], v[64:67]
    ds_read_b64_tr_b16 v[172:173], v233 offset:9216
    s_add_u32 s66, s69, s98
    v_mfma_f32_16x16x32_bf16 v[68:71], v[208:211], a[20:23], v[68:71]
    ds_read_b64_tr_b16 v[174:175], v233 offset:9728
    buffer_load_dwordx4 v242, s[8:11], s66 offen offset:0 lds
    v_mfma_f32_16x16x32_bf16 v[72:75], v[208:211], a[24:27], v[72:75]
    ds_read_b64_tr_b16 v[176:177], v234 offset:8192
    s_lshl_b32 s60, s18, 18
    v_mfma_f32_16x16x32_bf16 v[76:79], v[208:211], a[28:31], v[76:79]
    ds_read_b64_tr_b16 v[178:179], v234 offset:8704
    s_add_u32 s60, s60, 1048576
    v_mfma_f32_16x16x32_bf16 v[80:83], v[212:215], a[16:19], v[80:83]
    s_add_u32 s61, s60, 131072
    s_add_u32 s62, s60, 262144
    v_mfma_f32_16x16x32_bf16 v[84:87], v[212:215], a[20:23], v[84:87]
    ds_read_b64_tr_b16 v[180:181], v234 offset:9216
    s_add_u32 s63, s60, 393216
    v_mfma_f32_16x16x32_bf16 v[88:91], v[212:215], a[24:27], v[88:91]
    ds_read_b64_tr_b16 v[182:183], v234 offset:9728
    buffer_load_dwordx4 v243, s[8:11], s66 offen offset:1024 lds
    v_mfma_f32_16x16x32_bf16 v[92:95], v[212:215], a[28:31], v[92:95]
    ds_read_b64_tr_b16 v[184:185], v235 offset:8192
    s_lshl_b32 s34, s19, 1
    s_waitcnt lgkmcnt(6)
    v_mfma_f32_16x16x32_bf16 v[96:99], v[216:219], a[16:19], v[96:99]
    ds_read_b64_tr_b16 v[186:187], v235 offset:8704
    v_mfma_f32_16x16x32_bf16 v[100:103], v[216:219], a[20:23], v[100:103]
    ds_read_b64_tr_b16 v[188:189], v235 offset:9216
    s_add_u32 s34, s34, s32
    v_mfma_f32_16x16x32_bf16 v[104:107], v[216:219], a[24:27], v[104:107]
    ds_read_b64_tr_b16 v[190:191], v235 offset:9728
    buffer_load_dwordx4 v244, s[8:11], s66 offen offset:2048 lds
    v_mfma_f32_16x16x32_bf16 v[108:111], v[216:219], a[28:31], v[108:111]
    s_lshl_b32 s34, s34, 17
    s_add_u32 s34, s34, 1048576
    v_mfma_f32_16x16x32_bf16 v[112:115], v[220:223], a[16:19], v[112:115]
    v_min_u32 v254, 35, v252
    v_mul_u32_u24 v253, 57, v254
    v_mfma_f32_16x16x32_bf16 v[116:119], v[220:223], a[20:23], v[116:119]
    v_lshrrev_b32 v253, 9, v253
    v_mul_u32_u24 v254, 9216, v254
    v_mfma_f32_16x16x32_bf16 v[120:123], v[220:223], a[24:27], v[120:123]
    v_mul_u32_u24 v253, 82688, v253
    v_sub_u32 v254, v254, v253
    v_mfma_f32_16x16x32_bf16 v[124:127], v[220:223], a[28:31], v[124:127]
    buffer_load_dwordx4 v245, s[8:11], s66 offen offset:3072 lds
    s_lshl_b32 s71, s13, 1
    v_mfma_f32_16x16x32_bf16 v[0:3], v[160:163], a[32:35], v[0:3]
    s_waitcnt lgkmcnt(0)
    s_barrier
    v_mfma_f32_16x16x32_bf16 v[4:7], v[160:163], a[36:39], v[4:7]
    ds_read_b64_tr_b16 v[192:193], v232 offset:16384
    s_and_b32 s72, s17, 1
    v_mfma_f32_16x16x32_bf16 v[8:11], v[160:163], a[40:43], v[8:11]
    ds_read_b64_tr_b16 v[194:195], v232 offset:16896
    s_add_u32 s71, s71, s72
    v_mfma_f32_16x16x32_bf16 v[12:15], v[160:163], a[44:47], v[12:15]
    buffer_load_dwordx4 v[236:239], off, s[44:47], 0 sc1
    s_mul_i32 s71, s71, 82944
    v_mfma_f32_16x16x32_bf16 v[16:19], v[164:167], a[32:35], v[16:19]
    ds_read_b64_tr_b16 v[196:197], v232 offset:17408
    s_mul_i32 s72, s16, 2304
    v_mfma_f32_16x16x32_bf16 v[20:23], v[164:167], a[36:39], v[20:23]
    s_add_u32 s71, s71, s72
    s_and_b32 s72, s2, 1
    v_mfma_f32_16x16x32_bf16 v[24:27], v[164:167], a[40:43], v[24:27]
    ds_read_b64_tr_b16 v[198:199], v232 offset:17920
    s_add_u32 m0, s70, 0
    v_mfma_f32_16x16x32_bf16 v[28:31], v[164:167], a[44:47], v[28:31]
    ds_read_b64_tr_b16 v[200:201], v233 offset:16384
    s_add_u32 s66, s68, s98
    v_mfma_f32_16x16x32_bf16 v[32:35], v[168:171], a[32:35], v[32:35]
    s_add_u32 s66, s66, 128
    buffer_load_dwordx4 v242, s[8:11], s66 offen offset:0 lds
    v_mfma_f32_16x16x32_bf16 v[36:39], v[168:171], a[36:39], v[36:39]
    ds_read_b64_tr_b16 v[202:203], v233 offset:16896
    s_mul_i32 s72, s72, 1152
    v_mfma_f32_16x16x32_bf16 v[40:43], v[168:171], a[40:43], v[40:43]
    s_add_u32 s71, s71, s72
    v_add_u32 v254, s71, v254
    v_mfma_f32_16x16x32_bf16 v[44:47], v[168:171], a[44:47], v[44:47]
    ds_read_b64_tr_b16 v[204:205], v233 offset:17408
    s_lshl_b32 s4, s2, 7
    v_mfma_f32_16x16x32_bf16 v[48:51], v[172:175], a[32:35], v[48:51]
    ds_read_b64_tr_b16 v[206:207], v233 offset:17920
    buffer_load_dwordx4 v243, s[8:11], s66 offen offset:1024 lds
    v_mfma_f32_16x16x32_bf16 v[52:55], v[172:175], a[36:39], v[52:55]
    s_add_u32 s4, s4, 65536
    s_and_b32 s71, s12, 1
    v_mfma_f32_16x16x32_bf16 v[56:59], v[172:175], a[40:43], v[56:59]
    ds_read_b64_tr_b16 v[208:209], v234 offset:16384
    s_lshl_b32 s79, s15, 1
    v_mfma_f32_16x16x32_bf16 v[60:63], v[172:175], a[44:47], v[60:63]
    s_add_u32 s79, s79, s71
    s_lshl_b32 s79, s79, 2
    v_mfma_f32_16x16x32_bf16 v[64:67], v[176:179], a[32:35], v[64:67]
    ds_read_b64_tr_b16 v[210:211], v234 offset:16896
    s_add_u32 s79, s79, s14
    v_mfma_f32_16x16x32_bf16 v[68:71], v[176:179], a[36:39], v[68:71]
    ds_read_b64_tr_b16 v[212:213], v234 offset:17408
    buffer_load_dwordx4 v244, s[8:11], s66 offen offset:2048 lds
    v_mfma_f32_16x16x32_bf16 v[72:75], v[176:179], a[40:43], v[72:75]
    s_lshl_b32 s79, s79, 2
    s_add_u32 s72, s79, s16
    v_mfma_f32_16x16x32_bf16 v[76:79], v[176:179], a[44:47], v[76:79]
    ds_read_b64_tr_b16 v[214:215], v234 offset:17920
    s_lshr_b32 s5, s2, 4
    v_mfma_f32_16x16x32_bf16 v[80:83], v[180:183], a[32:35], v[80:83]
    s_and_b32 s5, s5, 0
    s_xor_b32 s5, s5, s72
    v_mfma_f32_16x16x32_bf16 v[84:87], v[180:183], a[36:39], v[84:87]
    ds_read_b64_tr_b16 v[216:217], v235 offset:16384
    buffer_load_dwordx4 v245, s[8:11], s66 offen offset:3072 lds
    v_mfma_f32_16x16x32_bf16 v[88:91], v[180:183], a[40:43], v[88:91]
    ds_read_b64_tr_b16 v[218:219], v235 offset:16896
    s_mul_i32 s5, s5, 24576
    v_mfma_f32_16x16x32_bf16 v[92:95], v[180:183], a[44:47], v[92:95]
    s_add_u32 s5, s5, s51
    s_add_u32 s5, s5, 28311552
    v_mfma_f32_16x16x32_bf16 v[96:99], v[184:187], a[32:35], v[96:99]
    ds_read_b64_tr_b16 v[220:221], v235 offset:17408
    s_add_u32 m0, s70, 4096
    v_mfma_f32_16x16x32_bf16 v[100:103], v[184:187], a[36:39], v[100:103]
    s_add_u32 s66, s69, s98
    s_add_u32 s66, s66, 128
    v_mfma_f32_16x16x32_bf16 v[104:107], v[184:187], a[40:43], v[104:107]
    ds_read_b64_tr_b16 v[222:223], v235 offset:17920
    buffer_load_dwordx4 v242, s[8:11], s66 offen offset:0 lds
    v_mfma_f32_16x16x32_bf16 v[108:111], v[184:187], a[44:47], v[108:111]
    s_sub_u32 s5, s5, s3
    s_lshl_b32 s1, s17, 12
    v_mfma_f32_16x16x32_bf16 v[112:115], v[188:191], a[32:35], v[112:115]
    s_lshl_b32 s6, s72, 14
    s_add_u32 s6, s6, s1
    v_mfma_f32_16x16x32_bf16 v[116:119], v[188:191], a[36:39], v[116:119]
    s_add_u32 s6, s6, 39845888
    s_sub_u32 s6, s6, s3
    v_mfma_f32_16x16x32_bf16 v[120:123], v[188:191], a[40:43], v[120:123]
    buffer_load_dwordx4 v243, s[8:11], s66 offen offset:1024 lds
    s_mul_i32 s7, s2, 4352
    v_mfma_f32_16x16x32_bf16 v[124:127], v[188:191], a[44:47], v[124:127]
    s_add_u32 s7, s7, 35651712
    s_sub_u32 s7, s7, s3
    s_waitcnt lgkmcnt(1)
    v_mfma_f32_16x16x32_bf16 v[0:3], v[192:195], a[48:51], v[0:3]
    s_waitcnt vmcnt(7)
    ds_read_b128 a[96:99], v246 offset:32768
    v_mfma_f32_16x16x32_bf16 v[4:7], v[192:195], a[52:55], v[4:7]
    ds_read_b128 a[100:103], v246 offset:34816
    s_lshl_b32 s72, s17, 1
    v_mfma_f32_16x16x32_bf16 v[8:11], v[192:195], a[56:59], v[8:11]
    ds_read_b128 a[104:107], v246 offset:36864
    s_sub_u32 s7, s7, s72
    v_mfma_f32_16x16x32_bf16 v[12:15], v[192:195], a[60:63], v[12:15]
    ds_read_b128 a[108:111], v246 offset:38912
    buffer_load_dwordx4 v244, s[8:11], s66 offen offset:2048 lds
    v_mfma_f32_16x16x32_bf16 v[16:19], v[196:199], a[48:51], v[16:19]
    ds_read_b64_tr_b16 v[160:161], v232 offset:24576
    s_mul_i32 s18, s16, 4718592
    v_mfma_f32_16x16x32_bf16 v[20:23], v[196:199], a[52:55], v[20:23]
    ds_read_b64_tr_b16 v[162:163], v232 offset:25088
    s_lshl_b32 s72, s15, 14
    v_mfma_f32_16x16x32_bf16 v[24:27], v[196:199], a[56:59], v[24:27]
    s_add_u32 s18, s18, s72
    s_lshl_b32 s72, s71, 13
    v_mfma_f32_16x16x32_bf16 v[28:31], v[196:199], a[60:63], v[28:31]
    ds_read_b64_tr_b16 v[164:165], v232 offset:25600
    buffer_load_dwordx4 v245, s[8:11], s66 offen offset:3072 lds
    v_mfma_f32_16x16x32_bf16 v[32:35], v[200:203], a[48:51], v[32:35]
    ds_read_b64_tr_b16 v[166:167], v232 offset:26112
    s_add_u32 s18, s18, s72
    v_mfma_f32_16x16x32_bf16 v[36:39], v[200:203], a[52:55], v[36:39]
    ds_read_b128 a[112:115], v247 offset:32768
    s_add_u32 s18, s18, s51
    v_mfma_f32_16x16x32_bf16 v[40:43], v[200:203], a[56:59], v[40:43]
    ds_read_b128 a[116:119], v247 offset:34816
    s_add_u32 m0, s51, 90112
    v_mfma_f32_16x16x32_bf16 v[44:47], v[200:203], a[60:63], v[44:47]
    ds_read_b128 a[120:123], v247 offset:36864
    s_add_u32 s66, s48, s95
    v_mfma_f32_16x16x32_bf16 v[48:51], v[204:207], a[48:51], v[48:51]
    ds_read_b128 a[124:127], v247 offset:38912
    s_add_u32 s66, s66, 884736
    v_mfma_f32_16x16x32_bf16 v[52:55], v[204:207], a[52:55], v[52:55]
    buffer_load_dwordx4 v248, s[20:23], s66 offen lds
    s_add_u32 s18, s18, 1048576
    v_mfma_f32_16x16x32_bf16 v[56:59], v[204:207], a[56:59], v[56:59]
    ds_read_b64_tr_b16 v[168:169], v233 offset:24576
    s_sub_u32 s18, s18, s3
    v_mfma_f32_16x16x32_bf16 v[60:63], v[204:207], a[60:63], v[60:63]
    ds_read_b64_tr_b16 v[170:171], v233 offset:25088
    s_mul_i32 s19, s16, 1327104
    v_mfma_f32_16x16x32_bf16 v[64:67], v[208:211], a[48:51], v[64:67]
    ds_read_b64_tr_b16 v[172:173], v233 offset:25600
    buffer_load_dwordx4 v248, s[24:27], s66 offen offset:1024 lds
    v_mfma_f32_16x16x32_bf16 v[68:71], v[208:211], a[52:55], v[68:71]
    ds_read_b64_tr_b16 v[174:175], v233 offset:26112
    s_lshr_b32 s72, s17, 1
    v_mfma_f32_16x16x32_bf16 v[72:75], v[208:211], a[56:59], v[72:75]
    ds_read_b64_tr_b16 v[176:177], v234 offset:24576
    s_and_b32 s74, s17, 1
    v_mfma_f32_16x16x32_bf16 v[76:79], v[208:211], a[60:63], v[76:79]
    ds_read_b64_tr_b16 v[178:179], v234 offset:25088
    s_add_u32 m0, s51, 98304
    v_mfma_f32_16x16x32_bf16 v[80:83], v[212:215], a[48:51], v[80:83]
    s_add_u32 s66, s66, 294912
    s_mul_i32 s74, s74, 9216
    v_mfma_f32_16x16x32_bf16 v[84:87], v[212:215], a[52:55], v[84:87]
    ds_read_b64_tr_b16 v[180:181], v234 offset:25600
    buffer_load_dwordx4 v248, s[20:23], s66 offen lds
    v_mfma_f32_16x16x32_bf16 v[88:91], v[212:215], a[56:59], v[88:91]
    ds_read_b64_tr_b16 v[182:183], v234 offset:26112
    s_add_u32 s74, s74, s19
    v_mfma_f32_16x16x32_bf16 v[92:95], v[212:215], a[60:63], v[92:95]
    ds_read_b64_tr_b16 v[184:185], v235 offset:24576
    s_mul_i32 s75, s72, 147456
    v_mfma_f32_16x16x32_bf16 v[96:99], v[216:219], a[48:51], v[96:99]
    ds_read_b64_tr_b16 v[186:187], v235 offset:25088
    s_add_u32 s74, s74, s75
    v_mfma_f32_16x16x32_bf16 v[100:103], v[216:219], a[52:55], v[100:103]
    ds_read_b64_tr_b16 v[188:189], v235 offset:25600
    buffer_load_dwordx4 v248, s[24:27], s66 offen offset:1024 lds
    v_mfma_f32_16x16x32_bf16 v[104:107], v[216:219], a[56:59], v[104:107]
    ds_read_b64_tr_b16 v[190:191], v235 offset:26112
    s_lshr_b32 s73, s2, 6
    v_mfma_f32_16x16x32_bf16 v[108:111], v[216:219], a[60:63], v[108:111]
    s_xor_b32 s73, s73, s14
    s_xor_b32 s71, s73, 0
    s_waitcnt lgkmcnt(6)
    v_mfma_f32_16x16x32_bf16 v[112:115], v[220:223], a[48:51], v[112:115]
    s_add_u32 m0, s51, 106496
    v_mfma_f32_16x16x32_bf16 v[116:119], v[220:223], a[52:55], v[116:119]
    s_add_u32 s66, s66, 294912
    s_and_b32 s75, s71, 1
    v_mfma_f32_16x16x32_bf16 v[120:123], v[220:223], a[56:59], v[120:123]
    buffer_load_dwordx4 v248, s[20:23], s66 offen lds
    s_lshl_b32 s75, s75, 3
    v_mfma_f32_16x16x32_bf16 v[124:127], v[220:223], a[60:63], v[124:127]
    s_lshl2_add_u32 s76, s16, s71
    s_cmp_eq_u32 s76, 7
    s_cselect_b32 s75, 10, s75
    v_mfma_f32_16x16x32_bf16 v[0:3], v[160:163], a[64:67], v[0:3]
    ds_read_b64_tr_b16 v[192:193], v232 offset:32768
    s_lshr_b32 s71, s71, 1
    v_mfma_f32_16x16x32_bf16 v[4:7], v[160:163], a[68:71], v[4:7]
    ds_read_b64_tr_b16 v[194:195], v232 offset:33280
    s_mul_i32 s71, s71, 18
    v_mfma_f32_16x16x32_bf16 v[8:11], v[160:163], a[72:75], v[8:11]
    buffer_load_dwordx4 v248, s[24:27], s66 offen offset:1024 lds
    s_add_u32 s71, s71, s75
    v_mfma_f32_16x16x32_bf16 v[12:15], v[160:163], a[76:79], v[12:15]
    ds_read_b64_tr_b16 v[196:197], v232 offset:33792
    s_lshl_b32 s75, s71, 17
    v_mfma_f32_16x16x32_bf16 v[16:19], v[164:167], a[64:67], v[16:19]
    s_add_u32 s32, s75, s18
    s_mul_i32 s75, s71, 36864
    v_mfma_f32_16x16x32_bf16 v[20:23], v[164:167], a[68:71], v[20:23]
    ds_read_b64_tr_b16 v[198:199], v232 offset:34304
    s_add_u32 m0, s70, 32768
    v_mfma_f32_16x16x32_bf16 v[24:27], v[164:167], a[72:75], v[24:27]
    s_add_u32 s66, s68, s98
    s_add_u32 s66, s66, 256
    v_mfma_f32_16x16x32_bf16 v[28:31], v[164:167], a[76:79], v[28:31]
    ds_read_b64_tr_b16 v[200:201], v233 offset:32768
    buffer_load_dwordx4 v242, s[8:11], s66 offen offset:0 lds
    v_mfma_f32_16x16x32_bf16 v[32:35], v[168:171], a[64:67], v[32:35]
    ds_read_b64_tr_b16 v[202:203], v233 offset:33280
    s_add_u32 s58, s75, s74
    v_mfma_f32_16x16x32_bf16 v[36:39], v[168:171], a[68:71], v[36:39]
    s_xor_b32 s71, s73, 1
    s_and_b32 s75, s71, 1
    v_mfma_f32_16x16x32_bf16 v[40:43], v[168:171], a[72:75], v[40:43]
    ds_read_b64_tr_b16 v[204:205], v233 offset:33792
    s_lshl_b32 s75, s75, 3
    v_mfma_f32_16x16x32_bf16 v[44:47], v[168:171], a[76:79], v[44:47]
    buffer_load_dwordx4 v243, s[8:11], s66 offen offset:1024 lds
    s_lshl2_add_u32 s76, s16, s71
    v_mfma_f32_16x16x32_bf16 v[48:51], v[172:175], a[64:67], v[48:51]
    ds_read_b64_tr_b16 v[206:207], v233 offset:34304
    s_cmp_eq_u32 s76, 7
    s_cselect_b32 s75, 10, s75
    v_mfma_f32_16x16x32_bf16 v[52:55], v[172:175], a[68:71], v[52:55]
    s_lshr_b32 s71, s71, 1
    s_mul_i32 s71, s71, 18
    v_mfma_f32_16x16x32_bf16 v[56:59], v[172:175], a[72:75], v[56:59]
    ds_read_b64_tr_b16 v[208:209], v234 offset:32768
    s_add_u32 s71, s71, s75
    v_mfma_f32_16x16x32_bf16 v[60:63], v[172:175], a[76:79], v[60:63]
    ds_read_b64_tr_b16 v[210:211], v234 offset:33280
    s_lshl_b32 s75, s71, 17
    v_mfma_f32_16x16x32_bf16 v[64:67], v[176:179], a[64:67], v[64:67]
    buffer_load_dwordx4 v244, s[8:11], s66 offen offset:2048 lds
    s_add_u32 s33, s75, s18
    v_mfma_f32_16x16x32_bf16 v[68:71], v[176:179], a[68:71], v[68:71]
    ds_read_b64_tr_b16 v[212:213], v234 offset:33792
    s_mul_i32 s75, s71, 36864
    v_mfma_f32_16x16x32_bf16 v[72:75], v[176:179], a[72:75], v[72:75]
    s_add_u32 s59, s75, s74
    s_xor_b32 s71, s73, 2
    v_mfma_f32_16x16x32_bf16 v[76:79], v[176:179], a[76:79], v[76:79]
    ds_read_b64_tr_b16 v[214:215], v234 offset:34304
    s_and_b32 s75, s71, 1
    s_waitcnt lgkmcnt(4)
    v_mfma_f32_16x16x32_bf16 v[80:83], v[180:183], a[64:67], v[80:83]
    buffer_load_dwordx4 v245, s[8:11], s66 offen offset:3072 lds
    v_mfma_f32_16x16x32_bf16 v[84:87], v[180:183], a[68:71], v[84:87]
    ds_read_b64_tr_b16 v[216:217], v235 offset:32768
    s_lshl_b32 s75, s75, 3
    v_mfma_f32_16x16x32_bf16 v[88:91], v[180:183], a[72:75], v[88:91]
    ds_read_b64_tr_b16 v[218:219], v235 offset:33280
    s_lshl2_add_u32 s76, s16, s71
    v_mfma_f32_16x16x32_bf16 v[92:95], v[180:183], a[76:79], v[92:95]
    s_add_u32 m0, s70, 36864
    s_add_u32 s66, s69, s98
    v_mfma_f32_16x16x32_bf16 v[96:99], v[184:187], a[64:67], v[96:99]
    ds_read_b64_tr_b16 v[220:221], v235 offset:33792
    s_add_u32 s66, s66, 256
    v_mfma_f32_16x16x32_bf16 v[100:103], v[184:187], a[68:71], v[100:103]
    buffer_load_dwordx4 v242, s[8:11], s66 offen offset:0 lds
    s_cmp_eq_u32 s76, 7
    s_cselect_b32 s75, 10, s75
    v_mfma_f32_16x16x32_bf16 v[104:107], v[184:187], a[72:75], v[104:107]
    ds_read_b64_tr_b16 v[222:223], v235 offset:34304
    s_lshr_b32 s71, s71, 1
    v_mfma_f32_16x16x32_bf16 v[108:111], v[184:187], a[76:79], v[108:111]
    s_mul_i32 s71, s71, 18
    s_add_u32 s71, s71, s75
    v_mfma_f32_16x16x32_bf16 v[112:115], v[188:191], a[64:67], v[112:115]
    s_lshl_b32 s75, s71, 17
    s_add_u32 s54, s75, s18
    v_mfma_f32_16x16x32_bf16 v[116:119], v[188:191], a[68:71], v[116:119]
    buffer_load_dwordx4 v243, s[8:11], s66 offen offset:1024 lds
    s_mul_i32 s75, s71, 36864
    v_mfma_f32_16x16x32_bf16 v[120:123], v[188:191], a[72:75], v[120:123]
    s_add_u32 s0, s75, s74
    s_xor_b32 s71, s73, 3
    v_mfma_f32_16x16x32_bf16 v[124:127], v[188:191], a[76:79], v[124:127]
    s_and_b32 s75, s71, 1
    s_lshl_b32 s75, s75, 3
    v_mfma_f32_16x16x32_bf16 v[0:3], v[192:195], a[80:83], v[0:3]
    s_waitcnt lgkmcnt(0)
    s_barrier
    v_mfma_f32_16x16x32_bf16 v[4:7], v[192:195], a[84:87], v[4:7]
    s_waitcnt vmcnt(12)
    ds_read_b128 a[128:131], v246 offset:0
    v_mfma_f32_16x16x32_bf16 v[8:11], v[192:195], a[88:91], v[8:11]
    ds_read_b128 a[132:135], v246 offset:2048
    buffer_load_dwordx4 v244, s[8:11], s66 offen offset:2048 lds
    v_mfma_f32_16x16x32_bf16 v[12:15], v[192:195], a[92:95], v[12:15]
    ds_read_b128 a[136:139], v246 offset:4096
    s_lshl2_add_u32 s76, s16, s71
    v_mfma_f32_16x16x32_bf16 v[16:19], v[196:199], a[80:83], v[16:19]
    ds_read_b128 a[140:143], v246 offset:6144
    s_cmp_eq_u32 s76, 7
    s_cselect_b32 s75, 10, s75
    v_mfma_f32_16x16x32_bf16 v[20:23], v[196:199], a[84:87], v[20:23]
    ds_read_b64_tr_b16 v[160:161], v228 offset:4096
    s_lshr_b32 s71, s71, 1
    v_mfma_f32_16x16x32_bf16 v[24:27], v[196:199], a[88:91], v[24:27]
    ds_read_b64_tr_b16 v[162:163], v228 offset:4608
    buffer_load_dwordx4 v245, s[8:11], s66 offen offset:3072 lds
    v_mfma_f32_16x16x32_bf16 v[28:31], v[196:199], a[92:95], v[28:31]
    ds_read_b64_tr_b16 v[164:165], v228 offset:5120
    s_mul_i32 s71, s71, 18
    v_mfma_f32_16x16x32_bf16 v[32:35], v[200:203], a[80:83], v[32:35]
    ds_read_b64_tr_b16 v[166:167], v228 offset:5632
    s_add_u32 s71, s71, s75
    v_mfma_f32_16x16x32_bf16 v[36:39], v[200:203], a[84:87], v[36:39]
    s_add_u32 m0, s51, 114688
    s_add_u32 s66, s48, s96
    v_mfma_f32_16x16x32_bf16 v[40:43], v[200:203], a[88:91], v[40:43]
    ds_read_b128 a[144:147], v247 offset:0
    s_lshl_b32 s75, s71, 17
    v_mfma_f32_16x16x32_bf16 v[44:47], v[200:203], a[92:95], v[44:47]
    ds_read_b128 a[148:151], v247 offset:2048
    buffer_load_dwordx4 v248, s[20:23], s66 offen lds
    v_mfma_f32_16x16x32_bf16 v[48:51], v[204:207], a[80:83], v[48:51]
    ds_read_b128 a[152:155], v247 offset:4096
    s_add_u32 s55, s75, s18
    v_mfma_f32_16x16x32_bf16 v[52:55], v[204:207], a[84:87], v[52:55]
    ds_read_b128 a[156:159], v247 offset:6144
    s_mul_i32 s75, s71, 36864
    v_mfma_f32_16x16x32_bf16 v[56:59], v[204:207], a[88:91], v[56:59]
    ds_read_b64_tr_b16 v[168:169], v229 offset:4096
    s_add_u32 s29, s75, s74
    v_mfma_f32_16x16x32_bf16 v[60:63], v[204:207], a[92:95], v[60:63]
    ds_read_b64_tr_b16 v[170:171], v229 offset:4608
    buffer_load_dwordx4 v248, s[24:27], s66 offen offset:1024 lds
    v_mfma_f32_16x16x32_bf16 v[64:67], v[208:211], a[80:83], v[64:67]
    ds_read_b64_tr_b16 v[172:173], v229 offset:5120
    s_lshl_b32 s28, s72, 8
    v_mfma_f32_16x16x32_bf16 v[68:71], v[208:211], a[84:87], v[68:71]
    ds_read_b64_tr_b16 v[174:175], v229 offset:5632
    s_add_u32 s28, s28, s2
    v_mfma_f32_16x16x32_bf16 v[72:75], v[208:211], a[88:91], v[72:75]
    s_add_u32 m0, s51, 122880
    s_add_u32 s66, s66, 294912
    v_mfma_f32_16x16x32_bf16 v[76:79], v[208:211], a[92:95], v[76:79]
    ds_read_b64_tr_b16 v[176:177], v230 offset:4096
    s_lshl_b32 s28, s28, 12
    v_mfma_f32_16x16x32_bf16 v[80:83], v[212:215], a[80:83], v[80:83]
    ds_read_b64_tr_b16 v[178:179], v230 offset:4608
    buffer_load_dwordx4 v248, s[20:23], s66 offen lds
    v_mfma_f32_16x16x32_bf16 v[84:87], v[212:215], a[84:87], v[84:87]
    ds_read_b64_tr_b16 v[180:181], v230 offset:5120
    s_and_b32 s73, s17, 1
    v_mfma_f32_16x16x32_bf16 v[88:91], v[212:215], a[88:91], v[88:91]
    ds_read_b64_tr_b16 v[182:183], v230 offset:5632
    s_lshl_b32 s73, s73, 11
    v_mfma_f32_16x16x32_bf16 v[92:95], v[212:215], a[92:95], v[92:95]
    ds_read_b64_tr_b16 v[184:185], v231 offset:4096
    s_add_u32 s28, s28, s73
    v_mfma_f32_16x16x32_bf16 v[96:99], v[216:219], a[80:83], v[96:99]
    ds_read_b64_tr_b16 v[186:187], v231 offset:4608
    buffer_load_dwordx4 v248, s[24:27], s66 offen offset:1024 lds
    v_mfma_f32_16x16x32_bf16 v[100:103], v[216:219], a[84:87], v[100:103]
    ds_read_b64_tr_b16 v[188:189], v231 offset:5120
    s_add_u32 s28, s28, 24117248
    v_mfma_f32_16x16x32_bf16 v[104:107], v[216:219], a[88:91], v[104:107]
    ds_read_b64_tr_b16 v[190:191], v231 offset:5632
    s_and_b32 s78, s2, 63
    v_mfma_f32_16x16x32_bf16 v[108:111], v[216:219], a[92:95], v[108:111]
    s_add_u32 m0, s51, 131072
    s_add_u32 s66, s66, 294912
    v_mfma_f32_16x16x32_bf16 v[112:115], v[220:223], a[80:83], v[112:115]
    s_lshl_b32 s78, s78, 12
    s_add_u32 s78, s78, 26214400
    v_mfma_f32_16x16x32_bf16 v[116:119], v[220:223], a[84:87], v[116:119]
    buffer_load_dwordx4 v248, s[20:23], s66 offen lds
    s_mul_i32 s80, s79, 24576
    v_mfma_f32_16x16x32_bf16 v[120:123], v[220:223], a[88:91], v[120:123]
    s_add_u32 s80, s80, s51
    s_add_u32 s80, s80, 28311552
    v_mfma_f32_16x16x32_bf16 v[124:127], v[220:223], a[92:95], v[124:127]
    s_sub_u32 s80, s80, s3
    s_andn2_b32 s81, s79, 15
    s_waitcnt lgkmcnt(2)
    v_mfma_f32_16x16x32_bf16 v[0:3], v[160:163], a[96:99], v[0:3]
    ds_read_b64_tr_b16 v[192:193], v228 offset:12288
    v_mfma_f32_16x16x32_bf16 v[4:7], v[160:163], a[100:103], v[4:7]
    ds_read_b64_tr_b16 v[194:195], v228 offset:12800
    buffer_load_dwordx4 v248, s[24:27], s66 offen offset:1024 lds
    v_mfma_f32_16x16x32_bf16 v[8:11], v[160:163], a[104:107], v[8:11]
    s_lshl_b32 s81, s81, 14
    s_add_u32 s81, s81, s1
    v_mfma_f32_16x16x32_bf16 v[12:15], v[160:163], a[108:111], v[12:15]
    ds_read_b64_tr_b16 v[196:197], v228 offset:13312
    s_lshl_b32 s73, s14, 2
    v_mfma_f32_16x16x32_bf16 v[16:19], v[164:167], a[96:99], v[16:19]
    s_add_u32 m0, s70, 0
    s_add_u32 s66, s68, s99
    v_mfma_f32_16x16x32_bf16 v[20:23], v[164:167], a[100:103], v[20:23]
    ds_read_b64_tr_b16 v[198:199], v228 offset:13824
    s_add_u32 s73, s73, s16
    v_mfma_f32_16x16x32_bf16 v[24:27], v[164:167], a[104:107], v[24:27]
    buffer_load_dwordx4 v242, s[8:11], s66 offen offset:0 lds
    s_lshl_b32 s73, s73, 8
    v_mfma_f32_16x16x32_bf16 v[28:31], v[164:167], a[108:111], v[28:31]
    ds_read_b64_tr_b16 v[200:201], v229 offset:12288
    s_add_u32 s81, s81, s73
    v_mfma_f32_16x16x32_bf16 v[32:35], v[168:171], a[96:99], v[32:35]
    ds_read_b64_tr_b16 v[202:203], v229 offset:12800
    s_add_u32 s81, s81, 39845888
    v_mfma_f32_16x16x32_bf16 v[36:39], v[168:171], a[100:103], v[36:39]
    s_and_b32 s73, s16, 1
    s_xor_b32 s73, s73, 1
    v_mfma_f32_16x16x32_bf16 v[40:43], v[168:171], a[104:107], v[40:43]
    ds_read_b64_tr_b16 v[204:205], v229 offset:13312
    buffer_load_dwordx4 v243, s[8:11], s66 offen offset:1024 lds
    v_mfma_f32_16x16x32_bf16 v[44:47], v[168:171], a[108:111], v[44:47]
    s_lshl_b32 s73, s73, 17
    s_add_u32 s81, s81, s73
    v_mfma_f32_16x16x32_bf16 v[48:51], v[172:175], a[96:99], v[48:51]
    ds_read_b64_tr_b16 v[206:207], v229 offset:13824
    s_and_b32 s71, s2, 1
    v_mfma_f32_16x16x32_bf16 v[52:55], v[172:175], a[100:103], v[52:55]
    s_lshl_b32 s71, s71, 4
    s_xor_b32 s71, s71, 16
    v_mfma_f32_16x16x32_bf16 v[56:59], v[172:175], a[104:107], v[56:59]
    ds_read_b64_tr_b16 v[208:209], v230 offset:12288
    s_lshl_b32 s100, s100, s71
    v_mfma_f32_16x16x32_bf16 v[60:63], v[172:175], a[108:111], v[60:63]
    ds_read_b64_tr_b16 v[210:211], v230 offset:12800
    buffer_load_dwordx4 v244, s[8:11], s66 offen offset:2048 lds
    v_mfma_f32_16x16x32_bf16 v[64:67], v[176:179], a[96:99], v[64:67]
    s_and_b32 s100, s100, s31
    s_lshl_b32 s101, s101, s71
    v_mfma_f32_16x16x32_bf16 v[68:71], v[176:179], a[100:103], v[68:71]
    ds_read_b64_tr_b16 v[212:213], v230 offset:13312
    s_and_b32 s101, s101, s31
    v_mfma_f32_16x16x32_bf16 v[72:75], v[176:179], a[104:107], v[72:75]
    v_and_b32 v236, v236, v237
    v_and_b32 v238, v238, v239
    v_mfma_f32_16x16x32_bf16 v[76:79], v[176:179], a[108:111], v[76:79]
    ds_read_b64_tr_b16 v[214:215], v230 offset:13824
    buffer_load_dwordx4 v245, s[8:11], s66 offen offset:3072 lds
    v_mfma_f32_16x16x32_bf16 v[80:83], v[180:183], a[96:99], v[80:83]
    v_and_b32 v236, v236, v238
    v_cmp_eq_u32 vcc, 0x01010101, v236
    s_cmp_eq_u64 vcc, exec
    s_cbranch_scc0 gated_mix__ssm_conv_s4__glu_gated_bilinear__prompt_kernel_slow1
gated_mix__ssm_conv_s4__glu_gated_bilinear__prompt_kernel_back1:
    v_mfma_f32_16x16x32_bf16 v[84:87], v[180:183], a[100:103], v[84:87]
    ds_read_b64_tr_b16 v[216:217], v231 offset:12288
    v_mov_b32 v240, 1
    v_mfma_f32_16x16x32_bf16 v[88:91], v[180:183], a[104:107], v[88:91]
    ds_read_b64_tr_b16 v[218:219], v231 offset:12800
    s_add_u32 m0, s70, 4096
    v_mfma_f32_16x16x32_bf16 v[92:95], v[180:183], a[108:111], v[92:95]
    s_add_u32 s66, s69, s99
    s_lshl_b32 s75, s17, 26
    v_mfma_f32_16x16x32_bf16 v[96:99], v[184:187], a[96:99], v[96:99]
    ds_read_b64_tr_b16 v[220:221], v231 offset:13312
    buffer_load_dwordx4 v242, s[8:11], s66 offen offset:0 lds
    v_mfma_f32_16x16x32_bf16 v[100:103], v[184:187], a[100:103], v[100:103]
    s_add_u32 s75, s75, s2
    s_lshl_b32 s75, s75, 2
    v_mfma_f32_16x16x32_bf16 v[104:107], v[184:187], a[104:107], v[104:107]
    ds_read_b64_tr_b16 v[222:223], v231 offset:13824
    s_add_u32 s75, s75, 131072
    v_mfma_f32_16x16x32_bf16 v[108:111], v[184:187], a[108:111], v[108:111]
    v_mov_b32 v236, -1
    v_mov_b32 v237, -1
    s_waitcnt lgkmcnt(4)
    v_mfma_f32_16x16x32_bf16 v[112:115], v[188:191], a[96:99], v[112:115]
    buffer_load_dwordx4 v243, s[8:11], s66 offen offset:1024 lds
    v_mfma_f32_16x16x32_bf16 v[116:119], v[188:191], a[100:103], v[116:119]
    v_mov_b32 v238, -1
    v_mov_b32 v239, -1
    v_mfma_f32_16x16x32_bf16 v[120:123], v[188:191], a[104:107], v[120:123]
    buffer_store_dword v240, off, s[36:39], s75 sc1
    v_mfma_f32_16x16x32_bf16 v[124:127], v[188:191], a[108:111], v[124:127]
    v_mfma_f32_16x16x32_bf16 v[0:3], v[192:195], a[112:115], v[0:3]
    s_waitcnt vmcnt(13)
    ds_read_b128 a[160:163], v246 offset:32768
    v_mfma_f32_16x16x32_bf16 v[4:7], v[192:195], a[116:119], v[4:7]
    ds_read_b128 a[164:167], v246 offset:34816
    v_mfma_f32_16x16x32_bf16 v[8:11], v[192:195], a[120:123], v[8:11]
    ds_read_b128 a[168:171], v246 offset:36864
    buffer_load_dwordx4 v244, s[8:11], s66 offen offset:2048 lds
    v_mfma_f32_16x16x32_bf16 v[12:15], v[192:195], a[124:127], v[12:15]
    ds_read_b128 a[172:175], v246 offset:38912
    v_mfma_f32_16x16x32_bf16 v[16:19], v[196:199], a[112:115], v[16:19]
    ds_read_b64_tr_b16 v[160:161], v228 offset:20480
    v_mfma_f32_16x16x32_bf16 v[20:23], v[196:199], a[116:119], v[20:23]
    ds_read_b64_tr_b16 v[162:163], v228 offset:20992
    v_mfma_f32_16x16x32_bf16 v[24:27], v[196:199], a[120:123], v[24:27]
    v_mfma_f32_16x16x32_bf16 v[28:31], v[196:199], a[124:127], v[28:31]
    ds_read_b64_tr_b16 v[164:165], v228 offset:21504
    buffer_load_dwordx4 v245, s[8:11], s66 offen offset:3072 lds
    v_mfma_f32_16x16x32_bf16 v[32:35], v[200:203], a[112:115], v[32:35]
    ds_read_b64_tr_b16 v[166:167], v228 offset:22016
    v_mfma_f32_16x16x32_bf16 v[36:39], v[200:203], a[116:119], v[36:39]
    ds_read_b128 a[176:179], v247 offset:32768
    v_mfma_f32_16x16x32_bf16 v[40:43], v[200:203], a[120:123], v[40:43]
    ds_read_b128 a[180:183], v247 offset:34816
    v_mfma_f32_16x16x32_bf16 v[44:47], v[200:203], a[124:127], v[44:47]
    ds_read_b128 a[184:187], v247 offset:36864
    buffer_load_dword v241, v254, s[40:43], 0 offen offset:128
    v_mfma_f32_16x16x32_bf16 v[48:51], v[204:207], a[112:115], v[48:51]
    ds_read_b128 a[188:191], v247 offset:38912
    v_mfma_f32_16x16x32_bf16 v[52:55], v[204:207], a[116:119], v[52:55]
    v_mfma_f32_16x16x32_bf16 v[56:59], v[204:207], a[120:123], v[56:59]
    ds_read_b64_tr_b16 v[168:169], v229 offset:20480
    v_mfma_f32_16x16x32_bf16 v[60:63], v[204:207], a[124:127], v[60:63]
    ds_read_b64_tr_b16 v[170:171], v229 offset:20992
    v_mfma_f32_16x16x32_bf16 v[64:67], v[208:211], a[112:115], v[64:67]
    ds_read_b64_tr_b16 v[172:173], v229 offset:21504
    s_waitcnt lgkmcnt(3)
    v_mfma_f32_16x16x32_bf16 v[68:71], v[208:211], a[116:119], v[68:71]
    ds_read_b64_tr_b16 v[174:175], v229 offset:22016
    s_add_u32 m0, s70, 32768
    v_mfma_f32_16x16x32_bf16 v[72:75], v[208:211], a[120:123], v[72:75]
    ds_read_b64_tr_b16 v[176:177], v230 offset:20480
    s_add_u32 s66, s68, s99
    v_mfma_f32_16x16x32_bf16 v[76:79], v[208:211], a[124:127], v[76:79]
    ds_read_b64_tr_b16 v[178:179], v230 offset:20992
    s_add_u32 s66, s66, 128
    v_mfma_f32_16x16x32_bf16 v[80:83], v[212:215], a[112:115], v[80:83]
    buffer_load_dwordx4 v242, s[8:11], s66 offen offset:0 lds
    v_mfma_f32_16x16x32_bf16 v[84:87], v[212:215], a[116:119], v[84:87]
    ds_read_b64_tr_b16 v[180:181], v230 offset:21504
    v_mfma_f32_16x16x32_bf16 v[88:91], v[212:215], a[120:123], v[88:91]
    ds_read_b64_tr_b16 v[182:183], v230 offset:22016
    v_mfma_f32_16x16x32_bf16 v[92:95], v[212:215], a[124:127], v[92:95]
    ds_read_b64_tr_b16 v[184:185], v231 offset:20480
    buffer_load_dwordx4 v243, s[8:11], s66 offen offset:1024 lds
    v_mfma_f32_16x16x32_bf16 v[96:99], v[216:219], a[112:115], v[96:99]
    ds_read_b64_tr_b16 v[186:187], v231 offset:20992
    v_mfma_f32_16x16x32_bf16 v[100:103], v[216:219], a[116:119], v[100:103]
    ds_read_b64_tr_b16 v[188:189], v231 offset:21504
    v_mfma_f32_16x16x32_bf16 v[104:107], v[216:219], a[120:123], v[104:107]
    ds_read_b64_tr_b16 v[190:191], v231 offset:22016
    v_mfma_f32_16x16x32_bf16 v[108:111], v[216:219], a[124:127], v[108:111]
    buffer_load_dwordx4 v244, s[8:11], s66 offen offset:2048 lds
    v_mfma_f32_16x16x32_bf16 v[112:115], v[220:223], a[112:115], v[112:115]
    v_mfma_f32_16x16x32_bf16 v[116:119], v[220:223], a[116:119], v[116:119]
    v_mfma_f32_16x16x32_bf16 v[120:123], v[220:223], a[120:123], v[120:123]
    v_mfma_f32_16x16x32_bf16 v[124:127], v[220:223], a[124:127], v[124:127]
    v_mfma_f32_16x16x32_bf16 v[0:3], v[160:163], a[128:131], v[0:3]
    s_waitcnt lgkmcnt(0)
    s_barrier
    v_mfma_f32_16x16x32_bf16 v[4:7], v[160:163], a[132:135], v[4:7]
    ds_read_b64_tr_b16 v[192:193], v228 offset:28672
    buffer_load_dwordx4 v245, s[8:11], s66 offen offset:3072 lds
    v_mfma_f32_16x16x32_bf16 v[8:11], v[160:163], a[136:139], v[8:11]
    ds_read_b64_tr_b16 v[194:195], v228 offset:29184
    s_add_u32 m0, s70, 36864
    v_mfma_f32_16x16x32_bf16 v[12:15], v[160:163], a[140:143], v[12:15]
    s_add_u32 s66, s69, s99
    s_add_u32 s66, s66, 128
    v_mfma_f32_16x16x32_bf16 v[16:19], v[164:167], a[128:131], v[16:19]
    ds_read_b64_tr_b16 v[196:197], v228 offset:29696
    buffer_load_dwordx4 v242, s[8:11], s66 offen offset:0 lds
    v_mfma_f32_16x16x32_bf16 v[20:23], v[164:167], a[132:135], v[20:23]
    v_mfma_f32_16x16x32_bf16 v[24:27], v[164:167], a[136:139], v[24:27]
    ds_read_b64_tr_b16 v[198:199], v228 offset:30208
    v_mfma_f32_16x16x32_bf16 v[28:31], v[164:167], a[140:143], v[28:31]
    ds_read_b64_tr_b16 v[200:201], v229 offset:28672
    v_mfma_f32_16x16x32_bf16 v[32:35], v[168:171], a[128:131], v[32:35]
    v_mfma_f32_16x16x32_bf16 v[36:39], v[168:171], a[132:135], v[36:39]
    ds_read_b64_tr_b16 v[202:203], v229 offset:29184
    buffer_load_dwordx4 v243, s[8:11], s66 offen offset:1024 lds
    v_mfma_f32_16x16x32_bf16 v[40:43], v[168:171], a[136:139], v[40:43]
    v_mfma_f32_16x16x32_bf16 v[44:47], v[168:171], a[140:143], v[44:47]
    ds_read_b64_tr_b16 v[204:205], v229 offset:29696
    v_mfma_f32_16x16x32_bf16 v[48:51], v[172:175], a[128:131], v[48:51]
    ds_read_b64_tr_b16 v[206:207], v229 offset:30208
    v_mfma_f32_16x16x32_bf16 v[52:55], v[172:175], a[132:135], v[52:55]
    buffer_load_dwordx4 v244, s[8:11], s66 offen offset:2048 lds
    v_mfma_f32_16x16x32_bf16 v[56:59], v[172:175], a[136:139], v[56:59]
    ds_read_b64_tr_b16 v[208:209], v230 offset:28672
    v_mfma_f32_16x16x32_bf16 v[60:63], v[172:175], a[140:143], v[60:63]
    v_mfma_f32_16x16x32_bf16 v[64:67], v[176:179], a[128:131], v[64:67]
    ds_read_b64_tr_b16 v[210:211], v230 offset:29184
    v_mfma_f32_16x16x32_bf16 v[68:71], v[176:179], a[132:135], v[68:71]
    ds_read_b64_tr_b16 v[212:213], v230 offset:29696
    v_mfma_f32_16x16x32_bf16 v[72:75], v[176:179], a[136:139], v[72:75]
    buffer_load_dwordx4 v245, s[8:11], s66 offen offset:3072 lds
    v_mfma_f32_16x16x32_bf16 v[76:79], v[176:179], a[140:143], v[76:79]
    ds_read_b64_tr_b16 v[214:215], v230 offset:30208
    v_mfma_f32_16x16x32_bf16 v[80:83], v[180:183], a[128:131], v[80:83]
    s_add_u32 m0, s51, 139264
    s_add_u32 s66, s48, s96
    v_mfma_f32_16x16x32_bf16 v[84:87], v[180:183], a[132:135], v[84:87]
    ds_read_b64_tr_b16 v[216:217], v231 offset:28672
    s_add_u32 s66, s66, 884736
    v_mfma_f32_16x16x32_bf16 v[88:91], v[180:183], a[136:139], v[88:91]
    ds_read_b64_tr_b16 v[218:219], v231 offset:29184
    buffer_load_dwordx4 v248, s[20:23], s66 offen lds
    v_mfma_f32_16x16x32_bf16 v[92:95], v[180:183], a[140:143], v[92:95]
    v_mfma_f32_16x16x32_bf16 v[96:99], v[184:187], a[128:131], v[96:99]
    ds_read_b64_tr_b16 v[220:221], v231 offset:29696
    v_mfma_f32_16x16x32_bf16 v[100:103], v[184:187], a[132:135], v[100:103]
    v_mfma_f32_16x16x32_bf16 v[104:107], v[184:187], a[136:139], v[104:107]
    ds_read_b64_tr_b16 v[222:223], v231 offset:30208
    v_mfma_f32_16x16x32_bf16 v[108:111], v[184:187], a[140:143], v[108:111]
    buffer_load_dwordx4 v248, s[24:27], s66 offen offset:1024 lds
    v_mfma_f32_16x16x32_bf16 v[112:115], v[188:191], a[128:131], v[112:115]
    v_mfma_f32_16x16x32_bf16 v[116:119], v[188:191], a[132:135], v[116:119]
    s_add_u32 m0, s51, 147456
    s_add_u32 s66, s66, 294912
    v_mfma_f32_16x16x32_bf16 v[120:123], v[188:191], a[136:139], v[120:123]
    v_mfma_f32_16x16x32_bf16 v[124:127], v[188:191], a[140:143], v[124:127]
    buffer_load_dwordx4 v248, s[20:23], s66 offen lds
    s_waitcnt lgkmcnt(1)
    v_mfma_f32_16x16x32_bf16 v[0:3], v[192:195], a[144:147], v[0:3]
    s_waitcnt vmcnt(12)
    ds_read_b128 a[192:195], v246 offset:0
    v_mfma_f32_16x16x32_bf16 v[4:7], v[192:195], a[148:151], v[4:7]
    ds_read_b128 a[196:199], v246 offset:2048
    v_mfma_f32_16x16x32_bf16 v[8:11], v[192:195], a[152:155], v[8:11]
    ds_read_b128 a[200:203], v246 offset:4096
    v_mfma_f32_16x16x32_bf16 v[12:15], v[192:195], a[156:159], v[12:15]
    ds_read_b128 a[204:207], v246 offset:6144
    v_mfma_f32_16x16x32_bf16 v[16:19], v[196:199], a[144:147], v[16:19]
    ds_read_b64_tr_b16 v[160:161], v228 offset:36864
    buffer_load_dwordx4 v248, s[24:27], s66 offen offset:1024 lds
    v_mfma_f32_16x16x32_bf16 v[20:23], v[196:199], a[148:151], v[20:23]
    ds_read_b64_tr_b16 v[162:163], v228 offset:37376
    v_mfma_f32_16x16x32_bf16 v[24:27], v[196:199], a[152:155], v[24:27]
    s_add_u32 m0, s51, 155648
    s_add_u32 s66, s66, 294912
    v_mfma_f32_16x16x32_bf16 v[28:31], v[196:199], a[156:159], v[28:31]
    ds_read_b64_tr_b16 v[164:165], v228 offset:37888
    v_mfma_f32_16x16x32_bf16 v[32:35], v[200:203], a[144:147], v[32:35]
    ds_read_b64_tr_b16 v[166:167], v228 offset:38400
    buffer_load_dwordx4 v248, s[20:23], s66 offen lds
    v_mfma_f32_16x16x32_bf16 v[36:39], v[200:203], a[148:151], v[36:39]
    ds_read_b128 a[208:211], v247 offset:0
    v_mfma_f32_16x16x32_bf16 v[40:43], v[200:203], a[152:155], v[40:43]
    ds_read_b128 a[212:215], v247 offset:2048
    v_mfma_f32_16x16x32_bf16 v[44:47], v[200:203], a[156:159], v[44:47]
    ds_read_b128 a[216:219], v247 offset:4096
    v_mfma_f32_16x16x32_bf16 v[48:51], v[204:207], a[144:147], v[48:51]
    ds_read_b128 a[220:223], v247 offset:6144
    v_mfma_f32_16x16x32_bf16 v[52:55], v[204:207], a[148:151], v[52:55]
    buffer_load_dwordx4 v248, s[24:27], s66 offen offset:1024 lds
    v_mfma_f32_16x16x32_bf16 v[56:59], v[204:207], a[152:155], v[56:59]
    ds_read_b64_tr_b16 v[168:169], v229 offset:36864
    v_mfma_f32_16x16x32_bf16 v[60:63], v[204:207], a[156:159], v[60:63]
    ds_read_b64_tr_b16 v[170:171], v229 offset:37376
    s_waitcnt lgkmcnt(2)
    v_mfma_f32_16x16x32_bf16 v[64:67], v[208:211], a[144:147], v[64:67]
    ds_read_b64_tr_b16 v[172:173], v229 offset:37888
    s_add_u32 m0, s70, 0
    v_mfma_f32_16x16x32_bf16 v[68:71], v[208:211], a[148:151], v[68:71]
    ds_read_b64_tr_b16 v[174:175], v229 offset:38400
    s_add_u32 s66, s68, s99
    v_mfma_f32_16x16x32_bf16 v[72:75], v[208:211], a[152:155], v[72:75]
    ds_read_b64_tr_b16 v[176:177], v230 offset:36864
    s_add_u32 s66, s66, 256
    v_mfma_f32_16x16x32_bf16 v[76:79], v[208:211], a[156:159], v[76:79]
    ds_read_b64_tr_b16 v[178:179], v230 offset:37376
    buffer_load_dwordx4 v242, s[8:11], s66 offen offset:0 lds
    v_mfma_f32_16x16x32_bf16 v[80:83], v[212:215], a[144:147], v[80:83]
    v_mfma_f32_16x16x32_bf16 v[84:87], v[212:215], a[148:151], v[84:87]
    ds_read_b64_tr_b16 v[180:181], v230 offset:37888
    v_mfma_f32_16x16x32_bf16 v[88:91], v[212:215], a[152:155], v[88:91]
    ds_read_b64_tr_b16 v[182:183], v230 offset:38400
    buffer_load_dwordx4 v243, s[8:11], s66 offen offset:1024 lds
    v_mfma_f32_16x16x32_bf16 v[92:95], v[212:215], a[156:159], v[92:95]
    ds_read_b64_tr_b16 v[184:185], v231 offset:36864
    v_mfma_f32_16x16x32_bf16 v[96:99], v[216:219], a[144:147], v[96:99]
    ds_read_b64_tr_b16 v[186:187], v231 offset:37376
    v_mfma_f32_16x16x32_bf16 v[100:103], v[216:219], a[148:151], v[100:103]
    ds_read_b64_tr_b16 v[188:189], v231 offset:37888
    v_mfma_f32_16x16x32_bf16 v[104:107], v[216:219], a[152:155], v[104:107]
    ds_read_b64_tr_b16 v[190:191], v231 offset:38400
    buffer_load_dwordx4 v244, s[8:11], s66 offen offset:2048 lds
    v_mfma_f32_16x16x32_bf16 v[108:111], v[216:219], a[156:159], v[108:111]
    v_mfma_f32_16x16x32_bf16 v[112:115], v[220:223], a[144:147], v[112:115]
    v_mfma_f32_16x16x32_bf16 v[116:119], v[220:223], a[148:151], v[116:119]
    v_mfma_f32_16x16x32_bf16 v[120:123], v[220:223], a[152:155], v[120:123]
    v_mfma_f32_16x16x32_bf16 v[124:127], v[220:223], a[156:159], v[124:127]
    buffer_load_dwordx4 v245, s[8:11], s66 offen offset:3072 lds
    v_mfma_f32_16x16x32_bf16 v[0:3], v[160:163], a[160:163], v[0:3]
    ds_read_b64_tr_b16 v[192:193], v228 offset:45056
    v_mfma_f32_16x16x32_bf16 v[4:7], v[160:163], a[164:167], v[4:7]
    ds_read_b64_tr_b16 v[194:195], v228 offset:45568
    s_add_u32 m0, s70, 4096
    v_mfma_f32_16x16x32_bf16 v[8:11], v[160:163], a[168:171], v[8:11]
    s_add_u32 s66, s69, s99
    s_add_u32 s66, s66, 256
    v_mfma_f32_16x16x32_bf16 v[12:15], v[160:163], a[172:175], v[12:15]
    ds_read_b64_tr_b16 v[196:197], v228 offset:46080
    buffer_load_dwordx4 v242, s[8:11], s66 offen offset:0 lds
    v_mfma_f32_16x16x32_bf16 v[16:19], v[164:167], a[160:163], v[16:19]
    v_mfma_f32_16x16x32_bf16 v[20:23], v[164:167], a[164:167], v[20:23]
    ds_read_b64_tr_b16 v[198:199], v228 offset:46592
    v_mfma_f32_16x16x32_bf16 v[24:27], v[164:167], a[168:171], v[24:27]
    v_mfma_f32_16x16x32_bf16 v[28:31], v[164:167], a[172:175], v[28:31]
    ds_read_b64_tr_b16 v[200:201], v229 offset:45056
    s_waitcnt lgkmcnt(4)
    v_mfma_f32_16x16x32_bf16 v[32:35], v[168:171], a[160:163], v[32:35]
    ds_read_b64_tr_b16 v[202:203], v229 offset:45568
    v_mfma_f32_16x16x32_bf16 v[36:39], v[168:171], a[164:167], v[36:39]
    buffer_load_dwordx4 v243, s[8:11], s66 offen offset:1024 lds
    v_mfma_f32_16x16x32_bf16 v[40:43], v[168:171], a[168:171], v[40:43]
    ds_read_b64_tr_b16 v[204:205], v229 offset:46080
    v_mfma_f32_16x16x32_bf16 v[44:47], v[168:171], a[172:175], v[44:47]
    v_mfma_f32_16x16x32_bf16 v[48:51], v[172:175], a[160:163], v[48:51]
    ds_read_b64_tr_b16 v[206:207], v229 offset:46592
    buffer_load_dwordx4 v244, s[8:11], s66 offen offset:2048 lds
    v_mfma_f32_16x16x32_bf16 v[52:55], v[172:175], a[164:167], v[52:55]
    v_mfma_f32_16x16x32_bf16 v[56:59], v[172:175], a[168:171], v[56:59]
    ds_read_b64_tr_b16 v[208:209], v230 offset:45056
    v_mfma_f32_16x16x32_bf16 v[60:63], v[172:175], a[172:175], v[60:63]
    ds_read_b64_tr_b16 v[210:211], v230 offset:45568
    v_mfma_f32_16x16x32_bf16 v[64:67], v[176:179], a[160:163], v[64:67]
    v_mfma_f32_16x16x32_bf16 v[68:71], v[176:179], a[164:167], v[68:71]
    ds_read_b64_tr_b16 v[212:213], v230 offset:46080
    buffer_load_dwordx4 v245, s[8:11], s66 offen offset:3072 lds
    v_mfma_f32_16x16x32_bf16 v[72:75], v[176:179], a[168:171], v[72:75]
    v_mfma_f32_16x16x32_bf16 v[76:79], v[176:179], a[172:175], v[76:79]
    ds_read_b64_tr_b16 v[214:215], v230 offset:46592
    s_add_u32 m0, s51, 65536
    v_mfma_f32_16x16x32_bf16 v[80:83], v[180:183], a[160:163], v[80:83]
    s_add_u32 s66, s49, s94
    v_mfma_f32_16x16x32_bf16 v[84:87], v[180:183], a[164:167], v[84:87]
    ds_read_b64_tr_b16 v[216:217], v231 offset:45056
    buffer_load_dwordx4 v248, s[20:23], s66 offen lds
    v_mfma_f32_16x16x32_bf16 v[88:91], v[180:183], a[168:171], v[88:91]
    ds_read_b64_tr_b16 v[218:219], v231 offset:45568
    v_mfma_f32_16x16x32_bf16 v[92:95], v[180:183], a[172:175], v[92:95]
    v_mfma_f32_16x16x32_bf16 v[96:99], v[184:187], a[160:163], v[96:99]
    ds_read_b64_tr_b16 v[220:221], v231 offset:46080
    v_mfma_f32_16x16x32_bf16 v[100:103], v[184:187], a[164:167], v[100:103]
    v_mfma_f32_16x16x32_bf16 v[104:107], v[184:187], a[168:171], v[104:107]
    ds_read_b64_tr_b16 v[222:223], v231 offset:46592
    buffer_load_dwordx4 v248, s[24:27], s66 offen offset:1024 lds
    v_mfma_f32_16x16x32_bf16 v[108:111], v[184:187], a[172:175], v[108:111]
    v_mfma_f32_16x16x32_bf16 v[112:115], v[188:191], a[160:163], v[112:115]
    s_add_u32 m0, s51, 73728
    s_add_u32 s66, s66, 294912
    v_mfma_f32_16x16x32_bf16 v[116:119], v[188:191], a[164:167], v[116:119]
    v_mfma_f32_16x16x32_bf16 v[120:123], v[188:191], a[168:171], v[120:123]
    buffer_load_dwordx4 v248, s[20:23], s66 offen lds
    v_mfma_f32_16x16x32_bf16 v[124:127], v[188:191], a[172:175], v[124:127]
    s_waitcnt lgkmcnt(1)
    v_mfma_f32_16x16x32_bf16 v[0:3], v[192:195], a[176:179], v[0:3]
    s_waitcnt lgkmcnt(0)
    s_barrier
    v_mfma_f32_16x16x32_bf16 v[4:7], v[192:195], a[180:183], v[4:7]
    s_waitcnt vmcnt(17)
    ds_read_b128 a[224:227], v246 offset:32768
    v_mfma_f32_16x16x32_bf16 v[8:11], v[192:195], a[184:187], v[8:11]
    ds_read_b128 a[228:231], v246 offset:34816
    v_mfma_f32_16x16x32_bf16 v[12:15], v[192:195], a[188:191], v[12:15]
    ds_read_b128 a[232:235], v246 offset:36864
    buffer_load_dwordx4 v248, s[24:27], s66 offen offset:1024 lds
    v_mfma_f32_16x16x32_bf16 v[16:19], v[196:199], a[176:179], v[16:19]
    ds_read_b128 a[236:239], v246 offset:38912
    v_mfma_f32_16x16x32_bf16 v[20:23], v[196:199], a[180:183], v[20:23]
    ds_read_b64_tr_b16 v[160:161], v228 offset:53248
    s_add_u32 m0, s51, 81920
    v_mfma_f32_16x16x32_bf16 v[24:27], v[196:199], a[184:187], v[24:27]
    ds_read_b64_tr_b16 v[162:163], v228 offset:53760
    s_add_u32 s66, s66, 294912
    v_mfma_f32_16x16x32_bf16 v[28:31], v[196:199], a[188:191], v[28:31]
    ds_read_b64_tr_b16 v[164:165], v228 offset:54272
    buffer_load_dwordx4 v248, s[20:23], s66 offen lds
    v_mfma_f32_16x16x32_bf16 v[32:35], v[200:203], a[176:179], v[32:35]
    ds_read_b64_tr_b16 v[166:167], v228 offset:54784
    v_mfma_f32_16x16x32_bf16 v[36:39], v[200:203], a[180:183], v[36:39]
    v_mfma_f32_16x16x32_bf16 v[40:43], v[200:203], a[184:187], v[40:43]
    ds_read_b128 a[240:243], v247 offset:32768
    v_mfma_f32_16x16x32_bf16 v[44:47], v[200:203], a[188:191], v[44:47]
    ds_read_b128 a[244:247], v247 offset:34816
    v_mfma_f32_16x16x32_bf16 v[48:51], v[204:207], a[176:179], v[48:51]
    ds_read_b128 a[248:251], v247 offset:36864
    buffer_load_dwordx4 v248, s[24:27], s66 offen offset:1024 lds
    v_mfma_f32_16x16x32_bf16 v[52:55], v[204:207], a[180:183], v[52:55]
    ds_read_b128 a[252:255], v247 offset:38912
    v_mfma_f32_16x16x32_bf16 v[56:59], v[204:207], a[184:187], v[56:59]
    ds_read_b64_tr_b16 v[168:169], v229 offset:53248
    v_mfma_f32_16x16x32_bf16 v[60:63], v[204:207], a[188:191], v[60:63]
    ds_read_b64_tr_b16 v[170:171], v229 offset:53760
    v_mfma_f32_16x16x32_bf16 v[64:67], v[208:211], a[176:179], v[64:67]
    ds_read_b64_tr_b16 v[172:173], v229 offset:54272
    buffer_load_dword v241, v254, s[40:43], 0 offen offset:256
    v_mfma_f32_16x16x32_bf16 v[68:71], v[208:211], a[180:183], v[68:71]
    ds_read_b64_tr_b16 v[174:175], v229 offset:54784
    v_mfma_f32_16x16x32_bf16 v[72:75], v[208:211], a[184:187], v[72:75]
    v_mfma_f32_16x16x32_bf16 v[76:79], v[208:211], a[188:191], v[76:79]
    ds_read_b64_tr_b16 v[176:177], v230 offset:53248
    v_mfma_f32_16x16x32_bf16 v[80:83], v[212:215], a[176:179], v[80:83]
    ds_read_b64_tr_b16 v[178:179], v230 offset:53760
    v_mfma_f32_16x16x32_bf16 v[84:87], v[212:215], a[180:183], v[84:87]
    ds_read_b64_tr_b16 v[180:181], v230 offset:54272
    s_add_u32 m0, s51, 90112
    v_mfma_f32_16x16x32_bf16 v[88:91], v[212:215], a[184:187], v[88:91]
    ds_read_b64_tr_b16 v[182:183], v230 offset:54784
    s_add_u32 s66, s49, s94
    v_mfma_f32_16x16x32_bf16 v[92:95], v[212:215], a[188:191], v[92:95]
    ds_read_b64_tr_b16 v[184:185], v231 offset:53248
    s_add_u32 s66, s66, 884736
    v_mfma_f32_16x16x32_bf16 v[96:99], v[216:219], a[176:179], v[96:99]
    ds_read_b64_tr_b16 v[186:187], v231 offset:53760
    buffer_load_dwordx4 v248, s[20:23], s66 offen lds
    v_mfma_f32_16x16x32_bf16 v[100:103], v[216:219], a[180:183], v[100:103]
    ds_read_b64_tr_b16 v[188:189], v231 offset:54272
    v_mfma_f32_16x16x32_bf16 v[104:107], v[216:219], a[184:187], v[104:107]
    ds_read_b64_tr_b16 v[190:191], v231 offset:54784
    v_mfma_f32_16x16x32_bf16 v[108:111], v[216:219], a[188:191], v[108:111]
    v_mfma_f32_16x16x32_bf16 v[112:115], v[220:223], a[176:179], v[112:115]
    buffer_load_dwordx4 v248, s[24:27], s66 offen offset:1024 lds
    v_mfma_f32_16x16x32_bf16 v[116:119], v[220:223], a[180:183], v[116:119]
    v_mfma_f32_16x16x32_bf16 v[120:123], v[220:223], a[184:187], v[120:123]
    s_add_u32 m0, s51, 98304
    s_add_u32 s66, s66, 294912
    v_mfma_f32_16x16x32_bf16 v[124:127], v[220:223], a[188:191], v[124:127]
    s_waitcnt lgkmcnt(2)
    v_mfma_f32_16x16x32_bf16 v[0:3], v[160:163], a[192:195], v[0:3]
    ds_read_b64_tr_b16 v[192:193], v232 offset:0
    v_mfma_f32_16x16x32_bf16 v[4:7], v[160:163], a[196:199], v[4:7]
    ds_read_b64_tr_b16 v[194:195], v232 offset:512
    buffer_load_dwordx4 v248, s[20:23], s66 offen lds
    v_mfma_f32_16x16x32_bf16 v[8:11], v[160:163], a[200:203], v[8:11]
    v_mfma_f32_16x16x32_bf16 v[12:15], v[160:163], a[204:207], v[12:15]
    ds_read_b64_tr_b16 v[196:197], v232 offset:1024
    v_mfma_f32_16x16x32_bf16 v[16:19], v[164:167], a[192:195], v[16:19]
    v_mfma_f32_16x16x32_bf16 v[20:23], v[164:167], a[196:199], v[20:23]
    ds_read_b64_tr_b16 v[198:199], v232 offset:1536
    buffer_load_dwordx4 v248, s[24:27], s66 offen offset:1024 lds
    v_mfma_f32_16x16x32_bf16 v[24:27], v[164:167], a[200:203], v[24:27]
    v_mfma_f32_16x16x32_bf16 v[28:31], v[164:167], a[204:207], v[28:31]
    ds_read_b64_tr_b16 v[200:201], v233 offset:0
    s_add_u32 m0, s51, 106496
    v_mfma_f32_16x16x32_bf16 v[32:35], v[168:171], a[192:195], v[32:35]
    ds_read_b64_tr_b16 v[202:203], v233 offset:512
    s_add_u32 s66, s66, 294912
    v_mfma_f32_16x16x32_bf16 v[36:39], v[168:171], a[196:199], v[36:39]
    buffer_load_dwordx4 v248, s[20:23], s66 offen lds
    v_mfma_f32_16x16x32_bf16 v[40:43], v[168:171], a[200:203], v[40:43]
    ds_read_b64_tr_b16 v[204:205], v233 offset:1024
    v_mfma_f32_16x16x32_bf16 v[44:47], v[168:171], a[204:207], v[44:47]
    v_mfma_f32_16x16x32_bf16 v[48:51], v[172:175], a[192:195], v[48:51]
    ds_read_b64_tr_b16 v[206:207], v233 offset:1536
    v_mfma_f32_16x16x32_bf16 v[52:55], v[172:175], a[196:199], v[52:55]
    v_mfma_f32_16x16x32_bf16 v[56:59], v[172:175], a[200:203], v[56:59]
    ds_read_b64_tr_b16 v[208:209], v234 offset:0
    buffer_load_dwordx4 v248, s[24:27], s66 offen offset:1024 lds
    v_mfma_f32_16x16x32_bf16 v[60:63], v[172:175], a[204:207], v[60:63]
    ds_read_b64_tr_b16 v[210:211], v234 offset:512
    v_mfma_f32_16x16x32_bf16 v[64:67], v[176:179], a[192:195], v[64:67]
    v_mfma_f32_16x16x32_bf16 v[68:71], v[176:179], a[196:199], v[68:71]
    ds_read_b64_tr_b16 v[212:213], v234 offset:1024
    v_mfma_f32_16x16x32_bf16 v[72:75], v[176:179], a[200:203], v[72:75]
    v_mfma_f32_16x16x32_bf16 v[76:79], v[176:179], a[204:207], v[76:79]
    ds_read_b64_tr_b16 v[214:215], v234 offset:1536
    v_mfma_f32_16x16x32_bf16 v[80:83], v[180:183], a[192:195], v[80:83]
    v_mfma_f32_16x16x32_bf16 v[84:87], v[180:183], a[196:199], v[84:87]
    ds_read_b64_tr_b16 v[216:217], v235 offset:0
    v_mfma_f32_16x16x32_bf16 v[88:91], v[180:183], a[200:203], v[88:91]
    ds_read_b64_tr_b16 v[218:219], v235 offset:512
    v_mfma_f32_16x16x32_bf16 v[92:95], v[180:183], a[204:207], v[92:95]
    v_mfma_f32_16x16x32_bf16 v[96:99], v[184:187], a[192:195], v[96:99]
    ds_read_b64_tr_b16 v[220:221], v235 offset:1024
    v_mfma_f32_16x16x32_bf16 v[100:103], v[184:187], a[196:199], v[100:103]
    v_mfma_f32_16x16x32_bf16 v[104:107], v[184:187], a[200:203], v[104:107]
    ds_read_b64_tr_b16 v[222:223], v235 offset:1536
    v_mfma_f32_16x16x32_bf16 v[108:111], v[184:187], a[204:207], v[108:111]
    s_waitcnt lgkmcnt(4)
    v_mfma_f32_16x16x32_bf16 v[112:115], v[188:191], a[192:195], v[112:115]
    v_mfma_f32_16x16x32_bf16 v[116:119], v[188:191], a[196:199], v[116:119]
    v_mfma_f32_16x16x32_bf16 v[120:123], v[188:191], a[200:203], v[120:123]
    v_mfma_f32_16x16x32_bf16 v[124:127], v[188:191], a[204:207], v[124:127]
    v_mfma_f32_16x16x32_bf16 v[0:3], v[192:195], a[208:211], v[0:3]
    s_waitcnt vmcnt(13)
    ds_read_b128 v[128:131], v246 offset:0
    v_mfma_f32_16x16x32_bf16 v[4:7], v[192:195], a[212:215], v[4:7]
    ds_read_b128 v[132:135], v246 offset:2048
    s_sub_u32 s77, 131072, s3
    v_mfma_f32_16x16x32_bf16 v[8:11], v[192:195], a[216:219], v[8:11]
    ds_read_b128 v[136:139], v246 offset:4096
    s_lshl_b32 s71, s2, 12
    v_mfma_f32_16x16x32_bf16 v[12:15], v[192:195], a[220:223], v[12:15]
    ds_read_b128 v[140:143], v246 offset:6144
    s_add_u32 s71, s71, s67
    v_mfma_f32_16x16x32_bf16 v[16:19], v[196:199], a[208:211], v[16:19]
    ds_read_b64_tr_b16 v[160:161], v232 offset:8192
    s_add_u32 s71, s71, 20971520
    v_mfma_f32_16x16x32_bf16 v[20:23], v[196:199], a[212:215], v[20:23]
    ds_read_b64_tr_b16 v[162:163], v232 offset:8704
    s_sub_u32 s68, s71, s3
    v_mfma_f32_16x16x32_bf16 v[24:27], v[196:199], a[216:219], v[24:27]
    s_add_u32 s69, s68, 1048576
    s_and_b32 s74, s2, 63
    v_mfma_f32_16x16x32_bf16 v[28:31], v[196:199], a[220:223], v[28:31]
    ds_read_b64_tr_b16 v[164:165], v232 offset:9216
    s_lshl_b32 s74, s74, 12
    v_mfma_f32_16x16x32_bf16 v[32:35], v[200:203], a[208:211], v[32:35]
    ds_read_b64_tr_b16 v[166:167], v232 offset:9728
    s_add_u32 s74, s74, s67
    v_mfma_f32_16x16x32_bf16 v[36:39], v[200:203], a[212:215], v[36:39]
    ds_read_b128 v[144:147], v247 offset:0
    s_add_u32 s74, s74, 23068672
    v_mfma_f32_16x16x32_bf16 v[40:43], v[200:203], a[216:219], v[40:43]
    ds_read_b128 v[148:151], v247 offset:2048
    s_sub_u32 s70, s74, s3
    v_mfma_f32_16x16x32_bf16 v[44:47], v[200:203], a[220:223], v[44:47]
    ds_read_b128 v[152:155], v247 offset:4096
    buffer_load_dwordx4 v[242:245], v250, s[36:39], s77 offen sc1
    v_mfma_f32_16x16x32_bf16 v[48:51], v[204:207], a[208:211], v[48:51]
    ds_read_b128 v[156:159], v247 offset:6144
    v_mfma_f32_16x16x32_bf16 v[52:55], v[204:207], a[212:215], v[52:55]
    v_mfma_f32_16x16x32_bf16 v[56:59], v[204:207], a[216:219], v[56:59]
    ds_read_b64_tr_b16 v[168:169], v233 offset:8192
    v_mfma_f32_16x16x32_bf16 v[60:63], v[204:207], a[220:223], v[60:63]
    ds_read_b64_tr_b16 v[170:171], v233 offset:8704
    v_mfma_f32_16x16x32_bf16 v[64:67], v[208:211], a[208:211], v[64:67]
    ds_read_b64_tr_b16 v[172:173], v233 offset:9216
    v_mfma_f32_16x16x32_bf16 v[68:71], v[208:211], a[212:215], v[68:71]
    ds_read_b64_tr_b16 v[174:175], v233 offset:9728
    v_mfma_f32_16x16x32_bf16 v[72:75], v[208:211], a[216:219], v[72:75]
    ds_read_b64_tr_b16 v[176:177], v234 offset:8192
    v_mfma_f32_16x16x32_bf16 v[76:79], v[208:211], a[220:223], v[76:79]
    ds_read_b64_tr_b16 v[178:179], v234 offset:8704
    v_mfma_f32_16x16x32_bf16 v[80:83], v[212:215], a[208:211], v[80:83]
    v_mfma_f32_16x16x32_bf16 v[84:87], v[212:215], a[212:215], v[84:87]
    ds_read_b64_tr_b16 v[180:181], v234 offset:9216
    v_mfma_f32_16x16x32_bf16 v[88:91], v[212:215], a[216:219], v[88:91]
    ds_read_b64_tr_b16 v[182:183], v234 offset:9728
    v_mfma_f32_16x16x32_bf16 v[92:95], v[212:215], a[220:223], v[92:95]
    ds_read_b64_tr_b16 v[184:185], v235 offset:8192
    s_waitcnt lgkmcnt(6)
    v_mfma_f32_16x16x32_bf16 v[96:99], v[216:219], a[208:211], v[96:99]
    ds_read_b64_tr_b16 v[186:187], v235 offset:8704
    v_mfma_f32_16x16x32_bf16 v[100:103], v[216:219], a[212:215], v[100:103]
    ds_read_b64_tr_b16 v[188:189], v235 offset:9216
    v_mfma_f32_16x16x32_bf16 v[104:107], v[216:219], a[216:219], v[104:107]
    ds_read_b64_tr_b16 v[190:191], v235 offset:9728
    v_mfma_f32_16x16x32_bf16 v[108:111], v[216:219], a[220:223], v[108:111]
    v_mfma_f32_16x16x32_bf16 v[112:115], v[220:223], a[208:211], v[112:115]
    v_mfma_f32_16x16x32_bf16 v[116:119], v[220:223], a[212:215], v[116:119]
    v_mfma_f32_16x16x32_bf16 v[120:123], v[220:223], a[216:219], v[120:123]
    v_mfma_f32_16x16x32_bf16 v[124:127], v[220:223], a[220:223], v[124:127]
    v_mfma_f32_16x16x32_bf16 v[0:3], v[160:163], a[224:227], v[0:3]
    s_waitcnt lgkmcnt(0)
    s_barrier
    v_mfma_f32_16x16x32_bf16 v[4:7], v[160:163], a[228:231], v[4:7]
    ds_read_b64_tr_b16 v[192:193], v232 offset:16384
    s_mul_i32 s35, s17, 4160
    v_mfma_f32_16x16x32_bf16 v[8:11], v[160:163], a[232:235], v[8:11]
    ds_read_b64_tr_b16 v[194:195], v232 offset:16896
    s_add_u32 m0, s35, 32
    v_mfma_f32_16x16x32_bf16 v[12:15], v[160:163], a[236:239], v[12:15]
    s_add_u32 s66, s7, 0
    buffer_load_dwordx4 v250, s[36:39], s66 offen offset:0 lds
    v_mfma_f32_16x16x32_bf16 v[16:19], v[164:167], a[224:227], v[16:19]
    ds_read_b64_tr_b16 v[196:197], v232 offset:17408
    v_mov_b32 v236, 0
    v_mfma_f32_16x16x32_bf16 v[20:23], v[164:167], a[228:231], v[20:23]
    v_mov_b32 v237, 0
    v_mov_b32 v238, 0
    v_mfma_f32_16x16x32_bf16 v[24:27], v[164:167], a[232:235], v[24:27]
    ds_read_b64_tr_b16 v[198:199], v232 offset:17920
    v_mov_b32 v239, 0
    v_mfma_f32_16x16x32_bf16 v[28:31], v[164:167], a[236:239], v[28:31]
    ds_read_b64_tr_b16 v[200:201], v233 offset:16384
    buffer_load_dwordx4 v250, s[36:39], s66 offen offset:1024 lds
    v_mfma_f32_16x16x32_bf16 v[32:35], v[168:171], a[224:227], v[32:35]
    v_min_u32 v253, 23, v252
    v_lshrrev_b32 v254, 3, v253
    v_mfma_f32_16x16x32_bf16 v[36:39], v[168:171], a[228:231], v[36:39]
    ds_read_b64_tr_b16 v[202:203], v233 offset:16896
    v_mul_u32_u24 v254, 21216, v254
    v_mfma_f32_16x16x32_bf16 v[40:43], v[168:171], a[232:235], v[40:43]
    v_bfe_u32 v255, v253, 1, 2
    v_mul_u32_u24 v255, 4160, v255
    v_mfma_f32_16x16x32_bf16 v[44:47], v[168:171], a[236:239], v[44:47]
    ds_read_b64_tr_b16 v[204:205], v233 offset:17408
    v_add_u32 v254, v254, v255
    v_mfma_f32_16x16x32_bf16 v[48:51], v[172:175], a[224:227], v[48:51]
    ds_read_b64_tr_b16 v[206:207], v233 offset:17920
    buffer_load_dwordx4 v250, s[36:39], s66 offen offset:2048 lds
    v_mfma_f32_16x16x32_bf16 v[52:55], v[172:175], a[228:231], v[52:55]
    v_and_b32 v255, 1, v253
    v_lshl_add_u32 v254, v255, 4, v254
    v_mfma_f32_16x16x32_bf16 v[56:59], v[172:175], a[232:235], v[56:59]
    ds_read_b64_tr_b16 v[208:209], v234 offset:16384
    ds_write_b128 v254, v[236:239]
    v_mfma_f32_16x16x32_bf16 v[60:63], v[172:175], a[236:239], v[60:63]
    v_lshlrev_b32 v253, 4, v252
    s_add_u32 s71, s67, 59072
    v_mfma_f32_16x16x32_bf16 v[64:67], v[176:179], a[224:227], v[64:67]
    ds_read_b64_tr_b16 v[210:211], v234 offset:16896
    s_cmp_eq_u32 s17, 2
    s_cselect_b32 s71, 16640, s71
    v_mfma_f32_16x16x32_bf16 v[68:71], v[176:179], a[228:231], v[68:71]
    ds_read_b64_tr_b16 v[212:213], v234 offset:17408
    buffer_load_dwordx4 v250, s[36:39], s66 offen offset:3072 lds
    v_mfma_f32_16x16x32_bf16 v[72:75], v[176:179], a[232:235], v[72:75]
    s_cmp_eq_u32 s17, 3
    s_cselect_b32 s71, 37856, s71
    v_mfma_f32_16x16x32_bf16 v[76:79], v[176:179], a[236:239], v[76:79]
    ds_read_b64_tr_b16 v[214:215], v234 offset:17920
    v_add_u32 v255, s71, v253
    v_mfma_f32_16x16x32_bf16 v[80:83], v[180:183], a[224:227], v[80:83]
    s_add_u32 m0, s51, 114688
    s_add_u32 s66, s49, s95
    v_mfma_f32_16x16x32_bf16 v[84:87], v[180:183], a[228:231], v[84:87]
    ds_read_b64_tr_b16 v[216:217], v235 offset:16384
    v_add_u32 v253, s67, v253
    v_mfma_f32_16x16x32_bf16 v[88:91], v[180:183], a[232:235], v[88:91]
    ds_read_b64_tr_b16 v[218:219], v235 offset:16896
    buffer_load_dwordx4 v248, s[20:23], s66 offen lds
    v_mfma_f32_16x16x32_bf16 v[92:95], v[180:183], a[236:239], v[92:95]
    ds_write_b128 v255, v[236:239]
    v_mfma_f32_16x16x32_bf16 v[96:99], v[184:187], a[224:227], v[96:99]
    ds_read_b64_tr_b16 v[220:221], v235 offset:17408
    v_mfma_f32_16x16x32_bf16 v[100:103], v[184:187], a[228:231], v[100:103]
    v_mfma_f32_16x16x32_bf16 v[104:107], v[184:187], a[232:235], v[104:107]
    ds_read_b64_tr_b16 v[222:223], v235 offset:17920
    buffer_load_dwordx4 v248, s[24:27], s66 offen offset:1024 lds
    v_mfma_f32_16x16x32_bf16 v[108:111], v[184:187], a[236:239], v[108:111]
    v_mfma_f32_16x16x32_bf16 v[112:115], v[188:191], a[224:227], v[112:115]
    v_mfma_f32_16x16x32_bf16 v[116:119], v[188:191], a[228:231], v[116:119]
    s_add_u32 m0, s51, 122880
    s_add_u32 s66, s66, 294912
    v_mfma_f32_16x16x32_bf16 v[120:123], v[188:191], a[232:235], v[120:123]
    v_mfma_f32_16x16x32_bf16 v[124:127], v[188:191], a[236:239], v[124:127]
    buffer_load_dwordx4 v248, s[20:23], s66 offen lds
    s_waitcnt lgkmcnt(1)
    v_mfma_f32_16x16x32_bf16 v[0:3], v[192:195], a[240:243], v[0:3]
    ds_read_b64_tr_b16 v[160:161], v232 offset:24576
    v_mfma_f32_16x16x32_bf16 v[4:7], v[192:195], a[244:247], v[4:7]
    ds_read_b64_tr_b16 v[162:163], v232 offset:25088
    v_mfma_f32_16x16x32_bf16 v[8:11], v[192:195], a[248:251], v[8:11]
    v_mfma_f32_16x16x32_bf16 v[12:15], v[192:195], a[252:255], v[12:15]
    ds_read_b64_tr_b16 v[164:165], v232 offset:25600
    buffer_load_dwordx4 v248, s[24:27], s66 offen offset:1024 lds
    v_mfma_f32_16x16x32_bf16 v[16:19], v[196:199], a[240:243], v[16:19]
    v_mfma_f32_16x16x32_bf16 v[20:23], v[196:199], a[244:247], v[20:23]
    ds_read_b64_tr_b16 v[166:167], v232 offset:26112
    v_mfma_f32_16x16x32_bf16 v[24:27], v[196:199], a[248:251], v[24:27]
    s_add_u32 m0, s51, 131072
    s_add_u32 s66, s66, 294912
    v_mfma_f32_16x16x32_bf16 v[28:31], v[196:199], a[252:255], v[28:31]
    ds_read_b64_tr_b16 v[168:169], v233 offset:24576
    v_mfma_f32_16x16x32_bf16 v[32:35], v[200:203], a[240:243], v[32:35]
    ds_read_b64_tr_b16 v[170:171], v233 offset:25088
    buffer_load_dwordx4 v248, s[20:23], s66 offen lds
    v_mfma_f32_16x16x32_bf16 v[36:39], v[200:203], a[244:247], v[36:39]
    v_mfma_f32_16x16x32_bf16 v[40:43], v[200:203], a[248:251], v[40:43]
    ds_read_b64_tr_b16 v[172:173], v233 offset:25600
    v_mfma_f32_16x16x32_bf16 v[44:47], v[200:203], a[252:255], v[44:47]
    v_mfma_f32_16x16x32_bf16 v[48:51], v[204:207], a[240:243], v[48:51]
    ds_read_b64_tr_b16 v[174:175], v233 offset:26112
    buffer_load_dwordx4 v248, s[24:27], s66 offen offset:1024 lds
    v_mfma_f32_16x16x32_bf16 v[52:55], v[204:207], a[244:247], v[52:55]
    v_mfma_f32_16x16x32_bf16 v[56:59], v[204:207], a[248:251], v[56:59]
    ds_read_b64_tr_b16 v[176:177], v234 offset:24576
    v_mfma_f32_16x16x32_bf16 v[60:63], v[204:207], a[252:255], v[60:63]
    ds_read_b64_tr_b16 v[178:179], v234 offset:25088
    s_mul_i32 s35, s17, 4160
    v_mfma_f32_16x16x32_bf16 v[64:67], v[208:211], a[240:243], v[64:67]
    s_add_u32 m0, s35, 21248
    s_add_u32 s66, s7, 1114112
    v_mfma_f32_16x16x32_bf16 v[68:71], v[208:211], a[244:247], v[68:71]
    ds_read_b64_tr_b16 v[180:181], v234 offset:25600
    buffer_load_dwordx4 v250, s[36:39], s66 offen offset:0 lds
    v_mfma_f32_16x16x32_bf16 v[72:75], v[208:211], a[248:251], v[72:75]
    v_mfma_f32_16x16x32_bf16 v[76:79], v[208:211], a[252:255], v[76:79]
    ds_read_b64_tr_b16 v[182:183], v234 offset:26112
    v_mfma_f32_16x16x32_bf16 v[80:83], v[212:215], a[240:243], v[80:83]
    v_mfma_f32_16x16x32_bf16 v[84:87], v[212:215], a[244:247], v[84:87]
    ds_read_b64_tr_b16 v[184:185], v235 offset:24576
    v_mfma_f32_16x16x32_bf16 v[88:91], v[212:215], a[248:251], v[88:91]
    ds_read_b64_tr_b16 v[186:187], v235 offset:25088
    buffer_load_dwordx4 v250, s[36:39], s66 offen offset:1024 lds
    v_mfma_f32_16x16x32_bf16 v[92:95], v[212:215], a[252:255], v[92:95]
    v_mfma_f32_16x16x32_bf16 v[96:99], v[216:219], a[240:243], v[96:99]
    ds_read_b64_tr_b16 v[188:189], v235 offset:25600
    v_mfma_f32_16x16x32_bf16 v[100:103], v[216:219], a[244:247], v[100:103]
    v_mfma_f32_16x16x32_bf16 v[104:107], v[216:219], a[248:251], v[104:107]
    ds_read_b64_tr_b16 v[190:191], v235 offset:26112
    v_mfma_f32_16x16x32_bf16 v[108:111], v[216:219], a[252:255], v[108:111]
    buffer_load_dwordx4 v250, s[36:39], s66 offen offset:2048 lds
    s_waitcnt lgkmcnt(4)
    v_mfma_f32_16x16x32_bf16 v[112:115], v[220:223], a[240:243], v[112:115]
    v_mfma_f32_16x16x32_bf16 v[116:119], v[220:223], a[244:247], v[116:119]
    v_mfma_f32_16x16x32_bf16 v[120:123], v[220:223], a[248:251], v[120:123]
    v_mfma_f32_16x16x32_bf16 v[124:127], v[220:223], a[252:255], v[124:127]
    v_mfma_f32_16x16x32_bf16 v[0:3], v[160:163], v[128:131], v[0:3]
    ds_read_b64_tr_b16 v[192:193], v232 offset:32768
    buffer_load_dwordx4 v250, s[36:39], s66 offen offset:3072 lds
    v_mfma_f32_16x16x32_bf16 v[4:7], v[160:163], v[132:135], v[4:7]
    ds_read_b64_tr_b16 v[194:195], v232 offset:33280
    s_waitcnt vmcnt(14)
    v_mfma_f32_16x16x32_bf16 v[8:11], v[160:163], v[136:139], v[8:11]
    v_and_b32 v242, v242, v243
    v_and_b32 v244, v244, v245
    v_mfma_f32_16x16x32_bf16 v[12:15], v[160:163], v[140:143], v[12:15]
    ds_read_b64_tr_b16 v[196:197], v232 offset:33792
    s_mul_i32 s35, s17, 4160
    v_mfma_f32_16x16x32_bf16 v[16:19], v[164:167], v[128:131], v[16:19]
    s_add_u32 m0, s35, 42464
    s_add_u32 s66, s7, 2228224
    v_mfma_f32_16x16x32_bf16 v[20:23], v[164:167], v[132:135], v[20:23]
    ds_read_b64_tr_b16 v[198:199], v232 offset:34304
    buffer_load_dwordx4 v250, s[36:39], s66 offen offset:0 lds
    v_mfma_f32_16x16x32_bf16 v[24:27], v[164:167], v[136:139], v[24:27]
    v_and_b32 v242, v242, v244
    v_cmp_eq_u32 vcc, 1, v242
    s_cmp_eq_u64 vcc, exec
    s_cbranch_scc0 gated_mix__ssm_conv_s4__glu_gated_bilinear__prompt_kernel_slow2
gated_mix__ssm_conv_s4__glu_gated_bilinear__prompt_kernel_back2:
    v_mfma_f32_16x16x32_bf16 v[28:31], v[164:167], v[140:143], v[28:31]
    ds_read_b64_tr_b16 v[200:201], v233 offset:32768
    v_mfma_f32_16x16x32_bf16 v[32:35], v[168:171], v[128:131], v[32:35]
    ds_read_b64_tr_b16 v[202:203], v233 offset:33280
    v_mfma_f32_16x16x32_bf16 v[36:39], v[168:171], v[132:135], v[36:39]
    v_mfma_f32_16x16x32_bf16 v[40:43], v[168:171], v[136:139], v[40:43]
    ds_read_b64_tr_b16 v[204:205], v233 offset:33792
    buffer_load_dwordx4 v250, s[36:39], s66 offen offset:1024 lds
    v_mfma_f32_16x16x32_bf16 v[44:47], v[168:171], v[140:143], v[44:47]
    v_mfma_f32_16x16x32_bf16 v[48:51], v[172:175], v[128:131], v[48:51]
    ds_read_b64_tr_b16 v[206:207], v233 offset:34304
    v_mfma_f32_16x16x32_bf16 v[52:55], v[172:175], v[132:135], v[52:55]
    v_mfma_f32_16x16x32_bf16 v[56:59], v[172:175], v[136:139], v[56:59]
    ds_read_b64_tr_b16 v[208:209], v234 offset:32768
    v_mfma_f32_16x16x32_bf16 v[60:63], v[172:175], v[140:143], v[60:63]
    ds_read_b64_tr_b16 v[210:211], v234 offset:33280
    buffer_load_dwordx4 v250, s[36:39], s66 offen offset:2048 lds
    v_mfma_f32_16x16x32_bf16 v[64:67], v[176:179], v[128:131], v[64:67]
    v_mfma_f32_16x16x32_bf16 v[68:71], v[176:179], v[132:135], v[68:71]
    ds_read_b64_tr_b16 v[212:213], v234 offset:33792
    v_mfma_f32_16x16x32_bf16 v[72:75], v[176:179], v[136:139], v[72:75]
    v_mfma_f32_16x16x32_bf16 v[76:79], v[176:179], v[140:143], v[76:79]
    ds_read_b64_tr_b16 v[214:215], v234 offset:34304
    v_mfma_f32_16x16x32_bf16 v[80:83], v[180:183], v[128:131], v[80:83]
    buffer_load_dwordx4 v250, s[36:39], s66 offen offset:3072 lds
    v_mfma_f32_16x16x32_bf16 v[84:87], v[180:183], v[132:135], v[84:87]
    ds_read_b64_tr_b16 v[216:217], v235 offset:32768
    v_mfma_f32_16x16x32_bf16 v[88:91], v[180:183], v[136:139], v[88:91]
    ds_read_b64_tr_b16 v[218:219], v235 offset:33280
    v_mfma_f32_16x16x32_bf16 v[92:95], v[180:183], v[140:143], v[92:95]
    s_waitcnt lgkmcnt(4)
    v_mfma_f32_16x16x32_bf16 v[96:99], v[184:187], v[128:131], v[96:99]
    ds_read_b64_tr_b16 v[220:221], v235 offset:33792
    v_mfma_f32_16x16x32_bf16 v[100:103], v[184:187], v[132:135], v[100:103]
    buffer_load_dwordx4 v[236:239], v250, s[36:39], s68 offen sc1
    v_mfma_f32_16x16x32_bf16 v[104:107], v[184:187], v[136:139], v[104:107]
    ds_read_b64_tr_b16 v[222:223], v235 offset:34304
    v_mfma_f32_16x16x32_bf16 v[108:111], v[184:187], v[140:143], v[108:111]
    v_mfma_f32_16x16x32_bf16 v[112:115], v[188:191], v[128:131], v[112:115]
    v_mfma_f32_16x16x32_bf16 v[116:119], v[188:191], v[132:135], v[116:119]
    v_mfma_f32_16x16x32_bf16 v[120:123], v[188:191], v[136:139], v[120:123]
    buffer_load_dwordx4 v[240:243], v250, s[36:39], s69 offen sc1
    v_mfma_f32_16x16x32_bf16 v[124:127], v[188:191], v[140:143], v[124:127]
    v_mfma_f32_16x16x32_bf16 v[0:3], v[192:195], v[144:147], v[0:3]
    s_waitcnt lgkmcnt(0)
    s_barrier
    v_mfma_f32_16x16x32_bf16 v[16:19], v[196:199], v[144:147], v[16:19]
    ds_read_b64_tr_b16 v[160:161], v228 offset:4096
    v_mfma_f32_16x16x32_bf16 v[32:35], v[200:203], v[144:147], v[32:35]
    ds_read_b64_tr_b16 v[162:163], v228 offset:4608
    v_mfma_f32_16x16x32_bf16 v[48:51], v[204:207], v[144:147], v[48:51]
    buffer_load_dwordx4 v[244:247], v250, s[36:39], s70 offen sc1
    v_mfma_f32_16x16x32_bf16 v[4:7], v[192:195], v[148:151], v[4:7]
    ds_read_b64_tr_b16 v[164:165], v228 offset:5120
    v_mfma_f32_16x16x32_bf16 v[20:23], v[196:199], v[148:151], v[20:23]
    v_mfma_f32_16x16x32_bf16 v[36:39], v[200:203], v[148:151], v[36:39]
    ds_read_b64_tr_b16 v[166:167], v228 offset:5632
    v_mfma_f32_16x16x32_bf16 v[52:55], v[204:207], v[148:151], v[52:55]
    ds_read_b64_tr_b16 v[168:169], v229 offset:4096
    v_mul_f32 v0, v0, v16
    v_mfma_f32_16x16x32_bf16 v[8:11], v[192:195], v[152:155], v[8:11]
    v_mul_f32 v1, v1, v17
    v_mul_f32 v2, v2, v18
    v_mfma_f32_16x16x32_bf16 v[24:27], v[196:199], v[152:155], v[24:27]
    ds_read_b64_tr_b16 v[170:171], v229 offset:4608
    v_mul_f32 v3, v3, v19
    v_mfma_f32_16x16x32_bf16 v[40:43], v[200:203], v[152:155], v[40:43]
    v_mul_f32 v32, v32, v48
    v_mul_f32 v33, v33, v49
    v_mfma_f32_16x16x32_bf16 v[56:59], v[204:207], v[152:155], v[56:59]
    ds_read_b64_tr_b16 v[172:173], v229 offset:5120
    v_mul_f32 v34, v34, v50
    v_mfma_f32_16x16x32_bf16 v[12:15], v[192:195], v[156:159], v[12:15]
    ds_read_b64_tr_b16 v[174:175], v229 offset:5632
    v_mul_f32 v35, v35, v51
    v_cvt_pk_bf16_f32 v16, v0, v1
    v_mfma_f32_16x16x32_bf16 v[28:31], v[196:199], v[156:159], v[28:31]
    v_cvt_pk_bf16_f32 v17, v2, v3
    v_cvt_pk_bf16_f32 v18, v32, v33
    v_mfma_f32_16x16x32_bf16 v[44:47], v[200:203], v[156:159], v[44:47]
    ds_read_b64_tr_b16 v[176:177], v230 offset:4096
    v_cvt_pk_bf16_f32 v19, v34, v35
    v_mfma_f32_16x16x32_bf16 v[60:63], v[204:207], v[156:159], v[60:63]
    buffer_store_dwordx4 v[16:19], v250, s[36:39], s60 offen offset:0 sc1
    v_mul_f32 v4, v4, v20
    v_mfma_f32_16x16x32_bf16 v[64:67], v[208:211], v[144:147], v[64:67]
    ds_read_b64_tr_b16 v[178:179], v230 offset:4608
    v_mul_f32 v5, v5, v21
    v_mul_f32 v6, v6, v22
    v_mfma_f32_16x16x32_bf16 v[80:83], v[212:215], v[144:147], v[80:83]
    ds_read_b64_tr_b16 v[180:181], v230 offset:5120
    v_mul_f32 v7, v7, v23
    v_mul_f32 v36, v36, v52
    v_mfma_f32_16x16x32_bf16 v[96:99], v[216:219], v[144:147], v[96:99]
    v_mul_f32 v37, v37, v53
    v_mul_f32 v38, v38, v54
    v_mul_f32 v39, v39, v55
    v_mfma_f32_16x16x32_bf16 v[112:115], v[220:223], v[144:147], v[112:115]
    ds_read_b64_tr_b16 v[182:183], v230 offset:5632
    v_cvt_pk_bf16_f32 v20, v4, v5
    v_cvt_pk_bf16_f32 v21, v6, v7
    v_mfma_f32_16x16x32_bf16 v[68:71], v[208:211], v[148:151], v[68:71]
    v_cvt_pk_bf16_f32 v22, v36, v37
    v_cvt_pk_bf16_f32 v23, v38, v39
    buffer_store_dwordx4 v[20:23], v250, s[36:39], s60 offen offset:1024 sc1
    v_mfma_f32_16x16x32_bf16 v[84:87], v[212:215], v[148:151], v[84:87]
    ds_read_b64_tr_b16 v[184:185], v231 offset:4096
    v_mul_f32 v8, v8, v24
    v_mul_f32 v9, v9, v25
    v_mfma_f32_16x16x32_bf16 v[100:103], v[216:219], v[148:151], v[100:103]
    ds_read_b64_tr_b16 v[186:187], v231 offset:4608
    v_mul_f32 v10, v10, v26
    v_mul_f32 v11, v11, v27
    v_mfma_f32_16x16x32_bf16 v[116:119], v[220:223], v[148:151], v[116:119]
    v_mul_f32 v40, v40, v56
    v_mul_f32 v41, v41, v57
    v_mul_f32 v42, v42, v58
    v_mfma_f32_16x16x32_bf16 v[72:75], v[208:211], v[152:155], v[72:75]
    ds_read_b64_tr_b16 v[188:189], v231 offset:5120
    v_mul_f32 v43, v43, v59
    v_cvt_pk_bf16_f32 v24, v8, v9
    v_mfma_f32_16x16x32_bf16 v[88:91], v[212:215], v[152:155], v[88:91]
    v_cvt_pk_bf16_f32 v25, v10, v11
    v_cvt_pk_bf16_f32 v26, v40, v41
    v_cvt_pk_bf16_f32 v27, v42, v43
    v_mfma_f32_16x16x32_bf16 v[104:107], v[216:219], v[152:155], v[104:107]
    ds_read_b64_tr_b16 v[190:191], v231 offset:5632
    buffer_store_dwordx4 v[24:27], v251, s[36:39], s60 offen offset:0 sc1
    v_mul_f32 v12, v12, v28
    v_mfma_f32_16x16x32_bf16 v[120:123], v[220:223], v[152:155], v[120:123]
    v_mul_f32 v13, v13, v29
    v_mul_f32 v14, v14, v30
    v_mul_f32 v15, v15, v31
    v_mfma_f32_16x16x32_bf16 v[76:79], v[208:211], v[156:159], v[76:79]
    v_mul_f32 v44, v44, v60
    v_mul_f32 v45, v45, v61
    v_mul_f32 v46, v46, v62
    v_mfma_f32_16x16x32_bf16 v[92:95], v[212:215], v[156:159], v[92:95]
    v_mul_f32 v47, v47, v63
    v_cvt_pk_bf16_f32 v28, v12, v13
    v_cvt_pk_bf16_f32 v29, v14, v15
    v_mfma_f32_16x16x32_bf16 v[108:111], v[216:219], v[156:159], v[108:111]
    v_cvt_pk_bf16_f32 v30, v44, v45
    v_cvt_pk_bf16_f32 v31, v46, v47
    buffer_store_dwordx4 v[28:31], v251, s[36:39], s60 offen offset:1024 sc1
    v_mfma_f32_16x16x32_bf16 v[124:127], v[220:223], v[156:159], v[124:127]
    v_mul_f32 v64, v64, v80
    v_mul_f32 v65, v65, v81
    v_mul_f32 v66, v66, v82
    s_waitcnt lgkmcnt(1)
    v_mfma_f32_16x16x32_bf16 v[0:3], v[160:163], a[0:3], 0
    ds_read_b64_tr_b16 v[192:193], v228 offset:12288
    v_mul_f32 v67, v67, v83
    v_mfma_f32_16x16x32_bf16 v[16:19], v[164:167], a[0:3], 0
    ds_read_b64_tr_b16 v[194:195], v228 offset:12800
    v_mul_f32 v96, v96, v112
    v_mul_f32 v97, v97, v113
    v_mfma_f32_16x16x32_bf16 v[32:35], v[168:171], a[0:3], 0
    v_mul_f32 v98, v98, v114
    v_mul_f32 v99, v99, v115
    v_cvt_pk_bf16_f32 v80, v64, v65
    v_mfma_f32_16x16x32_bf16 v[48:51], v[172:175], a[0:3], 0
    ds_read_b64_tr_b16 v[196:197], v228 offset:13312
    v_cvt_pk_bf16_f32 v81, v66, v67
    v_cvt_pk_bf16_f32 v82, v96, v97
    v_mfma_f32_16x16x32_bf16 v[4:7], v[160:163], a[4:7], 0
    v_cvt_pk_bf16_f32 v83, v98, v99
    buffer_store_dwordx4 v[80:83], v250, s[36:39], s61 offen offset:0 sc1
    v_mul_f32 v68, v68, v84
    v_mfma_f32_16x16x32_bf16 v[20:23], v[164:167], a[4:7], 0
    ds_read_b64_tr_b16 v[198:199], v228 offset:13824
    v_mul_f32 v69, v69, v85
    v_mul_f32 v70, v70, v86
    v_mfma_f32_16x16x32_bf16 v[36:39], v[168:171], a[4:7], 0
    v_mul_f32 v71, v71, v87
    v_mul_f32 v100, v100, v116
    v_mul_f32 v101, v101, v117
    v_mfma_f32_16x16x32_bf16 v[52:55], v[172:175], a[4:7], 0
    ds_read_b64_tr_b16 v[200:201], v229 offset:12288
    v_mul_f32 v102, v102, v118
    v_mul_f32 v103, v103, v119
    v_mfma_f32_16x16x32_bf16 v[8:11], v[160:163], a[8:11], 0
    ds_read_b64_tr_b16 v[202:203], v229 offset:12800
    v_cvt_pk_bf16_f32 v84, v68, v69
    v_cvt_pk_bf16_f32 v85, v70, v71
    v_mfma_f32_16x16x32_bf16 v[24:27], v[164:167], a[8:11], 0
    v_cvt_pk_bf16_f32 v86, v100, v101
    v_cvt_pk_bf16_f32 v87, v102, v103
    v_mfma_f32_16x16x32_bf16 v[40:43], v[168:171], a[8:11], 0
    ds_read_b64_tr_b16 v[204:205], v229 offset:13312
    buffer_store_dwordx4 v[84:87], v250, s[36:39], s61 offen offset:1024 sc1
    v_mfma_f32_16x16x32_bf16 v[56:59], v[172:175], a[8:11], 0
    v_mul_f32 v72, v72, v88
    v_mul_f32 v73, v73, v89
    v_mfma_f32_16x16x32_bf16 v[12:15], v[160:163], a[12:15], 0
    ds_read_b64_tr_b16 v[206:207], v229 offset:13824
    v_mul_f32 v74, v74, v90
    v_mfma_f32_16x16x32_bf16 v[28:31], v[164:167], a[12:15], 0
    v_mul_f32 v75, v75, v91
    v_mul_f32 v104, v104, v120
    v_mfma_f32_16x16x32_bf16 v[44:47], v[168:171], a[12:15], 0
    ds_read_b64_tr_b16 v[208:209], v230 offset:12288
    v_mul_f32 v105, v105, v121
    v_mfma_f32_16x16x32_bf16 v[60:63], v[172:175], a[12:15], 0
    ds_read_b64_tr_b16 v[210:211], v230 offset:12800
    v_mul_f32 v106, v106, v122
    v_mfma_f32_16x16x32_bf16 v[64:67], v[176:179], a[0:3], 0
    v_mul_f32 v107, v107, v123
    v_cvt_pk_bf16_f32 v88, v72, v73
    v_mfma_f32_16x16x32_bf16 v[80:83], v[180:183], a[0:3], 0
    ds_read_b64_tr_b16 v[212:213], v230 offset:13312
    v_cvt_pk_bf16_f32 v89, v74, v75
    v_mfma_f32_16x16x32_bf16 v[96:99], v[184:187], a[0:3], 0
    v_cvt_pk_bf16_f32 v90, v104, v105
    v_cvt_pk_bf16_f32 v91, v106, v107
    s_waitcnt lgkmcnt(4)
    v_mfma_f32_16x16x32_bf16 v[112:115], v[188:191], a[0:3], 0
    ds_read_b64_tr_b16 v[214:215], v230 offset:13824
    v_mfma_f32_16x16x32_bf16 v[68:71], v[176:179], a[4:7], 0
    buffer_store_dwordx4 v[88:91], v251, s[36:39], s61 offen offset:0 sc1
    v_mul_f32 v76, v76, v92
    v_mfma_f32_16x16x32_bf16 v[84:87], v[180:183], a[4:7], 0
    ds_read_b64_tr_b16 v[216:217], v231 offset:12288
    v_mul_f32 v77, v77, v93
    v_mfma_f32_16x16x32_bf16 v[100:103], v[184:187], a[4:7], 0
    ds_read_b64_tr_b16 v[218:219], v231 offset:12800
    v_mul_f32 v78, v78, v94
    v_mfma_f32_16x16x32_bf16 v[116:119], v[188:191], a[4:7], 0
    v_mul_f32 v79, v79, v95
    v_mul_f32 v108, v108, v124
    v_mfma_f32_16x16x32_bf16 v[72:75], v[176:179], a[8:11], 0
    ds_read_b64_tr_b16 v[220:221], v231 offset:13312
    v_mul_f32 v109, v109, v125
    v_mfma_f32_16x16x32_bf16 v[88:91], v[180:183], a[8:11], 0
    v_mul_f32 v110, v110, v126
    v_mul_f32 v111, v111, v127
    v_mfma_f32_16x16x32_bf16 v[104:107], v[184:187], a[8:11], 0
    ds_read_b64_tr_b16 v[222:223], v231 offset:13824
    v_cvt_pk_bf16_f32 v92, v76, v77
    v_mfma_f32_16x16x32_bf16 v[120:123], v[188:191], a[8:11], 0
    v_cvt_pk_bf16_f32 v93, v78, v79
    v_cvt_pk_bf16_f32 v94, v108, v109
    v_cvt_pk_bf16_f32 v95, v110, v111
    buffer_store_dwordx4 v[92:95], v251, s[36:39], s61 offen offset:1024 sc1
    s_nop 1
    v_mfma_f32_16x16x32_bf16 v[76:79], v[176:179], a[12:15], 0
    v_mfma_f32_16x16x32_bf16 v[92:95], v[180:183], a[12:15], 0
    v_mfma_f32_16x16x32_bf16 v[108:111], v[184:187], a[12:15], 0
    v_mfma_f32_16x16x32_bf16 v[124:127], v[188:191], a[12:15], 0
    v_mfma_f32_16x16x32_bf16 v[0:3], v[192:195], a[16:19], v[0:3]
    ds_read_b64_tr_b16 v[160:161], v228 offset:20480
    s_add_u32 m0, s51, 139264
    v_mfma_f32_16x16x32_bf16 v[4:7], v[192:195], a[20:23], v[4:7]
    ds_read_b64_tr_b16 v[162:163], v228 offset:20992
    s_add_u32 s66, s49, s95
    v_mfma_f32_16x16x32_bf16 v[8:11], v[192:195], a[24:27], v[8:11]
    s_add_u32 s66, s66, 884736
    buffer_load_dwordx4 v248, s[20:23], s66 offen lds
    v_mfma_f32_16x16x32_bf16 v[12:15], v[192:195], a[28:31], v[12:15]
    ds_read_b64_tr_b16 v[164:165], v228 offset:21504
    v_mfma_f32_16x16x32_bf16 v[16:19], v[196:199], a[16:19], v[16:19]
    v_mfma_f32_16x16x32_bf16 v[20:23], v[196:199], a[20:23], v[20:23]
    ds_read_b64_tr_b16 v[166:167], v228 offset:22016
    v_mfma_f32_16x16x32_bf16 v[24:27], v[196:199], a[24:27], v[24:27]
    v_mfma_f32_16x16x32_bf16 v[28:31], v[196:199], a[28:31], v[28:31]
    ds_read_b64_tr_b16 v[168:169], v229 offset:20480
    buffer_load_dwordx4 v248, s[24:27], s66 offen offset:1024 lds
    v_mfma_f32_16x16x32_bf16 v[32:35], v[200:203], a[16:19], v[32:35]
    ds_read_b64_tr_b16 v[170:171], v229 offset:20992
    v_mfma_f32_16x16x32_bf16 v[36:39], v[200:203], a[20:23], v[36:39]
    s_add_u32 m0, s51, 147456
    s_add_u32 s66, s66, 294912
    v_mfma_f32_16x16x32_bf16 v[40:43], v[200:203], a[24:27], v[40:43]
    ds_read_b64_tr_b16 v[172:173], v229 offset:21504
    v_mfma_f32_16x16x32_bf16 v[44:47], v[200:203], a[28:31], v[44:47]
    buffer_load_dwordx4 v248, s[20:23], s66 offen lds
    s_waitcnt lgkmcnt(4)
    v_mfma_f32_16x16x32_bf16 v[48:51], v[204:207], a[16:19], v[48:51]
    ds_read_b64_tr_b16 v[174:175], v229 offset:22016
    v_mfma_f32_16x16x32_bf16 v[52:55], v[204:207], a[20:23], v[52:55]
    v_mfma_f32_16x16x32_bf16 v[56:59], v[204:207], a[24:27], v[56:59]
    ds_read_b64_tr_b16 v[176:177], v230 offset:20480
    v_mfma_f32_16x16x32_bf16 v[60:63], v[204:207], a[28:31], v[60:63]
    ds_read_b64_tr_b16 v[178:179], v230 offset:20992
    v_mfma_f32_16x16x32_bf16 v[64:67], v[208:211], a[16:19], v[64:67]
    buffer_load_dwordx4 v248, s[24:27], s66 offen offset:1024 lds
    v_mfma_f32_16x16x32_bf16 v[68:71], v[208:211], a[20:23], v[68:71]
    ds_read_b64_tr_b16 v[180:181], v230 offset:21504
    v_mfma_f32_16x16x32_bf16 v[72:75], v[208:211], a[24:27], v[72:75]
    s_add_u32 m0, s51, 155648
    s_add_u32 s66, s66, 294912
    v_mfma_f32_16x16x32_bf16 v[76:79], v[208:211], a[28:31], v[76:79]
    ds_read_b64_tr_b16 v[182:183], v230 offset:22016
    v_mfma_f32_16x16x32_bf16 v[80:83], v[212:215], a[16:19], v[80:83]
    buffer_load_dwordx4 v248, s[20:23], s66 offen lds
    v_mfma_f32_16x16x32_bf16 v[84:87], v[212:215], a[20:23], v[84:87]
    ds_read_b64_tr_b16 v[184:185], v231 offset:20480
    v_mfma_f32_16x16x32_bf16 v[88:91], v[212:215], a[24:27], v[88:91]
    ds_read_b64_tr_b16 v[186:187], v231 offset:20992
    v_mfma_f32_16x16x32_bf16 v[92:95], v[212:215], a[28:31], v[92:95]
    v_mfma_f32_16x16x32_bf16 v[96:99], v[216:219], a[16:19], v[96:99]
    ds_read_b64_tr_b16 v[188:189], v231 offset:21504
    v_mfma_f32_16x16x32_bf16 v[100:103], v[216:219], a[20:23], v[100:103]
    buffer_load_dwordx4 v248, s[24:27], s66 offen offset:1024 lds
    v_mfma_f32_16x16x32_bf16 v[104:107], v[216:219], a[24:27], v[104:107]
    ds_read_b64_tr_b16 v[190:191], v231 offset:22016
    v_mfma_f32_16x16x32_bf16 v[108:111], v[216:219], a[28:31], v[108:111]
    v_mfma_f32_16x16x32_bf16 v[112:115], v[220:223], a[16:19], v[112:115]
    v_mfma_f32_16x16x32_bf16 v[116:119], v[220:223], a[20:23], v[116:119]
    v_mfma_f32_16x16x32_bf16 v[120:123], v[220:223], a[24:27], v[120:123]
    v_mfma_f32_16x16x32_bf16 v[124:127], v[220:223], a[28:31], v[124:127]
    v_mfma_f32_16x16x32_bf16 v[0:3], v[160:163], a[32:35], v[0:3]
    s_waitcnt lgkmcnt(0)
    s_barrier
    v_mfma_f32_16x16x32_bf16 v[4:7], v[160:163], a[36:39], v[4:7]
    ds_read_b64_tr_b16 v[192:193], v228 offset:28672
    s_add_u32 m0, s67, 65536
    v_mfma_f32_16x16x32_bf16 v[8:11], v[160:163], a[40:43], v[8:11]
    ds_read_b64_tr_b16 v[194:195], v228 offset:29184
    s_add_u32 s66, s50, s94
    v_mfma_f32_16x16x32_bf16 v[12:15], v[160:163], a[44:47], v[12:15]
    buffer_load_dwordx4 v249, s[40:43], s66 offen lds
    v_accvgpr_write_b32 a8, -1
    v_mfma_f32_16x16x32_bf16 v[16:19], v[164:167], a[32:35], v[16:19]
    ds_read_b64_tr_b16 v[196:197], v228 offset:29696
    v_accvgpr_write_b32 a9, -1
    v_mfma_f32_16x16x32_bf16 v[20:23], v[164:167], a[36:39], v[20:23]
    v_accvgpr_write_b32 a10, -1
    v_accvgpr_write_b32 a11, -1
    v_mfma_f32_16x16x32_bf16 v[24:27], v[164:167], a[40:43], v[24:27]
    ds_read_b64_tr_b16 v[198:199], v228 offset:30208
    s_waitcnt vmcnt(15)
    ds_write_b128 v253, v[236:239] offset:17120
    v_mfma_f32_16x16x32_bf16 v[28:31], v[164:167], a[44:47], v[28:31]
    ds_read_b64_tr_b16 v[200:201], v229 offset:28672
    ds_write_b128 v253, v[240:243] offset:38336
    v_mfma_f32_16x16x32_bf16 v[32:35], v[168:171], a[32:35], v[32:35]
    s_add_u32 m0, s67, 69632
    s_add_u32 s66, s66, 294912
    v_mfma_f32_16x16x32_bf16 v[36:39], v[168:171], a[36:39], v[36:39]
    ds_read_b64_tr_b16 v[202:203], v229 offset:29184
    ds_write_b128 v253, v[244:247] offset:61088
    v_mfma_f32_16x16x32_bf16 v[40:43], v[168:171], a[40:43], v[40:43]
    buffer_load_dwordx4 v249, s[40:43], s66 offen lds
    v_mfma_f32_16x16x32_bf16 v[44:47], v[168:171], a[44:47], v[44:47]
    ds_read_b64_tr_b16 v[204:205], v229 offset:29696
    v_mfma_f32_16x16x32_bf16 v[48:51], v[172:175], a[32:35], v[48:51]
    ds_read_b64_tr_b16 v[206:207], v229 offset:30208
    v_mfma_f32_16x16x32_bf16 v[52:55], v[172:175], a[36:39], v[52:55]
    v_mfma_f32_16x16x32_bf16 v[56:59], v[172:175], a[40:43], v[56:59]
    ds_read_b64_tr_b16 v[208:209], v230 offset:28672
    v_mfma_f32_16x16x32_bf16 v[60:63], v[172:175], a[44:47], v[60:63]
    v_mfma_f32_16x16x32_bf16 v[64:67], v[176:179], a[32:35], v[64:67]
    ds_read_b64_tr_b16 v[210:211], v230 offset:29184
    v_mfma_f32_16x16x32_bf16 v[68:71], v[176:179], a[36:39], v[68:71]
    ds_read_b64_tr_b16 v[212:213], v230 offset:29696
    s_add_u32 m0, s67, 73728
    v_mfma_f32_16x16x32_bf16 v[72:75], v[176:179], a[40:43], v[72:75]
    s_add_u32 s66, s66, 294912
    v_mfma_f32_16x16x32_bf16 v[76:79], v[176:179], a[44:47], v[76:79]
    ds_read_b64_tr_b16 v[214:215], v230 offset:30208
    buffer_load_dwordx4 v249, s[40:43], s66 offen lds
    v_mfma_f32_16x16x32_bf16 v[80:83], v[180:183], a[32:35], v[80:83]
    v_mfma_f32_16x16x32_bf16 v[84:87], v[180:183], a[36:39], v[84:87]
    ds_read_b64_tr_b16 v[216:217], v231 offset:28672
    v_mfma_f32_16x16x32_bf16 v[88:91], v[180:183], a[40:43], v[88:91]
    ds_read_b64_tr_b16 v[218:219], v231 offset:29184
    v_mfma_f32_16x16x32_bf16 v[92:95], v[180:183], a[44:47], v[92:95]
    v_mfma_f32_16x16x32_bf16 v[96:99], v[184:187], a[32:35], v[96:99]
    ds_read_b64_tr_b16 v[220:221], v231 offset:29696
    v_mfma_f32_16x16x32_bf16 v[100:103], v[184:187], a[36:39], v[100:103]
    v_mfma_f32_16x16x32_bf16 v[104:107], v[184:187], a[40:43], v[104:107]
    ds_read_b64_tr_b16 v[222:223], v231 offset:30208
    s_add_u32 m0, s67, 77824
    v_mfma_f32_16x16x32_bf16 v[108:111], v[184:187], a[44:47], v[108:111]
    s_add_u32 s66, s66, 294912
    v_mfma_f32_16x16x32_bf16 v[112:115], v[188:191], a[32:35], v[112:115]
    buffer_load_dwordx4 v249, s[40:43], s66 offen lds
    v_mfma_f32_16x16x32_bf16 v[116:119], v[188:191], a[36:39], v[116:119]
    v_mfma_f32_16x16x32_bf16 v[120:123], v[188:191], a[40:43], v[120:123]
    v_mfma_f32_16x16x32_bf16 v[124:127], v[188:191], a[44:47], v[124:127]
    s_waitcnt lgkmcnt(1)
    v_mfma_f32_16x16x32_bf16 v[0:3], v[192:195], a[48:51], v[0:3]
    ds_read_b64_tr_b16 v[160:161], v228 offset:36864
    v_mfma_f32_16x16x32_bf16 v[4:7], v[192:195], a[52:55], v[4:7]
    ds_read_b64_tr_b16 v[162:163], v228 offset:37376
    v_lshrrev_b32 v240, 4, v252
    v_mfma_f32_16x16x32_bf16 v[8:11], v[192:195], a[56:59], v[8:11]
    v_lshlrev_b32 v240, 9, v240
    v_bfe_u32 v241, v252, 2, 2
    v_mfma_f32_16x16x32_bf16 v[12:15], v[192:195], a[60:63], v[12:15]
    ds_read_b64_tr_b16 v[164:165], v228 offset:37888
    s_add_u32 m0, s67, 81920
    v_mfma_f32_16x16x32_bf16 v[16:19], v[196:199], a[48:51], v[16:19]
    s_add_u32 s66, s66, 294912
    v_lshlrev_b32 v241, 6, v241
    v_mfma_f32_16x16x32_bf16 v[20:23], v[196:199], a[52:55], v[20:23]
    ds_read_b64_tr_b16 v[166:167], v228 offset:38400
    buffer_load_dwordx4 v249, s[40:43], s66 offen lds
    v_mfma_f32_16x16x32_bf16 v[24:27], v[196:199], a[56:59], v[24:27]
    v_add_u32 v240, v240, v241
    v_and_b32 v241, 3, v252
    v_mfma_f32_16x16x32_bf16 v[28:31], v[196:199], a[60:63], v[28:31]
    ds_read_b64_tr_b16 v[168:169], v229 offset:36864
    v_lshlrev_b32 v241, 3, v241
    v_mfma_f32_16x16x32_bf16 v[32:35], v[200:203], a[48:51], v[32:35]
    ds_read_b64_tr_b16 v[170:171], v229 offset:37376
    v_add_u32 v240, v240, v241
    v_mfma_f32_16x16x32_bf16 v[36:39], v[200:203], a[52:55], v[36:39]
    v_bfe_u32 v241, v252, 4, 1
    v_lshlrev_b32 v241, 5, v241
    v_mfma_f32_16x16x32_bf16 v[40:43], v[200:203], a[56:59], v[40:43]
    ds_read_b64_tr_b16 v[172:173], v229 offset:37888
    v_add_u32 v236, v240, v241
    v_mfma_f32_16x16x32_bf16 v[44:47], v[200:203], a[60:63], v[44:47]
    v_xor_b32 v241, 32, v241
    v_add_u32 v237, v240, v241
    v_mfma_f32_16x16x32_bf16 v[48:51], v[204:207], a[48:51], v[48:51]
    ds_read_b64_tr_b16 v[174:175], v229 offset:38400
    s_add_u32 m0, s67, 86016
    v_mfma_f32_16x16x32_bf16 v[52:55], v[204:207], a[52:55], v[52:55]
    s_add_u32 s66, s66, 294912
    v_add_u32 v238, 61440, v236
    v_mfma_f32_16x16x32_bf16 v[56:59], v[204:207], a[56:59], v[56:59]
    ds_read_b64_tr_b16 v[176:177], v230 offset:36864
    buffer_load_dwordx4 v249, s[40:43], s66 offen lds
    v_mfma_f32_16x16x32_bf16 v[60:63], v[204:207], a[60:63], v[60:63]
    ds_read_b64_tr_b16 v[178:179], v230 offset:37376
    v_add_u32 v239, 61440, v237
    v_mfma_f32_16x16x32_bf16 v[64:67], v[208:211], a[48:51], v[64:67]
    v_add_u32 v240, 122880, v236
    v_add_u32 v241, 122880, v237
    v_mfma_f32_16x16x32_bf16 v[68:71], v[208:211], a[52:55], v[68:71]
    ds_read_b64_tr_b16 v[180:181], v230 offset:37888
    v_and_b32 v253, 7, v252
    v_mfma_f32_16x16x32_bf16 v[72:75], v[208:211], a[56:59], v[72:75]
    v_lshlrev_b32 v253, 10, v253
    s_and_b32 s71, s2, 0xc7
    v_mfma_f32_16x16x32_bf16 v[76:79], v[208:211], a[60:63], v[76:79]
    ds_read_b64_tr_b16 v[182:183], v230 offset:38400
    s_lshl_b32 s71, s71, 7
    v_mfma_f32_16x16x32_bf16 v[80:83], v[212:215], a[48:51], v[80:83]
    v_add_u32 v253, s71, v253
    s_mov_b32 s48, 65536
    v_mfma_f32_16x16x32_bf16 v[84:87], v[212:215], a[52:55], v[84:87]
    ds_read_b64_tr_b16 v[184:185], v231 offset:36864
    s_add_u32 s66, s5, 16384
    v_mfma_f32_16x16x32_bf16 v[88:91], v[212:215], a[56:59], v[88:91]
    ds_read_b64_tr_b16 v[186:187], v231 offset:37376
    s_xor_b32 s71, s4, 256
    v_mfma_f32_16x16x32_bf16 v[92:95], v[212:215], a[60:63], v[92:95]
    buffer_store_dwordx4 a[8:11], v250, s[36:39], s66 offen offset:0 sc1
    s_sub_u32 s71, s71, 65536
    v_mfma_f32_16x16x32_bf16 v[96:99], v[216:219], a[48:51], v[96:99]
    ds_read_b64_tr_b16 v[188:189], v231 offset:37888
    v_mov_b32 v254, s71
    v_mfma_f32_16x16x32_bf16 v[100:103], v[216:219], a[52:55], v[100:103]
    v_cmp_gt_u32 s[74:75], 32, v252
    s_nop 1
    v_mfma_f32_16x16x32_bf16 v[104:107], v[216:219], a[56:59], v[104:107]
    ds_read_b64_tr_b16 v[190:191], v231 offset:38400
    v_cndmask_b32 v253, v254, v253, s[74:75]
    v_mfma_f32_16x16x32_bf16 v[108:111], v[216:219], a[60:63], v[108:111]
    s_mov_b32 s8, s52
    s_mov_b32 s9, s53
    s_waitcnt lgkmcnt(4)
    v_mfma_f32_16x16x32_bf16 v[112:115], v[220:223], a[48:51], v[112:115]
    s_mov_b32 s10, 5308416
    v_mfma_f32_16x16x32_bf16 v[116:119], v[220:223], a[52:55], v[116:119]
    v_min_u32 v244, 40, v252
    v_lshlrev_b32 v244, 7, v244
    v_mfma_f32_16x16x32_bf16 v[120:123], v[220:223], a[56:59], v[120:123]
    buffer_store_dwordx4 a[8:11], v250, s[36:39], s66 offen offset:1024 sc1
    s_lshl_b32 s71, s13, 2
    v_mfma_f32_16x16x32_bf16 v[124:127], v[220:223], a[60:63], v[124:127]
    s_add_u32 s71, s71, s17
    s_mul_i32 s64, s71, 10368
    v_mfma_f32_16x16x32_bf16 v[0:3], v[160:163], a[64:67], v[0:3]
    ds_read_b64_tr_b16 v[192:193], v228 offset:45056
    s_add_u32 s64, s64, s19
    v_mfma_f32_16x16x32_bf16 v[4:7], v[160:163], a[68:71], v[4:7]
    ds_read_b64_tr_b16 v[194:195], v228 offset:45568
    s_and_b32 s71, s2, 1
    v_mfma_f32_16x16x32_bf16 v[8:11], v[160:163], a[72:75], v[8:11]
    s_mul_i32 s71, s71, 5248
    s_add_u32 s64, s64, s71
    v_mfma_f32_16x16x32_bf16 v[12:15], v[160:163], a[76:79], v[12:15]
    ds_read_b64_tr_b16 v[196:197], v228 offset:46080
    v_mfma_f32_16x16x32_bf16 v[16:19], v[164:167], a[64:67], v[16:19]
    s_lshr_b32 s66, s2, 6
    s_cmp_eq_u32 s66, 0
    s_cselect_b32 s66, s64, 0x80000000
    v_mfma_f32_16x16x32_bf16 v[20:23], v[164:167], a[68:71], v[20:23]
    ds_read_b64_tr_b16 v[198:199], v228 offset:46592
    buffer_load_dword v245, v244, s[8:11], s66 offen
    v_mfma_f32_16x16x32_bf16 v[24:27], v[164:167], a[72:75], v[24:27]
    s_lshr_b32 s66, s2, 6
    s_cmp_eq_u32 s66, 1
    s_cselect_b32 s66, s64, 0x80000000
    v_mfma_f32_16x16x32_bf16 v[28:31], v[164:167], a[76:79], v[28:31]
    ds_read_b64_tr_b16 v[200:201], v229 offset:45056
    buffer_load_dword v245, v244, s[8:11], s66 offen
    v_mfma_f32_16x16x32_bf16 v[32:35], v[168:171], a[64:67], v[32:35]
    ds_read_b64_tr_b16 v[202:203], v229 offset:45568
    s_lshr_b32 s66, s2, 6
    s_cmp_eq_u32 s66, 2
    s_cselect_b32 s66, s64, 0x80000000
    v_mfma_f32_16x16x32_bf16 v[36:39], v[168:171], a[68:71], v[36:39]
    buffer_load_dword v245, v244, s[8:11], s66 offen
    v_mfma_f32_16x16x32_bf16 v[40:43], v[168:171], a[72:75], v[40:43]
    ds_read_b64_tr_b16 v[204:205], v229 offset:46080
    s_lshr_b32 s66, s2, 6
    s_cmp_eq_u32 s66, 3
    s_cselect_b32 s66, s64, 0x80000000
    v_mfma_f32_16x16x32_bf16 v[44:47], v[168:171], a[76:79], v[44:47]
    v_mfma_f32_16x16x32_bf16 v[48:51], v[172:175], a[64:67], v[48:51]
    ds_read_b64_tr_b16 v[206:207], v229 offset:46592
    buffer_load_dword v245, v244, s[8:11], s66 offen
    v_mfma_f32_16x16x32_bf16 v[52:55], v[172:175], a[68:71], v[52:55]
    v_mfma_f32_16x16x32_bf16 v[56:59], v[172:175], a[72:75], v[56:59]
    ds_read_b64_tr_b16 v[208:209], v230 offset:45056
    v_mfma_f32_16x16x32_bf16 v[60:63], v[172:175], a[76:79], v[60:63]
    ds_read_b64_tr_b16 v[210:211], v230 offset:45568
    v_mfma_f32_16x16x32_bf16 v[64:67], v[176:179], a[64:67], v[64:67]
    v_mfma_f32_16x16x32_bf16 v[68:71], v[176:179], a[68:71], v[68:71]
    ds_read_b64_tr_b16 v[212:213], v230 offset:46080
    v_mfma_f32_16x16x32_bf16 v[72:75], v[176:179], a[72:75], v[72:75]
    v_mfma_f32_16x16x32_bf16 v[76:79], v[176:179], a[76:79], v[76:79]
    ds_read_b64_tr_b16 v[214:215], v230 offset:46592
    v_mfma_f32_16x16x32_bf16 v[80:83], v[180:183], a[64:67], v[80:83]
    v_mfma_f32_16x16x32_bf16 v[84:87], v[180:183], a[68:71], v[84:87]
    ds_read_b64_tr_b16 v[216:217], v231 offset:45056
    v_mfma_f32_16x16x32_bf16 v[88:91], v[180:183], a[72:75], v[88:91]
    ds_read_b64_tr_b16 v[218:219], v231 offset:45568
    v_mfma_f32_16x16x32_bf16 v[92:95], v[180:183], a[76:79], v[92:95]
    s_waitcnt lgkmcnt(4)
    v_mfma_f32_16x16x32_bf16 v[96:99], v[184:187], a[64:67], v[96:99]
    ds_read_b64_tr_b16 v[220:221], v231 offset:46080
    v_mfma_f32_16x16x32_bf16 v[100:103], v[184:187], a[68:71], v[100:103]
    v_mfma_f32_16x16x32_bf16 v[104:107], v[184:187], a[72:75], v[104:107]
    ds_read_b64_tr_b16 v[222:223], v231 offset:46592
    v_mfma_f32_16x16x32_bf16 v[108:111], v[184:187], a[76:79], v[108:111]
    v_mfma_f32_16x16x32_bf16 v[112:115], v[188:191], a[64:67], v[112:115]
    v_mfma_f32_16x16x32_bf16 v[116:119], v[188:191], a[68:71], v[116:119]
    v_mfma_f32_16x16x32_bf16 v[120:123], v[188:191], a[72:75], v[120:123]
    v_mfma_f32_16x16x32_bf16 v[124:127], v[188:191], a[76:79], v[124:127]
    v_mfma_f32_16x16x32_bf16 v[0:3], v[192:195], a[80:83], v[0:3]
    s_waitcnt lgkmcnt(0)
    s_barrier
    v_mfma_f32_16x16x32_bf16 v[4:7], v[192:195], a[84:87], v[4:7]
    ds_read_b64_tr_b16 v[160:161], v228 offset:53248
    s_add_u32 m0, s51, 90112
    v_mfma_f32_16x16x32_bf16 v[8:11], v[192:195], a[88:91], v[8:11]
    ds_read_b64_tr_b16 v[162:163], v228 offset:53760
    s_add_u32 s66, s49, s96
    v_mfma_f32_16x16x32_bf16 v[12:15], v[192:195], a[92:95], v[12:15]
    buffer_load_dwordx4 v248, s[20:23], s66 offen lds
    v_mfma_f32_16x16x32_bf16 v[16:19], v[196:199], a[80:83], v[16:19]
    ds_read_b64_tr_b16 v[164:165], v228 offset:54272
    v_mfma_f32_16x16x32_bf16 v[20:23], v[196:199], a[84:87], v[20:23]
    v_mfma_f32_16x16x32_bf16 v[24:27], v[196:199], a[88:91], v[24:27]
    ds_read_b64_tr_b16 v[166:167], v228 offset:54784
    buffer_load_dwordx4 v248, s[24:27], s66 offen offset:1024 lds
    v_mfma_f32_16x16x32_bf16 v[28:31], v[196:199], a[92:95], v[28:31]
    ds_read_b64_tr_b16 v[168:169], v229 offset:53248
    v_mfma_f32_16x16x32_bf16 v[32:35], v[200:203], a[80:83], v[32:35]
    s_add_u32 m0, s51, 98304
    s_add_u32 s66, s66, 294912
    v_mfma_f32_16x16x32_bf16 v[36:39], v[200:203], a[84:87], v[36:39]
    ds_read_b64_tr_b16 v[170:171], v229 offset:53760
    v_mfma_f32_16x16x32_bf16 v[40:43], v[200:203], a[88:91], v[40:43]
    buffer_load_dwordx4 v248, s[20:23], s66 offen lds
    v_mfma_f32_16x16x32_bf16 v[44:47], v[200:203], a[92:95], v[44:47]
    ds_read_b64_tr_b16 v[172:173], v229 offset:54272
    v_mfma_f32_16x16x32_bf16 v[48:51], v[204:207], a[80:83], v[48:51]
    ds_read_b64_tr_b16 v[174:175], v229 offset:54784
    v_mfma_f32_16x16x32_bf16 v[52:55], v[204:207], a[84:87], v[52:55]
    v_mfma_f32_16x16x32_bf16 v[56:59], v[204:207], a[88:91], v[56:59]
    ds_read_b64_tr_b16 v[176:177], v230 offset:53248
    v_mfma_f32_16x16x32_bf16 v[60:63], v[204:207], a[92:95], v[60:63]
    buffer_load_dwordx4 v248, s[24:27], s66 offen offset:1024 lds
    v_mfma_f32_16x16x32_bf16 v[64:67], v[208:211], a[80:83], v[64:67]
    ds_read_b64_tr_b16 v[178:179], v230 offset:53760
    v_mfma_f32_16x16x32_bf16 v[68:71], v[208:211], a[84:87], v[68:71]
    ds_read_b64_tr_b16 v[180:181], v230 offset:54272
    s_add_u32 m0, s51, 106496
    v_mfma_f32_16x16x32_bf16 v[72:75], v[208:211], a[88:91], v[72:75]
    s_add_u32 s66, s66, 294912
    v_mfma_f32_16x16x32_bf16 v[76:79], v[208:211], a[92:95], v[76:79]
    ds_read_b64_tr_b16 v[182:183], v230 offset:54784
    buffer_load_dwordx4 v248, s[20:23], s66 offen lds
    v_mfma_f32_16x16x32_bf16 v[80:83], v[212:215], a[80:83], v[80:83]
    v_mfma_f32_16x16x32_bf16 v[84:87], v[212:215], a[84:87], v[84:87]
    ds_read_b64_tr_b16 v[184:185], v231 offset:53248
    v_mfma_f32_16x16x32_bf16 v[88:91], v[212:215], a[88:91], v[88:91]
    ds_read_b64_tr_b16 v[186:187], v231 offset:53760
    v_mfma_f32_16x16x32_bf16 v[92:95], v[212:215], a[92:95], v[92:95]
    v_mfma_f32_16x16x32_bf16 v[96:99], v[216:219], a[80:83], v[96:99]
    ds_read_b64_tr_b16 v[188:189], v231 offset:54272
    buffer_load_dwordx4 v248, s[24:27], s66 offen offset:1024 lds
    v_mfma_f32_16x16x32_bf16 v[100:103], v[216:219], a[84:87], v[100:103]
    v_mfma_f32_16x16x32_bf16 v[104:107], v[216:219], a[88:91], v[104:107]
    ds_read_b64_tr_b16 v[190:191], v231 offset:54784
    v_mfma_f32_16x16x32_bf16 v[108:111], v[216:219], a[92:95], v[108:111]
    v_mfma_f32_16x16x32_bf16 v[112:115], v[220:223], a[80:83], v[112:115]
    v_mfma_f32_16x16x32_bf16 v[116:119], v[220:223], a[84:87], v[116:119]
    v_mfma_f32_16x16x32_bf16 v[120:123], v[220:223], a[88:91], v[120:123]
    v_mfma_f32_16x16x32_bf16 v[124:127], v[220:223], a[92:95], v[124:127]
    s_waitcnt lgkmcnt(1)
    v_mfma_f32_16x16x32_bf16 v[0:3], v[160:163], a[96:99], v[0:3]
    ds_read_b64_tr_b16 v[192:193], v232 offset:0
    v_mfma_f32_16x16x32_bf16 v[4:7], v[160:163], a[100:103], v[4:7]
    ds_read_b64_tr_b16 v[194:195], v232 offset:512
    v_mfma_f32_16x16x32_bf16 v[8:11], v[160:163], a[104:107], v[8:11]
    v_mfma_f32_16x16x32_bf16 v[12:15], v[160:163], a[108:111], v[12:15]
    ds_read_b64_tr_b16 v[196:197], v232 offset:1024
    v_mfma_f32_16x16x32_bf16 v[16:19], v[164:167], a[96:99], v[16:19]
    v_mfma_f32_16x16x32_bf16 v[20:23], v[164:167], a[100:103], v[20:23]
    ds_read_b64_tr_b16 v[198:199], v232 offset:1536
    v_mfma_f32_16x16x32_bf16 v[24:27], v[164:167], a[104:107], v[24:27]
    v_mfma_f32_16x16x32_bf16 v[28:31], v[164:167], a[108:111], v[28:31]
    ds_read_b64_tr_b16 v[200:201], v233 offset:0
    v_mfma_f32_16x16x32_bf16 v[32:35], v[168:171], a[96:99], v[32:35]
    ds_read_b64_tr_b16 v[202:203], v233 offset:512
    v_mfma_f32_16x16x32_bf16 v[36:39], v[168:171], a[100:103], v[36:39]
    v_mfma_f32_16x16x32_bf16 v[40:43], v[168:171], a[104:107], v[40:43]
    ds_read_b64_tr_b16 v[204:205], v233 offset:1024
    v_mfma_f32_16x16x32_bf16 v[44:47], v[168:171], a[108:111], v[44:47]
    v_mfma_f32_16x16x32_bf16 v[48:51], v[172:175], a[96:99], v[48:51]
    ds_read_b64_tr_b16 v[206:207], v233 offset:1536
    v_mfma_f32_16x16x32_bf16 v[52:55], v[172:175], a[100:103], v[52:55]
    v_mfma_f32_16x16x32_bf16 v[56:59], v[172:175], a[104:107], v[56:59]
    ds_read_b64_tr_b16 v[208:209], v234 offset:0
    v_mfma_f32_16x16x32_bf16 v[60:63], v[172:175], a[108:111], v[60:63]
    ds_read_b64_tr_b16 v[210:211], v234 offset:512
    v_mfma_f32_16x16x32_bf16 v[64:67], v[176:179], a[96:99], v[64:67]
    v_mfma_f32_16x16x32_bf16 v[68:71], v[176:179], a[100:103], v[68:71]
    ds_read_b64_tr_b16 v[212:213], v234 offset:1024
    v_mfma_f32_16x16x32_bf16 v[72:75], v[176:179], a[104:107], v[72:75]
    v_mfma_f32_16x16x32_bf16 v[76:79], v[176:179], a[108:111], v[76:79]
    ds_read_b64_tr_b16 v[214:215], v234 offset:1536
    v_mfma_f32_16x16x32_bf16 v[80:83], v[180:183], a[96:99], v[80:83]
    v_mfma_f32_16x16x32_bf16 v[84:87], v[180:183], a[100:103], v[84:87]
    ds_read_b64_tr_b16 v[216:217], v235 offset:0
    v_mfma_f32_16x16x32_bf16 v[88:91], v[180:183], a[104:107], v[88:91]
    ds_read_b64_tr_b16 v[218:219], v235 offset:512
    v_mfma_f32_16x16x32_bf16 v[92:95], v[180:183], a[108:111], v[92:95]
    v_mfma_f32_16x16x32_bf16 v[96:99], v[184:187], a[96:99], v[96:99]
    ds_read_b64_tr_b16 v[220:221], v235 offset:1024
    v_mfma_f32_16x16x32_bf16 v[100:103], v[184:187], a[100:103], v[100:103]
    v_mfma_f32_16x16x32_bf16 v[104:107], v[184:187], a[104:107], v[104:107]
    ds_read_b64_tr_b16 v[222:223], v235 offset:1536
    v_mfma_f32_16x16x32_bf16 v[108:111], v[184:187], a[108:111], v[108:111]
    s_waitcnt lgkmcnt(4)
    v_mfma_f32_16x16x32_bf16 v[112:115], v[188:191], a[96:99], v[112:115]
    v_mfma_f32_16x16x32_bf16 v[116:119], v[188:191], a[100:103], v[116:119]
    v_mfma_f32_16x16x32_bf16 v[120:123], v[188:191], a[104:107], v[120:123]
    v_mfma_f32_16x16x32_bf16 v[124:127], v[188:191], a[108:111], v[124:127]
    v_mfma_f32_16x16x32_bf16 v[0:3], v[192:195], a[112:115], v[0:3]
    ds_read_b64_tr_b16 v[160:161], v232 offset:8192
    v_mfma_f32_16x16x32_bf16 v[4:7], v[192:195], a[116:119], v[4:7]
    ds_read_b64_tr_b16 v[162:163], v232 offset:8704
    v_mfma_f32_16x16x32_bf16 v[8:11], v[192:195], a[120:123], v[8:11]
    v_mfma_f32_16x16x32_bf16 v[12:15], v[192:195], a[124:127], v[12:15]
    ds_read_b64_tr_b16 v[164:165], v232 offset:9216
    v_mfma_f32_16x16x32_bf16 v[16:19], v[196:199], a[112:115], v[16:19]
    v_mfma_f32_16x16x32_bf16 v[20:23], v[196:199], a[116:119], v[20:23]
    ds_read_b64_tr_b16 v[166:167], v232 offset:9728
    v_mfma_f32_16x16x32_bf16 v[24:27], v[196:199], a[120:123], v[24:27]
    v_mfma_f32_16x16x32_bf16 v[28:31], v[196:199], a[124:127], v[28:31]
    ds_read_b64_tr_b16 v[168:169], v233 offset:8192
    v_mfma_f32_16x16x32_bf16 v[32:35], v[200:203], a[112:115], v[32:35]
    ds_read_b64_tr_b16 v[170:171], v233 offset:8704
    v_mfma_f32_16x16x32_bf16 v[36:39], v[200:203], a[116:119], v[36:39]
    v_mfma_f32_16x16x32_bf16 v[40:43], v[200:203], a[120:123], v[40:43]
    ds_read_b64_tr_b16 v[172:173], v233 offset:9216
    v_mfma_f32_16x16x32_bf16 v[44:47], v[200:203], a[124:127], v[44:47]
    v_mfma_f32_16x16x32_bf16 v[48:51], v[204:207], a[112:115], v[48:51]
    ds_read_b64_tr_b16 v[174:175], v233 offset:9728
    v_mfma_f32_16x16x32_bf16 v[52:55], v[204:207], a[116:119], v[52:55]
    v_mfma_f32_16x16x32_bf16 v[56:59], v[204:207], a[120:123], v[56:59]
    ds_read_b64_tr_b16 v[176:177], v234 offset:8192
    v_mfma_f32_16x16x32_bf16 v[60:63], v[204:207], a[124:127], v[60:63]
    ds_read_b64_tr_b16 v[178:179], v234 offset:8704
    v_mfma_f32_16x16x32_bf16 v[64:67], v[208:211], a[112:115], v[64:67]
    v_mfma_f32_16x16x32_bf16 v[68:71], v[208:211], a[116:119], v[68:71]
    ds_read_b64_tr_b16 v[180:181], v234 offset:9216
    v_mfma_f32_16x16x32_bf16 v[72:75], v[208:211], a[120:123], v[72:75]
    v_mfma_f32_16x16x32_bf16 v[76:79], v[208:211], a[124:127], v[76:79]
    ds_read_b64_tr_b16 v[182:183], v234 offset:9728
    v_mfma_f32_16x16x32_bf16 v[80:83], v[212:215], a[112:115], v[80:83]
    v_mfma_f32_16x16x32_bf16 v[84:87], v[212:215], a[116:119], v[84:87]
    ds_read_b64_tr_b16 v[184:185], v235 offset:8192
    v_mfma_f32_16x16x32_bf16 v[88:91], v[212:215], a[120:123], v[88:91]
    ds_read_b64_tr_b16 v[186:187], v235 offset:8704
    v_mfma_f32_16x16x32_bf16 v[92:95], v[212:215], a[124:127], v[92:95]
    s_waitcnt lgkmcnt(4)
    v_mfma_f32_16x16x32_bf16 v[96:99], v[216:219], a[112:115], v[96:99]
    ds_read_b64_tr_b16 v[188:189], v235 offset:9216
    v_mfma_f32_16x16x32_bf16 v[100:103], v[216:219], a[116:119], v[100:103]
    v_mfma_f32_16x16x32_bf16 v[104:107], v[216:219], a[120:123], v[104:107]
    ds_read_b64_tr_b16 v[190:191], v235 offset:9728
    v_mfma_f32_16x16x32_bf16 v[108:111], v[216:219], a[124:127], v[108:111]
    v_mfma_f32_16x16x32_bf16 v[112:115], v[220:223], a[112:115], v[112:115]
    v_mfma_f32_16x16x32_bf16 v[116:119], v[220:223], a[116:119], v[116:119]
    v_mfma_f32_16x16x32_bf16 v[120:123], v[220:223], a[120:123], v[120:123]
    v_mfma_f32_16x16x32_bf16 v[124:127], v[220:223], a[124:127], v[124:127]
    v_mfma_f32_16x16x32_bf16 v[0:3], v[160:163], a[128:131], v[0:3]
    s_waitcnt vmcnt(18)
    s_waitcnt lgkmcnt(0)
    s_barrier
    v_mfma_f32_16x16x32_bf16 v[4:7], v[160:163], a[132:135], v[4:7]
    ds_read_b64_tr_b16 v[192:193], v232 offset:16384
    v_mov_b32 v255, 2
    buffer_store_dword v255, off, s[36:39], s4 offset:0 sc1
    v_mfma_f32_16x16x32_bf16 v[8:11], v[160:163], a[136:139], v[8:11]
    ds_read_b64_tr_b16 v[194:195], v232 offset:16896
    s_add_u32 m0, s51, 114688
    v_mfma_f32_16x16x32_bf16 v[12:15], v[160:163], a[140:143], v[12:15]
    s_add_u32 s66, s49, s96
    s_add_u32 s66, s66, 884736
    v_mfma_f32_16x16x32_bf16 v[16:19], v[164:167], a[128:131], v[16:19]
    ds_read_b64_tr_b16 v[196:197], v232 offset:17408
    buffer_load_dwordx4 v248, s[20:23], s66 offen lds
    v_mfma_f32_16x16x32_bf16 v[20:23], v[164:167], a[132:135], v[20:23]
    s_lshl_b32 s8, s14, 7
    s_lshl_b32 s72, s16, 5
    v_mfma_f32_16x16x32_bf16 v[24:27], v[164:167], a[136:139], v[24:27]
    ds_read_b64_tr_b16 v[198:199], v232 offset:17920
    s_add_u32 s8, s8, s72
    v_mfma_f32_16x16x32_bf16 v[28:31], v[164:167], a[140:143], v[28:31]
    ds_read_b64_tr_b16 v[200:201], v233 offset:16384
    buffer_load_dwordx4 v248, s[24:27], s66 offen offset:1024 lds
    v_mfma_f32_16x16x32_bf16 v[32:35], v[168:171], a[128:131], v[32:35]
    s_sub_u32 s73, 7, s15
    s_min_u32 s73, s73, s15
    v_mfma_f32_16x16x32_bf16 v[36:39], v[168:171], a[132:135], v[36:39]
    ds_read_b64_tr_b16 v[202:203], v233 offset:16896
    s_add_u32 m0, s51, 122880
    v_mfma_f32_16x16x32_bf16 v[40:43], v[168:171], a[136:139], v[40:43]
    s_add_u32 s66, s66, 294912
    s_lshl_b32 s73, s73, 6
    v_mfma_f32_16x16x32_bf16 v[44:47], v[168:171], a[140:143], v[44:47]
    ds_read_b64_tr_b16 v[204:205], v233 offset:17408
    buffer_load_dwordx4 v248, s[20:23], s66 offen lds
    v_mfma_f32_16x16x32_bf16 v[48:51], v[172:175], a[128:131], v[48:51]
    ds_read_b64_tr_b16 v[206:207], v233 offset:17920
    s_lshl_b32 s74, s14, 4
    v_mfma_f32_16x16x32_bf16 v[52:55], v[172:175], a[132:135], v[52:55]
    s_lshl_b32 s72, s16, 2
    s_add_u32 s74, s74, s72
    v_mfma_f32_16x16x32_bf16 v[56:59], v[172:175], a[136:139], v[56:59]
    ds_read_b64_tr_b16 v[208:209], v234 offset:16384
    s_add_u32 s9, s73, s74
    v_mfma_f32_16x16x32_bf16 v[60:63], v[172:175], a[140:143], v[60:63]
    s_lshr_b32 s72, s79, 4
    s_lshl_b32 s72, s72, 7
    v_mfma_f32_16x16x32_bf16 v[64:67], v[176:179], a[128:131], v[64:67]
    ds_read_b64_tr_b16 v[210:211], v234 offset:16896
    buffer_load_dwordx4 v248, s[24:27], s66 offen offset:1024 lds
    v_mfma_f32_16x16x32_bf16 v[68:71], v[176:179], a[132:135], v[68:71]
    ds_read_b64_tr_b16 v[212:213], v234 offset:17408
    s_lshl_b32 s73, s17, 5
    v_mfma_f32_16x16x32_bf16 v[72:75], v[176:179], a[136:139], v[72:75]
    s_add_u32 m0, s51, 131072
    s_add_u32 s66, s66, 294912
    v_mfma_f32_16x16x32_bf16 v[76:79], v[176:179], a[140:143], v[76:79]
    ds_read_b64_tr_b16 v[214:215], v234 offset:17920
    s_add_u32 s72, s72, s73
    v_mfma_f32_16x16x32_bf16 v[80:83], v[180:183], a[128:131], v[80:83]
    buffer_load_dwordx4 v248, s[20:23], s66 offen lds
    s_lshl_b32 s60, s8, 12
    v_mfma_f32_16x16x32_bf16 v[84:87], v[180:183], a[132:135], v[84:87]
    ds_read_b64_tr_b16 v[216:217], v235 offset:16384
    s_lshl_b32 s73, s72, 1
    v_mfma_f32_16x16x32_bf16 v[88:91], v[180:183], a[136:139], v[88:91]
    ds_read_b64_tr_b16 v[218:219], v235 offset:16896
    s_add_u32 s60, s60, s73
    v_mfma_f32_16x16x32_bf16 v[92:95], v[180:183], a[140:143], v[92:95]
    s_add_u32 s60, s60, 24117248
    s_lshl_b32 s64, s74, 12
    v_mfma_f32_16x16x32_bf16 v[96:99], v[184:187], a[128:131], v[96:99]
    ds_read_b64_tr_b16 v[220:221], v235 offset:17408
    s_add_u32 s64, s64, s73
    v_mfma_f32_16x16x32_bf16 v[100:103], v[184:187], a[132:135], v[100:103]
    buffer_load_dwordx4 v248, s[24:27], s66 offen offset:1024 lds
    s_add_u32 s64, s64, 26214400
    v_mfma_f32_16x16x32_bf16 v[104:107], v[184:187], a[136:139], v[104:107]
    ds_read_b64_tr_b16 v[222:223], v235 offset:17920
    s_add_u32 s30, s64, 4096
    v_mfma_f32_16x16x32_bf16 v[108:111], v[184:187], a[140:143], v[108:111]
    s_lshl_b32 s61, s72, 2
    s_add_u32 s61, s61, 27262976
    v_mfma_f32_16x16x32_bf16 v[112:115], v[188:191], a[128:131], v[112:115]
    s_mul_i32 s47, s72, 1152
    s_lshl_b32 s73, s8, 1
    v_mfma_f32_16x16x32_bf16 v[116:119], v[188:191], a[132:135], v[116:119]
    s_add_u32 s65, s47, s73
    s_add_u32 s68, s65, 18432
    v_mfma_f32_16x16x32_bf16 v[120:123], v[188:191], a[136:139], v[120:123]
    s_lshl_b32 s73, s74, 1
    s_add_u32 s47, s47, s73
    v_mfma_f32_16x16x32_bf16 v[124:127], v[188:191], a[140:143], v[124:127]
    s_add_u32 s47, s47, 1024
    s_mov_b32 s69, 65536
    s_waitcnt lgkmcnt(1)
    v_mfma_f32_16x16x32_bf16 v[0:3], v[192:195], a[144:147], v[0:3]
    ds_read_b64_tr_b16 v[160:161], v232 offset:24576
    v_mfma_f32_16x16x32_bf16 v[4:7], v[192:195], a[148:151], v[4:7]
    ds_read_b64_tr_b16 v[162:163], v232 offset:25088
    s_add_u32 s70, s5, 8192
    v_mfma_f32_16x16x32_bf16 v[8:11], v[192:195], a[152:155], v[8:11]
    s_add_u32 s11, s5, 16384
    s_add_u32 s10, s51, 139264
    v_mfma_f32_16x16x32_bf16 v[12:15], v[192:195], a[156:159], v[12:15]
    ds_read_b64_tr_b16 v[164:165], v232 offset:25600
    s_xor_b32 s72, s16, 3
    v_mfma_f32_16x16x32_bf16 v[16:19], v[196:199], a[144:147], v[16:19]
    s_mul_i32 s44, s72, 24576
    s_xor_b32 s72, s16, 2
    v_mfma_f32_16x16x32_bf16 v[20:23], v[196:199], a[148:151], v[20:23]
    ds_read_b64_tr_b16 v[166:167], v232 offset:26112
    s_mul_i32 s45, s72, 24576
    v_mfma_f32_16x16x32_bf16 v[24:27], v[196:199], a[152:155], v[24:27]
    s_xor_b32 s72, s16, 1
    s_mul_i32 s46, s72, 24576
    v_mfma_f32_16x16x32_bf16 v[28:31], v[196:199], a[156:159], v[28:31]
    ds_read_b64_tr_b16 v[168:169], v233 offset:24576
    s_and_b32 s72, s16, 1
    v_mfma_f32_16x16x32_bf16 v[32:35], v[200:203], a[144:147], v[32:35]
    ds_read_b64_tr_b16 v[170:171], v233 offset:25088
    s_lshl_b32 s72, s72, 13
    v_mfma_f32_16x16x32_bf16 v[36:39], v[200:203], a[148:151], v[36:39]
    s_add_u32 s72, s72, s80
    s_add_u32 s44, s44, s72
    v_mfma_f32_16x16x32_bf16 v[40:43], v[200:203], a[152:155], v[40:43]
    ds_read_b64_tr_b16 v[172:173], v233 offset:25600
    s_add_u32 s45, s45, s72
    v_mfma_f32_16x16x32_bf16 v[44:47], v[200:203], a[156:159], v[44:47]
    s_add_u32 s46, s46, s80
    s_add_u32 s46, s46, 16384
    v_mfma_f32_16x16x32_bf16 v[48:51], v[204:207], a[144:147], v[48:51]
    ds_read_b64_tr_b16 v[174:175], v233 offset:26112
    s_lshr_b32 s72, s16, 1
    v_mfma_f32_16x16x32_bf16 v[52:55], v[204:207], a[148:151], v[52:55]
    s_lshl_b32 s72, s72, 7
    s_lshl_b32 s73, s14, 8
    v_mfma_f32_16x16x32_bf16 v[56:59], v[204:207], a[152:155], v[56:59]
    ds_read_b64_tr_b16 v[176:177], v234 offset:24576
    s_add_u32 s99, s72, s73
    v_mfma_f32_16x16x32_bf16 v[60:63], v[204:207], a[156:159], v[60:63]
    ds_read_b64_tr_b16 v[178:179], v234 offset:25088
    s_xor_b32 s98, s99, 128
    v_mfma_f32_16x16x32_bf16 v[64:67], v[208:211], a[144:147], v[64:67]
    s_lshr_b32 s73, s2, 6
    s_xor_b32 s73, s73, s14
    v_mfma_f32_16x16x32_bf16 v[68:71], v[208:211], a[148:151], v[68:71]
    ds_read_b64_tr_b16 v[180:181], v234 offset:25600
    s_lshr_b32 s72, s17, 1
    v_mfma_f32_16x16x32_bf16 v[72:75], v[208:211], a[152:155], v[72:75]
    s_lshr_b32 s74, s73, 1
    s_xor_b32 s72, s72, s74
    v_mfma_f32_16x16x32_bf16 v[76:79], v[208:211], a[156:159], v[76:79]
    ds_read_b64_tr_b16 v[182:183], v234 offset:26112
    s_cmp_eq_u32 s16, 1
    s_cselect_b32 s74, 10, 18
    v_mfma_f32_16x16x32_bf16 v[80:83], v[212:215], a[144:147], v[80:83]
    s_mul_i32 s72, s72, s74
    s_mul_i32 s72, s72, 36864
    v_mfma_f32_16x16x32_bf16 v[84:87], v[212:215], a[148:151], v[84:87]
    ds_read_b64_tr_b16 v[184:185], v235 offset:24576
    s_and_b32 s74, s17, 1
    v_mfma_f32_16x16x32_bf16 v[88:91], v[212:215], a[152:155], v[88:91]
    ds_read_b64_tr_b16 v[186:187], v235 offset:25088
    s_mul_i32 s74, s74, 9216
    v_mfma_f32_16x16x32_bf16 v[92:95], v[212:215], a[156:159], v[92:95]
    s_add_u32 s74, s74, s19
    s_add_u32 s74, s74, 589824
    v_mfma_f32_16x16x32_bf16 v[96:99], v[216:219], a[144:147], v[96:99]
    ds_read_b64_tr_b16 v[188:189], v235 offset:25600
    s_add_u32 s97, s74, s72
    v_mfma_f32_16x16x32_bf16 v[100:103], v[216:219], a[148:151], v[100:103]
    v_mfma_f32_16x16x32_bf16 v[104:107], v[216:219], a[152:155], v[104:107]
    ds_read_b64_tr_b16 v[190:191], v235 offset:26112
    v_mfma_f32_16x16x32_bf16 v[108:111], v[216:219], a[156:159], v[108:111]
    s_waitcnt lgkmcnt(4)
    v_mfma_f32_16x16x32_bf16 v[112:115], v[220:223], a[144:147], v[112:115]
    v_mfma_f32_16x16x32_bf16 v[116:119], v[220:223], a[148:151], v[116:119]
    v_mfma_f32_16x16x32_bf16 v[120:123], v[220:223], a[152:155], v[120:123]
    v_mfma_f32_16x16x32_bf16 v[124:127], v[220:223], a[156:159], v[124:127]
    v_mfma_f32_16x16x32_bf16 v[0:3], v[160:163], a[160:163], v[0:3]
    ds_read_b64_tr_b16 v[192:193], v232 offset:32768
    buffer_load_dword v255, v253, s[36:39], s48 offen sc1
    v_mfma_f32_16x16x32_bf16 v[4:7], v[160:163], a[164:167], v[4:7]
    ds_read_b64_tr_b16 v[194:195], v232 offset:33280
    v_mfma_f32_16x16x32_bf16 v[8:11], v[160:163], a[168:171], v[8:11]
    v_mfma_f32_16x16x32_bf16 v[12:15], v[160:163], a[172:175], v[12:15]
    ds_read_b64_tr_b16 v[196:197], v232 offset:33792
    v_mfma_f32_16x16x32_bf16 v[16:19], v[164:167], a[160:163], v[16:19]
    v_mfma_f32_16x16x32_bf16 v[20:23], v[164:167], a[164:167], v[20:23]
    ds_read_b64_tr_b16 v[198:199], v232 offset:34304
    v_mfma_f32_16x16x32_bf16 v[24:27], v[164:167], a[168:171], v[24:27]
    v_mfma_f32_16x16x32_bf16 v[28:31], v[164:167], a[172:175], v[28:31]
    ds_read_b64_tr_b16 v[200:201], v233 offset:32768
    v_mfma_f32_16x16x32_bf16 v[32:35], v[168:171], a[160:163], v[32:35]
    ds_read_b64_tr_b16 v[202:203], v233 offset:33280
    v_mfma_f32_16x16x32_bf16 v[36:39], v[168:171], a[164:167], v[36:39]
    v_mfma_f32_16x16x32_bf16 v[40:43], v[168:171], a[168:171], v[40:43]
    ds_read_b64_tr_b16 v[204:205], v233 offset:33792
    v_mfma_f32_16x16x32_bf16 v[44:47], v[168:171], a[172:175], v[44:47]
    v_mfma_f32_16x16x32_bf16 v[48:51], v[172:175], a[160:163], v[48:51]
    ds_read_b64_tr_b16 v[206:207], v233 offset:34304
    v_mfma_f32_16x16x32_bf16 v[52:55], v[172:175], a[164:167], v[52:55]
    v_mfma_f32_16x16x32_bf16 v[56:59], v[172:175], a[168:171], v[56:59]
    ds_read_b64_tr_b16 v[208:209], v234 offset:32768
    v_mfma_f32_16x16x32_bf16 v[60:63], v[172:175], a[172:175], v[60:63]
    ds_read_b64_tr_b16 v[210:211], v234 offset:33280
    v_mfma_f32_16x16x32_bf16 v[64:67], v[176:179], a[160:163], v[64:67]
    v_mfma_f32_16x16x32_bf16 v[68:71], v[176:179], a[164:167], v[68:71]
    ds_read_b64_tr_b16 v[212:213], v234 offset:33792
    v_mfma_f32_16x16x32_bf16 v[72:75], v[176:179], a[168:171], v[72:75]
    v_mfma_f32_16x16x32_bf16 v[76:79], v[176:179], a[172:175], v[76:79]
    ds_read_b64_tr_b16 v[214:215], v234 offset:34304
    v_mfma_f32_16x16x32_bf16 v[80:83], v[180:183], a[160:163], v[80:83]
    v_mfma_f32_16x16x32_bf16 v[84:87], v[180:183], a[164:167], v[84:87]
    ds_read_b64_tr_b16 v[216:217], v235 offset:32768
    v_mfma_f32_16x16x32_bf16 v[88:91], v[180:183], a[168:171], v[88:91]
    ds_read_b64_tr_b16 v[218:219], v235 offset:33280
    v_mfma_f32_16x16x32_bf16 v[92:95], v[180:183], a[172:175], v[92:95]
    s_waitcnt lgkmcnt(4)
    v_mfma_f32_16x16x32_bf16 v[96:99], v[184:187], a[160:163], v[96:99]
    ds_read_b64_tr_b16 v[220:221], v235 offset:33792
    v_mfma_f32_16x16x32_bf16 v[100:103], v[184:187], a[164:167], v[100:103]
    v_mfma_f32_16x16x32_bf16 v[104:107], v[184:187], a[168:171], v[104:107]
    ds_read_b64_tr_b16 v[222:223], v235 offset:34304
    v_mfma_f32_16x16x32_bf16 v[108:111], v[184:187], a[172:175], v[108:111]
    v_mfma_f32_16x16x32_bf16 v[112:115], v[188:191], a[160:163], v[112:115]
    v_mfma_f32_16x16x32_bf16 v[116:119], v[188:191], a[164:167], v[116:119]
    v_mfma_f32_16x16x32_bf16 v[120:123], v[188:191], a[168:171], v[120:123]
    v_mfma_f32_16x16x32_bf16 v[124:127], v[188:191], a[172:175], v[124:127]
    v_mfma_f32_16x16x32_bf16 v[0:3], v[192:195], a[176:179], v[0:3]
    s_waitcnt vmcnt(8)
    s_waitcnt lgkmcnt(0)
    s_barrier
    v_mfma_f32_16x16x32_bf16 v[4:7], v[192:195], a[180:183], v[4:7]
    ds_read_b64_tr_b16 v[160:161], v228 offset:28672
    s_add_u32 m0, s67, 139264
    v_mfma_f32_16x16x32_bf16 v[8:11], v[192:195], a[184:187], v[8:11]
    ds_read_b64_tr_b16 v[162:163], v228 offset:29184
    s_add_u32 s66, s50, s95
    v_mfma_f32_16x16x32_bf16 v[12:15], v[192:195], a[188:191], v[12:15]
    buffer_load_dwordx4 v249, s[40:43], s66 offen lds
    v_mfma_f32_16x16x32_bf16 v[16:19], v[196:199], a[176:179], v[16:19]
    ds_read_b64_tr_b16 v[164:165], v228 offset:29696
    v_mfma_f32_16x16x32_bf16 v[20:23], v[196:199], a[180:183], v[20:23]
    v_mfma_f32_16x16x32_bf16 v[24:27], v[196:199], a[184:187], v[24:27]
    ds_read_b64_tr_b16 v[166:167], v228 offset:30208
    v_mfma_f32_16x16x32_bf16 v[28:31], v[196:199], a[188:191], v[28:31]
    ds_read_b64_tr_b16 v[168:169], v229 offset:28672
    v_mfma_f32_16x16x32_bf16 v[32:35], v[200:203], a[176:179], v[32:35]
    s_add_u32 m0, s67, 143360
    s_add_u32 s66, s66, 294912
    v_mfma_f32_16x16x32_bf16 v[36:39], v[200:203], a[180:183], v[36:39]
    ds_read_b64_tr_b16 v[170:171], v229 offset:29184
    v_mfma_f32_16x16x32_bf16 v[40:43], v[200:203], a[184:187], v[40:43]
    buffer_load_dwordx4 v249, s[40:43], s66 offen lds
    v_mfma_f32_16x16x32_bf16 v[44:47], v[200:203], a[188:191], v[44:47]
    ds_read_b64_tr_b16 v[172:173], v229 offset:29696
    v_mfma_f32_16x16x32_bf16 v[48:51], v[204:207], a[176:179], v[48:51]
    ds_read_b64_tr_b16 v[174:175], v229 offset:30208
    v_mfma_f32_16x16x32_bf16 v[52:55], v[204:207], a[180:183], v[52:55]
    v_mfma_f32_16x16x32_bf16 v[56:59], v[204:207], a[184:187], v[56:59]
    ds_read_b64_tr_b16 v[176:177], v230 offset:28672
    v_mfma_f32_16x16x32_bf16 v[60:63], v[204:207], a[188:191], v[60:63]
    v_mfma_f32_16x16x32_bf16 v[64:67], v[208:211], a[176:179], v[64:67]
    ds_read_b64_tr_b16 v[178:179], v230 offset:29184
    v_mfma_f32_16x16x32_bf16 v[68:71], v[208:211], a[180:183], v[68:71]
    ds_read_b64_tr_b16 v[180:181], v230 offset:29696
    s_add_u32 m0, s67, 147456
    v_mfma_f32_16x16x32_bf16 v[72:75], v[208:211], a[184:187], v[72:75]
    s_add_u32 s66, s66, 294912
    v_mfma_f32_16x16x32_bf16 v[76:79], v[208:211], a[188:191], v[76:79]
    ds_read_b64_tr_b16 v[182:183], v230 offset:30208
    buffer_load_dwordx4 v249, s[40:43], s66 offen lds
    v_mfma_f32_16x16x32_bf16 v[80:83], v[212:215], a[176:179], v[80:83]
    v_mfma_f32_16x16x32_bf16 v[84:87], v[212:215], a[180:183], v[84:87]
    ds_read_b64_tr_b16 v[184:185], v231 offset:28672
    v_mfma_f32_16x16x32_bf16 v[88:91], v[212:215], a[184:187], v[88:91]
    ds_read_b64_tr_b16 v[186:187], v231 offset:29184
    v_mfma_f32_16x16x32_bf16 v[92:95], v[212:215], a[188:191], v[92:95]
    v_mfma_f32_16x16x32_bf16 v[96:99], v[216:219], a[176:179], v[96:99]
    ds_read_b64_tr_b16 v[188:189], v231 offset:29696
    v_mfma_f32_16x16x32_bf16 v[100:103], v[216:219], a[180:183], v[100:103]
    v_mfma_f32_16x16x32_bf16 v[104:107], v[216:219], a[184:187], v[104:107]
    ds_read_b64_tr_b16 v[190:191], v231 offset:30208
    s_add_u32 m0, s67, 151552
    v_mfma_f32_16x16x32_bf16 v[108:111], v[216:219], a[188:191], v[108:111]
    s_add_u32 s66, s66, 294912
    v_mfma_f32_16x16x32_bf16 v[112:115], v[220:223], a[176:179], v[112:115]
    buffer_load_dwordx4 v249, s[40:43], s66 offen lds
    v_mfma_f32_16x16x32_bf16 v[116:119], v[220:223], a[180:183], v[116:119]
    v_mfma_f32_16x16x32_bf16 v[120:123], v[220:223], a[184:187], v[120:123]
    v_mfma_f32_16x16x32_bf16 v[124:127], v[220:223], a[188:191], v[124:127]
    s_waitcnt lgkmcnt(1)
    v_mfma_f32_16x16x32_bf16 v[0:3], v[160:163], a[192:195], v[0:3]
    ds_read_b64_tr_b16 v[192:193], v228 offset:36864
    v_mfma_f32_16x16x32_bf16 v[4:7], v[160:163], a[196:199], v[4:7]
    ds_read_b64_tr_b16 v[194:195], v228 offset:37376
    s_waitcnt vmcnt(4)
    v_mfma_f32_16x16x32_bf16 v[8:11], v[160:163], a[200:203], v[8:11]
    v_cmp_le_u32 vcc, 2, v255
    s_cmp_eq_u64 vcc, exec
    s_cbranch_scc0 gated_mix__ssm_conv_s4__glu_gated_bilinear__prompt_kernel_slow3
gated_mix__ssm_conv_s4__glu_gated_bilinear__prompt_kernel_back3:
    v_mfma_f32_16x16x32_bf16 v[12:15], v[160:163], a[204:207], v[12:15]
    ds_read_b64_tr_b16 v[196:197], v228 offset:37888
    s_add_u32 m0, s67, 155648
    v_mfma_f32_16x16x32_bf16 v[16:19], v[164:167], a[192:195], v[16:19]
    s_add_u32 s66, s66, 294912
    s_mov_b32 s24, s56
    v_mfma_f32_16x16x32_bf16 v[20:23], v[164:167], a[196:199], v[20:23]
    ds_read_b64_tr_b16 v[198:199], v228 offset:38400
    buffer_load_dwordx4 v249, s[40:43], s66 offen lds
    v_mfma_f32_16x16x32_bf16 v[24:27], v[164:167], a[200:203], v[24:27]
    s_mov_b32 s25, s57
    s_mov_b32 s26, 2359296
    v_mfma_f32_16x16x32_bf16 v[28:31], v[164:167], a[204:207], v[28:31]
    ds_read_b64_tr_b16 v[200:201], v229 offset:36864
    s_mov_b32 s20, s52
    v_mfma_f32_16x16x32_bf16 v[32:35], v[168:171], a[192:195], v[32:35]
    ds_read_b64_tr_b16 v[202:203], v229 offset:37376
    s_mov_b32 s21, s53
    v_mfma_f32_16x16x32_bf16 v[36:39], v[168:171], a[196:199], v[36:39]
    s_mov_b32 s22, 5308416
    v_bfe_u32 v254, v252, 2, 2
    v_mfma_f32_16x16x32_bf16 v[40:43], v[168:171], a[200:203], v[40:43]
    ds_read_b64_tr_b16 v[204:205], v229 offset:37888
    v_mul_u32_u24 v254, 4160, v254
    v_mfma_f32_16x16x32_bf16 v[44:47], v[168:171], a[204:207], v[44:47]
    v_and_b32 v255, 48, v252
    v_sub_u32 v254, v254, v255
    v_mfma_f32_16x16x32_bf16 v[48:51], v[172:175], a[192:195], v[48:51]
    ds_read_b64_tr_b16 v[206:207], v229 offset:38400
    s_add_u32 m0, s67, 159744
    v_mfma_f32_16x16x32_bf16 v[52:55], v[172:175], a[196:199], v[52:55]
    s_add_u32 s66, s66, 294912
    v_and_b32 v242, 3, v252
    v_mfma_f32_16x16x32_bf16 v[56:59], v[172:175], a[200:203], v[56:59]
    ds_read_b64_tr_b16 v[208:209], v230 offset:36864
    buffer_load_dwordx4 v249, s[40:43], s66 offen lds
    v_mfma_f32_16x16x32_bf16 v[60:63], v[172:175], a[204:207], v[60:63]
    ds_read_b64_tr_b16 v[210:211], v230 offset:37376
    v_lshl_add_u32 v254, v242, 3, v254
    v_mfma_f32_16x16x32_bf16 v[64:67], v[176:179], a[192:195], v[64:67]
    s_lshr_b32 s71, s17, 1
    s_mul_i32 s71, s71, 21216
    v_mfma_f32_16x16x32_bf16 v[68:71], v[176:179], a[196:199], v[68:71]
    ds_read_b64_tr_b16 v[212:213], v230 offset:37888
    s_and_b32 s72, s17, 1
    v_mfma_f32_16x16x32_bf16 v[72:75], v[176:179], a[200:203], v[72:75]
    s_lshl_b32 s72, s72, 8
    s_add_u32 s73, s71, s72
    v_mfma_f32_16x16x32_bf16 v[76:79], v[176:179], a[204:207], v[76:79]
    ds_read_b64_tr_b16 v[214:215], v230 offset:38400
    s_add_u32 s73, s73, 56
    v_mfma_f32_16x16x32_bf16 v[80:83], v[180:183], a[192:195], v[80:83]
    v_add_u32 v242, s73, v254
    s_lshl_b32 s73, s17, 7
    v_mfma_f32_16x16x32_bf16 v[84:87], v[180:183], a[196:199], v[84:87]
    ds_read_b64_tr_b16 v[216:217], v231 offset:36864
    s_add_u32 s66, s32, 0
    v_mfma_f32_16x16x32_bf16 v[88:91], v[180:183], a[200:203], v[88:91]
    ds_read_b64_tr_b16 v[218:219], v231 offset:37376
    s_add_u32 s74, s73, 42488
    v_mfma_f32_16x16x32_bf16 v[92:95], v[180:183], a[204:207], v[92:95]
    buffer_load_dwordx4 a[8:11], v250, s[36:39], s66 offen sc1
    v_add_u32 v244, s74, v254
    v_mfma_f32_16x16x32_bf16 v[96:99], v[184:187], a[192:195], v[96:99]
    ds_read_b64_tr_b16 v[220:221], v231 offset:37888
    v_and_b32 v254, 15, v252
    v_mfma_f32_16x16x32_bf16 v[100:103], v[184:187], a[196:199], v[100:103]
    v_lshlrev_b32 v254, 5, v254
    v_add_u32 v247, v254, v255
    v_mfma_f32_16x16x32_bf16 v[104:107], v[184:187], a[200:203], v[104:107]
    ds_read_b64_tr_b16 v[222:223], v231 offset:38400
    s_sub_u32 s74, s71, s72
    v_mfma_f32_16x16x32_bf16 v[108:111], v[184:187], a[204:207], v[108:111]
    s_add_u32 s74, s74, 16896
    v_add_u32 v243, s74, v247
    s_waitcnt lgkmcnt(4)
    v_mfma_f32_16x16x32_bf16 v[112:115], v[188:191], a[192:195], v[112:115]
    s_lshr_b32 s49, s2, 6
    v_mfma_f32_16x16x32_bf16 v[116:119], v[188:191], a[196:199], v[116:119]
    buffer_load_dwordx4 a[12:15], v250, s[36:39], s66 offen offset:1024 sc1
    s_lshl_b32 s49, s49, 9
    v_mfma_f32_16x16x32_bf16 v[120:123], v[188:191], a[200:203], v[120:123]
    s_sub_u32 s74, 60992, s73
    s_sub_u32 s73, s74, s49
    v_mfma_f32_16x16x32_bf16 v[124:127], v[188:191], a[204:207], v[124:127]
    v_add_u32 v245, s73, v247
    s_add_u32 s73, s74, s49
    v_mfma_f32_16x16x32_bf16 v[0:3], v[192:195], a[208:211], v[0:3]
    ds_read_b64_tr_b16 v[160:161], v228 offset:45056
    s_add_u32 s66, s32, 131072
    v_mfma_f32_16x16x32_bf16 v[4:7], v[192:195], a[212:215], v[4:7]
    ds_read_b64_tr_b16 v[162:163], v228 offset:45568
    s_sub_u32 s73, s73, 1536
    v_mfma_f32_16x16x32_bf16 v[8:11], v[192:195], a[216:219], v[8:11]
    buffer_load_dwordx4 a[24:27], v250, s[36:39], s66 offen sc1
    v_add_u32 v247, s73, v247
    v_mfma_f32_16x16x32_bf16 v[12:15], v[192:195], a[220:223], v[12:15]
    ds_read_b64_tr_b16 v[164:165], v228 offset:46080
    v_lshrrev_b32 v255, 1, v255
    v_mfma_f32_16x16x32_bf16 v[16:19], v[196:199], a[208:211], v[16:19]
    v_add_u32 v254, v254, v255
    s_lshl_b32 s72, s72, 3
    v_mfma_f32_16x16x32_bf16 v[20:23], v[196:199], a[212:215], v[20:23]
    ds_read_b64_tr_b16 v[166:167], v228 offset:46592
    s_add_u32 s71, s71, s72
    v_mfma_f32_16x16x32_bf16 v[24:27], v[196:199], a[216:219], v[24:27]
    v_add_u32 v248, s71, v254
    v_mfma_f32_16x16x32_bf16 v[28:31], v[196:199], a[220:223], v[28:31]
    ds_read_b64_tr_b16 v[168:169], v229 offset:45056
    buffer_load_dwordx4 a[28:31], v250, s[36:39], s66 offen offset:1024 sc1
    v_mfma_f32_16x16x32_bf16 v[32:35], v[200:203], a[208:211], v[32:35]
    ds_read_b64_tr_b16 v[170:171], v229 offset:45568
    v_mfma_f32_16x16x32_bf16 v[36:39], v[200:203], a[212:215], v[36:39]
    v_mfma_f32_16x16x32_bf16 v[40:43], v[200:203], a[216:219], v[40:43]
    ds_read_b64_tr_b16 v[172:173], v229 offset:46080
    s_add_u32 s66, s32, 524288
    v_mfma_f32_16x16x32_bf16 v[44:47], v[200:203], a[220:223], v[44:47]
    v_mfma_f32_16x16x32_bf16 v[48:51], v[204:207], a[208:211], v[48:51]
    ds_read_b64_tr_b16 v[174:175], v229 offset:46592
    buffer_load_dwordx4 a[40:43], v250, s[36:39], s66 offen sc1
    v_mfma_f32_16x16x32_bf16 v[52:55], v[204:207], a[212:215], v[52:55]
    v_mfma_f32_16x16x32_bf16 v[56:59], v[204:207], a[216:219], v[56:59]
    ds_read_b64_tr_b16 v[176:177], v230 offset:45056
    v_mfma_f32_16x16x32_bf16 v[60:63], v[204:207], a[220:223], v[60:63]
    ds_read_b64_tr_b16 v[178:179], v230 offset:45568
    v_mfma_f32_16x16x32_bf16 v[64:67], v[208:211], a[208:211], v[64:67]
    v_mfma_f32_16x16x32_bf16 v[68:71], v[208:211], a[212:215], v[68:71]
    ds_read_b64_tr_b16 v[180:181], v230 offset:46080
    buffer_load_dwordx4 a[44:47], v250, s[36:39], s66 offen offset:1024 sc1
    v_mfma_f32_16x16x32_bf16 v[72:75], v[208:211], a[216:219], v[72:75]
    v_mfma_f32_16x16x32_bf16 v[76:79], v[208:211], a[220:223], v[76:79]
    ds_read_b64_tr_b16 v[182:183], v230 offset:46592
    v_mfma_f32_16x16x32_bf16 v[80:83], v[212:215], a[208:211], v[80:83]
    s_add_u32 s66, s32, 655360
    v_mfma_f32_16x16x32_bf16 v[84:87], v[212:215], a[212:215], v[84:87]
    ds_read_b64_tr_b16 v[184:185], v231 offset:45056
    v_mfma_f32_16x16x32_bf16 v[88:91], v[212:215], a[216:219], v[88:91]
    ds_read_b64_tr_b16 v[186:187], v231 offset:45568
    buffer_load_dwordx4 a[56:59], v250, s[36:39], s66 offen sc1
    v_mfma_f32_16x16x32_bf16 v[92:95], v[212:215], a[220:223], v[92:95]
    s_waitcnt lgkmcnt(4)
    v_mfma_f32_16x16x32_bf16 v[96:99], v[216:219], a[208:211], v[96:99]
    ds_read_b64_tr_b16 v[188:189], v231 offset:46080
    v_mfma_f32_16x16x32_bf16 v[100:103], v[216:219], a[212:215], v[100:103]
    v_mfma_f32_16x16x32_bf16 v[104:107], v[216:219], a[216:219], v[104:107]
    ds_read_b64_tr_b16 v[190:191], v231 offset:46592
    v_mfma_f32_16x16x32_bf16 v[108:111], v[216:219], a[220:223], v[108:111]
    buffer_load_dwordx4 a[60:63], v250, s[36:39], s66 offen offset:1024 sc1
    v_mfma_f32_16x16x32_bf16 v[112:115], v[220:223], a[208:211], v[112:115]
    v_mfma_f32_16x16x32_bf16 v[116:119], v[220:223], a[212:215], v[116:119]
    v_mfma_f32_16x16x32_bf16 v[120:123], v[220:223], a[216:219], v[120:123]
    s_add_u32 s66, s33, 0
    v_mfma_f32_16x16x32_bf16 v[124:127], v[220:223], a[220:223], v[124:127]
    v_mfma_f32_16x16x32_bf16 v[0:3], v[160:163], a[224:227], v[0:3]
    s_waitcnt lgkmcnt(0)
    s_barrier
    v_mfma_f32_16x16x32_bf16 v[4:7], v[160:163], a[228:231], v[4:7]
    ds_read_b64_tr_b16 v[192:193], v228 offset:53248
    buffer_load_dwordx4 a[72:75], v250, s[36:39], s66 offen sc1
    v_mfma_f32_16x16x32_bf16 v[8:11], v[160:163], a[232:235], v[8:11]
    ds_read_b64_tr_b16 v[194:195], v228 offset:53760
    v_mfma_f32_16x16x32_bf16 v[12:15], v[160:163], a[236:239], v[12:15]
    v_mfma_f32_16x16x32_bf16 v[16:19], v[164:167], a[224:227], v[16:19]
    ds_read_b64_tr_b16 v[196:197], v228 offset:54272
    v_mfma_f32_16x16x32_bf16 v[20:23], v[164:167], a[228:231], v[20:23]
    buffer_load_dwordx4 a[76:79], v250, s[36:39], s66 offen offset:1024 sc1
    v_mfma_f32_16x16x32_bf16 v[24:27], v[164:167], a[232:235], v[24:27]
    ds_read_b64_tr_b16 v[198:199], v228 offset:54784
    v_mfma_f32_16x16x32_bf16 v[28:31], v[164:167], a[236:239], v[28:31]
    ds_read_b64_tr_b16 v[200:201], v229 offset:53248
    v_mfma_f32_16x16x32_bf16 v[32:35], v[168:171], a[224:227], v[32:35]
    s_add_u32 m0, s67, 90112
    s_add_u32 s66, s50, s96
    v_mfma_f32_16x16x32_bf16 v[36:39], v[168:171], a[228:231], v[36:39]
    ds_read_b64_tr_b16 v[202:203], v229 offset:53760
    v_mfma_f32_16x16x32_bf16 v[40:43], v[168:171], a[232:235], v[40:43]
    buffer_load_dwordx4 v249, s[40:43], s66 offen lds
    v_mfma_f32_16x16x32_bf16 v[44:47], v[168:171], a[236:239], v[44:47]
    ds_read_b64_tr_b16 v[204:205], v229 offset:54272
    v_mfma_f32_16x16x32_bf16 v[48:51], v[172:175], a[224:227], v[48:51]
    ds_read_b64_tr_b16 v[206:207], v229 offset:54784
    v_mfma_f32_16x16x32_bf16 v[52:55], v[172:175], a[228:231], v[52:55]
    v_mfma_f32_16x16x32_bf16 v[56:59], v[172:175], a[232:235], v[56:59]
    ds_read_b64_tr_b16 v[208:209], v230 offset:53248
    v_mfma_f32_16x16x32_bf16 v[60:63], v[172:175], a[236:239], v[60:63]
    v_mfma_f32_16x16x32_bf16 v[64:67], v[176:179], a[224:227], v[64:67]
    ds_read_b64_tr_b16 v[210:211], v230 offset:53760
    v_mfma_f32_16x16x32_bf16 v[68:71], v[176:179], a[228:231], v[68:71]
    ds_read_b64_tr_b16 v[212:213], v230 offset:54272
    s_add_u32 m0, s67, 94208
    v_mfma_f32_16x16x32_bf16 v[72:75], v[176:179], a[232:235], v[72:75]
    s_add_u32 s66, s66, 294912
    v_mfma_f32_16x16x32_bf16 v[76:79], v[176:179], a[236:239], v[76:79]
    ds_read_b64_tr_b16 v[214:215], v230 offset:54784
    buffer_load_dwordx4 v249, s[40:43], s66 offen lds
    v_mfma_f32_16x16x32_bf16 v[80:83], v[180:183], a[224:227], v[80:83]
    v_mfma_f32_16x16x32_bf16 v[84:87], v[180:183], a[228:231], v[84:87]
    ds_read_b64_tr_b16 v[216:217], v231 offset:53248
    v_mfma_f32_16x16x32_bf16 v[88:91], v[180:183], a[232:235], v[88:91]
    ds_read_b64_tr_b16 v[218:219], v231 offset:53760
    v_mfma_f32_16x16x32_bf16 v[92:95], v[180:183], a[236:239], v[92:95]
    v_mfma_f32_16x16x32_bf16 v[96:99], v[184:187], a[224:227], v[96:99]
    ds_read_b64_tr_b16 v[220:221], v231 offset:54272
    v_mfma_f32_16x16x32_bf16 v[100:103], v[184:187], a[228:231], v[100:103]
    v_mfma_f32_16x16x32_bf16 v[104:107], v[184:187], a[232:235], v[104:107]
    ds_read_b64_tr_b16 v[222:223], v231 offset:54784
    s_add_u32 m0, s67, 98304
    v_mfma_f32_16x16x32_bf16 v[108:111], v[184:187], a[236:239], v[108:111]
    s_add_u32 s66, s66, 294912
    v_mfma_f32_16x16x32_bf16 v[112:115], v[188:191], a[224:227], v[112:115]
    buffer_load_dwordx4 v249, s[40:43], s66 offen lds
    v_mfma_f32_16x16x32_bf16 v[116:119], v[188:191], a[228:231], v[116:119]
    v_mfma_f32_16x16x32_bf16 v[120:123], v[188:191], a[232:235], v[120:123]
    v_mfma_f32_16x16x32_bf16 v[124:127], v[188:191], a[236:239], v[124:127]
    s_waitcnt lgkmcnt(1)
    v_mfma_f32_16x16x32_bf16 v[0:3], v[192:195], a[240:243], v[0:3]
    ds_read_b64_tr_b16 v[160:161], v232 offset:0
    v_mfma_f32_16x16x32_bf16 v[4:7], v[192:195], a[244:247], v[4:7]
    ds_read_b64_tr_b16 v[162:163], v232 offset:512
    v_mfma_f32_16x16x32_bf16 v[8:11], v[192:195], a[248:251], v[8:11]
    v_mfma_f32_16x16x32_bf16 v[12:15], v[192:195], a[252:255], v[12:15]
    ds_read_b64_tr_b16 v[164:165], v232 offset:1024
    s_add_u32 m0, s67, 102400
    v_mfma_f32_16x16x32_bf16 v[16:19], v[196:199], a[240:243], v[16:19]
    s_add_u32 s66, s66, 294912
    v_mfma_f32_16x16x32_bf16 v[20:23], v[196:199], a[244:247], v[20:23]
    ds_read_b64_tr_b16 v[166:167], v232 offset:1536
    buffer_load_dwordx4 v249, s[40:43], s66 offen lds
    v_mfma_f32_16x16x32_bf16 v[24:27], v[196:199], a[248:251], v[24:27]
    v_mfma_f32_16x16x32_bf16 v[28:31], v[196:199], a[252:255], v[28:31]
    ds_read_b64_tr_b16 v[168:169], v233 offset:0
    v_mfma_f32_16x16x32_bf16 v[32:35], v[200:203], a[240:243], v[32:35]
    ds_read_b64_tr_b16 v[170:171], v233 offset:512
    v_mfma_f32_16x16x32_bf16 v[36:39], v[200:203], a[244:247], v[36:39]
    v_mfma_f32_16x16x32_bf16 v[40:43], v[200:203], a[248:251], v[40:43]
    ds_read_b64_tr_b16 v[172:173], v233 offset:1024
    v_mfma_f32_16x16x32_bf16 v[44:47], v[200:203], a[252:255], v[44:47]
    v_mfma_f32_16x16x32_bf16 v[48:51], v[204:207], a[240:243], v[48:51]
    ds_read_b64_tr_b16 v[174:175], v233 offset:1536
    s_add_u32 m0, s67, 106496
    v_mfma_f32_16x16x32_bf16 v[52:55], v[204:207], a[244:247], v[52:55]
    s_add_u32 s66, s66, 294912
    v_mfma_f32_16x16x32_bf16 v[56:59], v[204:207], a[248:251], v[56:59]
    ds_read_b64_tr_b16 v[176:177], v234 offset:0
    buffer_load_dwordx4 v249, s[40:43], s66 offen lds
    v_mfma_f32_16x16x32_bf16 v[60:63], v[204:207], a[252:255], v[60:63]
    ds_read_b64_tr_b16 v[178:179], v234 offset:512
    v_mfma_f32_16x16x32_bf16 v[64:67], v[208:211], a[240:243], v[64:67]
    v_mfma_f32_16x16x32_bf16 v[68:71], v[208:211], a[244:247], v[68:71]
    ds_read_b64_tr_b16 v[180:181], v234 offset:1024
    v_mfma_f32_16x16x32_bf16 v[72:75], v[208:211], a[248:251], v[72:75]
    v_mfma_f32_16x16x32_bf16 v[76:79], v[208:211], a[252:255], v[76:79]
    ds_read_b64_tr_b16 v[182:183], v234 offset:1536
    v_mfma_f32_16x16x32_bf16 v[80:83], v[212:215], a[240:243], v[80:83]
    v_mfma_f32_16x16x32_bf16 v[84:87], v[212:215], a[244:247], v[84:87]
    ds_read_b64_tr_b16 v[184:185], v235 offset:0
    s_add_u32 m0, s67, 110592
    v_mfma_f32_16x16x32_bf16 v[88:91], v[212:215], a[248:251], v[88:91]
    ds_read_b64_tr_b16 v[186:187], v235 offset:512
    s_add_u32 s66, s66, 294912
    v_mfma_f32_16x16x32_bf16 v[92:95], v[212:215], a[252:255], v[92:95]
    buffer_load_dwordx4 v249, s[40:43], s66 offen lds
    v_mfma_f32_16x16x32_bf16 v[96:99], v[216:219], a[240:243], v[96:99]
    ds_read_b64_tr_b16 v[188:189], v235 offset:1024
    v_mfma_f32_16x16x32_bf16 v[100:103], v[216:219], a[244:247], v[100:103]
    v_mfma_f32_16x16x32_bf16 v[104:107], v[216:219], a[248:251], v[104:107]
    ds_read_b64_tr_b16 v[190:191], v235 offset:1536
    v_mfma_f32_16x16x32_bf16 v[108:111], v[216:219], a[252:255], v[108:111]
    s_waitcnt lgkmcnt(4)
    v_mfma_f32_16x16x32_bf16 v[112:115], v[220:223], a[240:243], v[112:115]
    v_mfma_f32_16x16x32_bf16 v[116:119], v[220:223], a[244:247], v[116:119]
    v_mfma_f32_16x16x32_bf16 v[120:123], v[220:223], a[248:251], v[120:123]
    v_mfma_f32_16x16x32_bf16 v[124:127], v[220:223], a[252:255], v[124:127]
    v_mfma_f32_16x16x32_bf16 v[0:3], v[160:163], v[128:131], v[0:3]
    ds_read_b64_tr_b16 v[192:193], v232 offset:8192
    s_add_u32 s66, s33, 131072
    v_mfma_f32_16x16x32_bf16 v[4:7], v[160:163], v[132:135], v[4:7]
    ds_read_b64_tr_b16 v[194:195], v232 offset:8704
    buffer_load_dwordx4 a[88:91], v250, s[36:39], s66 offen sc1
    v_mfma_f32_16x16x32_bf16 v[8:11], v[160:163], v[136:139], v[8:11]
    s_sub_u32 s73, 3584, s49
    s_bitcmp1_b32 s17, 0
    s_cselect_b32 s73, s73, s49
    v_mfma_f32_16x16x32_bf16 v[12:15], v[160:163], v[140:143], v[12:15]
    ds_read_b64_tr_b16 v[196:197], v232 offset:9216
    s_lshr_b32 s71, s17, 1
    v_mfma_f32_16x16x32_bf16 v[16:19], v[164:167], v[128:131], v[16:19]
    s_lshl_b32 s72, s71, 2
    s_add_u32 s73, s73, s72
    v_mfma_f32_16x16x32_bf16 v[20:23], v[164:167], v[132:135], v[20:23]
    ds_read_b64_tr_b16 v[198:199], v232 offset:9728
    buffer_load_dwordx4 a[92:95], v250, s[36:39], s66 offen offset:1024 sc1
    v_mfma_f32_16x16x32_bf16 v[24:27], v[164:167], v[136:139], v[24:27]
    s_mul_i32 s72, s71, 21216
    s_sub_u32 s73, s73, s72
    v_mfma_f32_16x16x32_bf16 v[28:31], v[164:167], v[140:143], v[28:31]
    ds_read_b64_tr_b16 v[200:201], v233 offset:8192
    s_and_b32 s72, s17, 1
    v_mfma_f32_16x16x32_bf16 v[32:35], v[168:171], v[128:131], v[32:35]
    ds_read_b64_tr_b16 v[202:203], v233 offset:8704
    s_add_u32 s66, s33, 524288
    v_mfma_f32_16x16x32_bf16 v[36:39], v[168:171], v[132:135], v[36:39]
    s_lshl_b32 s72, s72, 11
    s_sub_u32 s73, s73, s72
    v_mfma_f32_16x16x32_bf16 v[40:43], v[168:171], v[136:139], v[40:43]
    ds_read_b64_tr_b16 v[204:205], v233 offset:9216
    buffer_load_dwordx4 a[104:107], v250, s[36:39], s66 offen sc1
    v_mfma_f32_16x16x32_bf16 v[44:47], v[168:171], v[140:143], v[44:47]
    v_add_u32 v246, s73, v248
    s_mul_i32 s72, s17, 6144
    v_mfma_f32_16x16x32_bf16 v[48:51], v[172:175], v[128:131], v[48:51]
    ds_read_b64_tr_b16 v[206:207], v233 offset:9728
    s_add_u32 s72, s72, 90112
    v_mfma_f32_16x16x32_bf16 v[52:55], v[172:175], v[132:135], v[52:55]
    s_sub_u32 s72, s72, s3
    v_add_u32 v249, s72, v250
    v_mfma_f32_16x16x32_bf16 v[56:59], v[172:175], v[136:139], v[56:59]
    ds_read_b64_tr_b16 v[208:209], v234 offset:8192
    s_xor_b32 s72, s17, 1
    v_mfma_f32_16x16x32_bf16 v[60:63], v[172:175], v[140:143], v[60:63]
    ds_read_b64_tr_b16 v[210:211], v234 offset:8704
    buffer_load_dwordx4 a[108:111], v250, s[36:39], s66 offen offset:1024 sc1
    v_mfma_f32_16x16x32_bf16 v[64:67], v[176:179], v[128:131], v[64:67]
    s_mul_i32 s72, s72, 6144
    s_add_u32 s72, s72, 90112
    v_mfma_f32_16x16x32_bf16 v[68:71], v[176:179], v[132:135], v[68:71]
    ds_read_b64_tr_b16 v[212:213], v234 offset:9216
    s_sub_u32 s49, s72, s3
    v_mfma_f32_16x16x32_bf16 v[72:75], v[176:179], v[136:139], v[72:75]
    s_add_u32 s66, s33, 655360
    s_and_b32 s72, s17, 1
    v_mfma_f32_16x16x32_bf16 v[76:79], v[176:179], v[140:143], v[76:79]
    ds_read_b64_tr_b16 v[214:215], v234 offset:9728
    s_lshl_b32 s72, s72, 10
    v_mfma_f32_16x16x32_bf16 v[80:83], v[180:183], v[128:131], v[80:83]
    buffer_load_dwordx4 a[120:123], v250, s[36:39], s66 offen sc1
    s_lshl_b32 s71, s71, 3
    v_mfma_f32_16x16x32_bf16 v[84:87], v[180:183], v[132:135], v[84:87]
    ds_read_b64_tr_b16 v[216:217], v235 offset:8192
    s_add_u32 s72, s72, s71
    v_mfma_f32_16x16x32_bf16 v[88:91], v[180:183], v[136:139], v[88:91]
    ds_read_b64_tr_b16 v[218:219], v235 offset:8704
    s_add_u32 s72, s72, 94208
    v_mfma_f32_16x16x32_bf16 v[92:95], v[180:183], v[140:143], v[92:95]
    s_sub_u32 s72, s72, s3
    v_add_u32 v254, s72, v250
    s_waitcnt lgkmcnt(4)
    v_mfma_f32_16x16x32_bf16 v[96:99], v[184:187], v[128:131], v[96:99]
    ds_read_b64_tr_b16 v[220:221], v235 offset:9216
    v_mfma_f32_16x16x32_bf16 v[100:103], v[184:187], v[132:135], v[100:103]
    buffer_load_dwordx4 a[124:127], v250, s[36:39], s66 offen offset:1024 sc1
    v_and_b32 v255, 15, v252
    v_mfma_f32_16x16x32_bf16 v[104:107], v[184:187], v[136:139], v[104:107]
    ds_read_b64_tr_b16 v[222:223], v235 offset:9728
    v_lshlrev_b32 v255, 5, v255
    v_mfma_f32_16x16x32_bf16 v[108:111], v[184:187], v[140:143], v[108:111]
    v_mfma_f32_16x16x32_bf16 v[112:115], v[188:191], v[128:131], v[112:115]
    s_add_u32 s66, s54, 0
    v_mfma_f32_16x16x32_bf16 v[116:119], v[188:191], v[132:135], v[116:119]
    v_mfma_f32_16x16x32_bf16 v[120:123], v[188:191], v[136:139], v[120:123]
    buffer_load_dwordx4 a[136:139], v250, s[36:39], s66 offen sc1
    v_mfma_f32_16x16x32_bf16 v[124:127], v[188:191], v[140:143], v[124:127]
    v_mfma_f32_16x16x32_bf16 v[0:3], v[192:195], v[144:147], v[0:3]
    s_waitcnt lgkmcnt(0)
    s_barrier
    v_mfma_f32_16x16x32_bf16 v[16:19], v[196:199], v[144:147], v[16:19]
    ds_read_b64_tr_b16 v[160:161], v238 offset:4096
    v_mfma_f32_16x16x32_bf16 v[32:35], v[200:203], v[144:147], v[32:35]
    ds_read_b64_tr_b16 v[162:163], v238 offset:4352
    v_mfma_f32_16x16x32_bf16 v[48:51], v[204:207], v[144:147], v[48:51]
    v_mfma_f32_16x16x32_bf16 v[4:7], v[192:195], v[148:151], v[4:7]
    ds_read_b64_tr_b16 v[164:165], v238 offset:6144
    v_mfma_f32_16x16x32_bf16 v[20:23], v[196:199], v[148:151], v[20:23]
    v_mfma_f32_16x16x32_bf16 v[36:39], v[200:203], v[148:151], v[36:39]
    ds_read_b64_tr_b16 v[166:167], v238 offset:6400
    v_mfma_f32_16x16x32_bf16 v[52:55], v[204:207], v[148:151], v[52:55]
    ds_read_b64_tr_b16 v[168:169], v239 offset:4096
    v_mfma_f32_16x16x32_bf16 v[8:11], v[192:195], v[152:155], v[8:11]
    v_mul_f32 v0, v0, v16
    v_mul_f32 v1, v1, v17
    v_mfma_f32_16x16x32_bf16 v[24:27], v[196:199], v[152:155], v[24:27]
    ds_read_b64_tr_b16 v[170:171], v239 offset:4352
    v_mul_f32 v2, v2, v18
    v_mfma_f32_16x16x32_bf16 v[40:43], v[200:203], v[152:155], v[40:43]
    v_mul_f32 v3, v3, v19
    v_mul_f32 v32, v32, v48
    v_mfma_f32_16x16x32_bf16 v[56:59], v[204:207], v[152:155], v[56:59]
    ds_read_b64_tr_b16 v[172:173], v239 offset:6144
    v_mul_f32 v33, v33, v49
    v_mfma_f32_16x16x32_bf16 v[12:15], v[192:195], v[156:159], v[12:15]
    ds_read_b64_tr_b16 v[174:175], v239 offset:6400
    v_mul_f32 v34, v34, v50
    v_mul_f32 v35, v35, v51
    v_mfma_f32_16x16x32_bf16 v[28:31], v[196:199], v[156:159], v[28:31]
    v_cvt_pk_bf16_f32 v16, v0, v1
    v_cvt_pk_bf16_f32 v17, v2, v3
    v_cvt_pk_bf16_f32 v18, v32, v33
    v_mfma_f32_16x16x32_bf16 v[44:47], v[200:203], v[156:159], v[44:47]
    ds_read_b64_tr_b16 v[176:177], v238 offset:8192
    v_cvt_pk_bf16_f32 v19, v34, v35
    v_mfma_f32_16x16x32_bf16 v[60:63], v[204:207], v[156:159], v[60:63]
    buffer_store_dwordx4 v[16:19], v250, s[36:39], s62 offen offset:0 sc1
    v_mul_f32 v4, v4, v20
    v_mfma_f32_16x16x32_bf16 v[64:67], v[208:211], v[144:147], v[64:67]
    ds_read_b64_tr_b16 v[178:179], v238 offset:8448
    v_mul_f32 v5, v5, v21
    v_mul_f32 v6, v6, v22
    v_mfma_f32_16x16x32_bf16 v[80:83], v[212:215], v[144:147], v[80:83]
    ds_read_b64_tr_b16 v[180:181], v238 offset:10240
    v_mul_f32 v7, v7, v23
    v_mul_f32 v36, v36, v52
    v_mfma_f32_16x16x32_bf16 v[96:99], v[216:219], v[144:147], v[96:99]
    v_mul_f32 v37, v37, v53
    v_mul_f32 v38, v38, v54
    v_mul_f32 v39, v39, v55
    v_mfma_f32_16x16x32_bf16 v[112:115], v[220:223], v[144:147], v[112:115]
    ds_read_b64_tr_b16 v[182:183], v238 offset:10496
    v_cvt_pk_bf16_f32 v20, v4, v5
    v_cvt_pk_bf16_f32 v21, v6, v7
    v_mfma_f32_16x16x32_bf16 v[68:71], v[208:211], v[148:151], v[68:71]
    v_cvt_pk_bf16_f32 v22, v36, v37
    v_cvt_pk_bf16_f32 v23, v38, v39
    buffer_store_dwordx4 v[20:23], v250, s[36:39], s62 offen offset:1024 sc1
    v_mfma_f32_16x16x32_bf16 v[84:87], v[212:215], v[148:151], v[84:87]
    ds_read_b64_tr_b16 v[184:185], v239 offset:8192
    v_mul_f32 v8, v8, v24
    v_mul_f32 v9, v9, v25
    v_mfma_f32_16x16x32_bf16 v[100:103], v[216:219], v[148:151], v[100:103]
    ds_read_b64_tr_b16 v[186:187], v239 offset:8448
    v_mul_f32 v10, v10, v26
    v_mul_f32 v11, v11, v27
    v_mfma_f32_16x16x32_bf16 v[116:119], v[220:223], v[148:151], v[116:119]
    v_mul_f32 v40, v40, v56
    v_mul_f32 v41, v41, v57
    v_mul_f32 v42, v42, v58
    v_mfma_f32_16x16x32_bf16 v[72:75], v[208:211], v[152:155], v[72:75]
    ds_read_b64_tr_b16 v[188:189], v239 offset:10240
    v_mul_f32 v43, v43, v59
    v_cvt_pk_bf16_f32 v24, v8, v9
    v_mfma_f32_16x16x32_bf16 v[88:91], v[212:215], v[152:155], v[88:91]
    v_cvt_pk_bf16_f32 v25, v10, v11
    v_cvt_pk_bf16_f32 v26, v40, v41
    v_cvt_pk_bf16_f32 v27, v42, v43
    v_mfma_f32_16x16x32_bf16 v[104:107], v[216:219], v[152:155], v[104:107]
    ds_read_b64_tr_b16 v[190:191], v239 offset:10496
    buffer_store_dwordx4 v[24:27], v251, s[36:39], s62 offen offset:0 sc1
    v_mul_f32 v12, v12, v28
    v_mfma_f32_16x16x32_bf16 v[120:123], v[220:223], v[152:155], v[120:123]
    v_mul_f32 v13, v13, v29
    v_mul_f32 v14, v14, v30
    v_mul_f32 v15, v15, v31
    v_mfma_f32_16x16x32_bf16 v[76:79], v[208:211], v[156:159], v[76:79]
    v_mul_f32 v44, v44, v60
    v_mul_f32 v45, v45, v61
    v_mul_f32 v46, v46, v62
    v_mfma_f32_16x16x32_bf16 v[92:95], v[212:215], v[156:159], v[92:95]
    v_mul_f32 v47, v47, v63
    v_cvt_pk_bf16_f32 v28, v12, v13
    v_cvt_pk_bf16_f32 v29, v14, v15
    v_mfma_f32_16x16x32_bf16 v[108:111], v[216:219], v[156:159], v[108:111]
    v_cvt_pk_bf16_f32 v30, v44, v45
    v_cvt_pk_bf16_f32 v31, v46, v47
    buffer_store_dwordx4 v[28:31], v251, s[36:39], s62 offen offset:1024 sc1
    v_mfma_f32_16x16x32_bf16 v[124:127], v[220:223], v[156:159], v[124:127]
    v_mul_f32 v64, v64, v80
    v_mul_f32 v65, v65, v81
    v_mul_f32 v66, v66, v82
    s_waitcnt lgkmcnt(1)
    v_mfma_f32_16x16x32_bf16 v[0:3], v[160:163], a[0:3], 0
    ds_read_b64_tr_b16 v[192:193], v238 offset:12288
    ds_read_b64_tr_b16 v[194:195], v238 offset:12544
    v_mfma_f32_16x16x32_bf16 v[16:19], v[164:167], a[0:3], 0
    ds_read_b64_tr_b16 v[196:197], v238 offset:14336
    v_mul_f32 v67, v67, v83
    v_mul_f32 v96, v96, v112
    v_mfma_f32_16x16x32_bf16 v[32:35], v[168:171], a[0:3], 0
    ds_read_b64_tr_b16 v[198:199], v238 offset:14592
    v_mul_f32 v97, v97, v113
    v_mul_f32 v98, v98, v114
    v_mfma_f32_16x16x32_bf16 v[48:51], v[172:175], a[0:3], 0
    ds_read_b64_tr_b16 v[200:201], v239 offset:12288
    ds_read_b64_tr_b16 v[202:203], v239 offset:12544
    v_mul_f32 v99, v99, v115
    v_mfma_f32_16x16x32_bf16 v[4:7], v[160:163], a[4:7], 0
    ds_read_b64_tr_b16 v[204:205], v239 offset:14336
    v_cvt_pk_bf16_f32 v80, v64, v65
    v_cvt_pk_bf16_f32 v81, v66, v67
    v_mfma_f32_16x16x32_bf16 v[20:23], v[164:167], a[4:7], 0
    ds_read_b64_tr_b16 v[206:207], v239 offset:14592
    v_cvt_pk_bf16_f32 v82, v96, v97
    v_cvt_pk_bf16_f32 v83, v98, v99
    v_mfma_f32_16x16x32_bf16 v[36:39], v[168:171], a[4:7], 0
    ds_read_b64_tr_b16 v[208:209], v238 offset:16384
    ds_read_b64_tr_b16 v[210:211], v238 offset:16640
    buffer_store_dwordx4 v[80:83], v250, s[36:39], s63 offen offset:0 sc1
    v_mfma_f32_16x16x32_bf16 v[52:55], v[172:175], a[4:7], 0
    ds_read_b64_tr_b16 v[212:213], v238 offset:18432
    v_mul_f32 v68, v68, v84
    v_mul_f32 v69, v69, v85
    v_mfma_f32_16x16x32_bf16 v[0:3], v[176:179], a[16:19], v[0:3]
    ds_read_b64_tr_b16 v[214:215], v238 offset:18688
    v_mul_f32 v70, v70, v86
    v_mul_f32 v71, v71, v87
    v_mfma_f32_16x16x32_bf16 v[4:7], v[176:179], a[20:23], v[4:7]
    ds_read_b64_tr_b16 v[216:217], v239 offset:16384
    ds_read_b64_tr_b16 v[218:219], v239 offset:16640
    v_mul_f32 v100, v100, v116
    v_mfma_f32_16x16x32_bf16 v[16:19], v[180:183], a[16:19], v[16:19]
    ds_read_b64_tr_b16 v[220:221], v239 offset:18432
    v_mul_f32 v101, v101, v117
    v_mul_f32 v102, v102, v118
    v_mfma_f32_16x16x32_bf16 v[20:23], v[180:183], a[20:23], v[20:23]
    ds_read_b64_tr_b16 v[222:223], v239 offset:18688
    v_mul_f32 v103, v103, v119
    v_cvt_pk_bf16_f32 v84, v68, v69
    v_mfma_f32_16x16x32_bf16 v[32:35], v[184:187], a[16:19], v[32:35]
    v_cvt_pk_bf16_f32 v85, v70, v71
    v_cvt_pk_bf16_f32 v86, v100, v101
    v_mfma_f32_16x16x32_bf16 v[36:39], v[184:187], a[20:23], v[36:39]
    v_cvt_pk_bf16_f32 v87, v102, v103
    buffer_store_dwordx4 v[84:87], v250, s[36:39], s63 offen offset:1024 sc1
    s_waitcnt lgkmcnt(6)
    v_mfma_f32_16x16x32_bf16 v[48:51], v[188:191], a[16:19], v[48:51]
    v_mul_f32 v72, v72, v88
    v_mfma_f32_16x16x32_bf16 v[52:55], v[188:191], a[20:23], v[52:55]
    v_mul_f32 v73, v73, v89
    v_mul_f32 v74, v74, v90
    v_mfma_f32_16x16x32_bf16 v[0:3], v[192:195], a[32:35], v[0:3]
    ds_read_b64_tr_b16 v[160:161], v238 offset:20480
    ds_read_b64_tr_b16 v[162:163], v238 offset:20736
    v_mfma_f32_16x16x32_bf16 v[4:7], v[192:195], a[36:39], v[4:7]
    ds_read_b64_tr_b16 v[164:165], v238 offset:22528
    v_mul_f32 v75, v75, v91
    v_mfma_f32_16x16x32_bf16 v[16:19], v[196:199], a[32:35], v[16:19]
    ds_read_b64_tr_b16 v[166:167], v238 offset:22784
    v_mul_f32 v104, v104, v120
    v_mfma_f32_16x16x32_bf16 v[20:23], v[196:199], a[36:39], v[20:23]
    ds_read_b64_tr_b16 v[168:169], v239 offset:20480
    ds_read_b64_tr_b16 v[170:171], v239 offset:20736
    v_mfma_f32_16x16x32_bf16 v[32:35], v[200:203], a[32:35], v[32:35]
    ds_read_b64_tr_b16 v[172:173], v239 offset:22528
    v_mul_f32 v105, v105, v121
    v_mfma_f32_16x16x32_bf16 v[36:39], v[200:203], a[36:39], v[36:39]
    ds_read_b64_tr_b16 v[174:175], v239 offset:22784
    v_mul_f32 v106, v106, v122
    v_mfma_f32_16x16x32_bf16 v[48:51], v[204:207], a[32:35], v[48:51]
    ds_read_b64_tr_b16 v[176:177], v238 offset:24576
    ds_read_b64_tr_b16 v[178:179], v238 offset:24832
    v_mfma_f32_16x16x32_bf16 v[52:55], v[204:207], a[36:39], v[52:55]
    ds_read_b64_tr_b16 v[180:181], v238 offset:26624
    v_mul_f32 v107, v107, v123
    v_mfma_f32_16x16x32_bf16 v[0:3], v[208:211], a[48:51], v[0:3]
    ds_read_b64_tr_b16 v[182:183], v238 offset:26880
    v_cvt_pk_bf16_f32 v88, v72, v73
    v_mfma_f32_16x16x32_bf16 v[4:7], v[208:211], a[52:55], v[4:7]
    ds_read_b64_tr_b16 v[184:185], v239 offset:24576
    ds_read_b64_tr_b16 v[186:187], v239 offset:24832
    s_waitcnt lgkmcnt(10)
    v_mfma_f32_16x16x32_bf16 v[16:19], v[212:215], a[48:51], v[16:19]
    ds_read_b64_tr_b16 v[188:189], v239 offset:26624
    v_mfma_f32_16x16x32_bf16 v[20:23], v[212:215], a[52:55], v[20:23]
    ds_read_b64_tr_b16 v[190:191], v239 offset:26880
    v_cvt_pk_bf16_f32 v89, v74, v75
    v_mfma_f32_16x16x32_bf16 v[32:35], v[216:219], a[48:51], v[32:35]
    v_cvt_pk_bf16_f32 v90, v104, v105
    v_cvt_pk_bf16_f32 v91, v106, v107
    v_mfma_f32_16x16x32_bf16 v[36:39], v[216:219], a[52:55], v[36:39]
    buffer_store_dwordx4 v[88:91], v251, s[36:39], s63 offen offset:0 sc1
    v_mul_f32 v76, v76, v92
    v_mfma_f32_16x16x32_bf16 v[48:51], v[220:223], a[48:51], v[48:51]
    v_mul_f32 v77, v77, v93
    v_mul_f32 v78, v78, v94
    v_mfma_f32_16x16x32_bf16 v[52:55], v[220:223], a[52:55], v[52:55]
    v_mul_f32 v79, v79, v95
    v_mul_f32 v108, v108, v124
    v_mfma_f32_16x16x32_bf16 v[0:3], v[160:163], a[64:67], v[0:3]
    s_waitcnt vmcnt(30)
    s_waitcnt lgkmcnt(0)
    s_barrier
    v_mfma_f32_16x16x32_bf16 v[4:7], v[160:163], a[68:71], v[4:7]
    ds_read_b64_tr_b16 v[192:193], v240 offset:16384
    ds_read_b64_tr_b16 v[194:195], v240 offset:16640
    v_mfma_f32_16x16x32_bf16 v[16:19], v[164:167], a[64:67], v[16:19]
    ds_read_b64_tr_b16 v[196:197], v240 offset:18432
    v_mul_f32 v109, v109, v125
    v_mfma_f32_16x16x32_bf16 v[20:23], v[164:167], a[68:71], v[20:23]
    ds_read_b64_tr_b16 v[198:199], v240 offset:18688
    ds_read_b64_tr_b16 v[200:201], v241 offset:16384
    v_mfma_f32_16x16x32_bf16 v[32:35], v[168:171], a[64:67], v[32:35]
    ds_read_b64_tr_b16 v[202:203], v241 offset:16640
    v_mul_f32 v110, v110, v126
    v_mfma_f32_16x16x32_bf16 v[36:39], v[168:171], a[68:71], v[36:39]
    ds_read_b64_tr_b16 v[204:205], v241 offset:18432
    ds_read_b64_tr_b16 v[206:207], v241 offset:18688
    v_mfma_f32_16x16x32_bf16 v[48:51], v[172:175], a[64:67], v[48:51]
    ds_read_b64_tr_b16 v[208:209], v240 offset:20480
    v_mul_f32 v111, v111, v127
    v_mfma_f32_16x16x32_bf16 v[52:55], v[172:175], a[68:71], v[52:55]
    ds_read_b64_tr_b16 v[210:211], v240 offset:20736
    ds_read_b64_tr_b16 v[212:213], v240 offset:22528
    v_mfma_f32_16x16x32_bf16 v[0:3], v[176:179], a[80:83], v[0:3]
    ds_read_b64_tr_b16 v[214:215], v240 offset:22784
    v_cvt_pk_bf16_f32 v92, v76, v77
    v_mfma_f32_16x16x32_bf16 v[4:7], v[176:179], a[84:87], v[4:7]
    ds_read_b64_tr_b16 v[216:217], v241 offset:20480
    ds_read_b64_tr_b16 v[218:219], v241 offset:20736
    v_mfma_f32_16x16x32_bf16 v[16:19], v[180:183], a[80:83], v[16:19]
    ds_read_b64_tr_b16 v[220:221], v241 offset:22528
    v_cvt_pk_bf16_f32 v93, v78, v79
    v_mfma_f32_16x16x32_bf16 v[20:23], v[180:183], a[84:87], v[20:23]
    ds_read_b64_tr_b16 v[222:223], v241 offset:22784
    v_cvt_pk_bf16_f32 v94, v108, v109
    v_mfma_f32_16x16x32_bf16 v[32:35], v[184:187], a[80:83], v[32:35]
    v_cvt_pk_bf16_f32 v95, v110, v111
    buffer_store_dwordx4 v[92:95], v251, s[36:39], s63 offen offset:1024 sc1
    v_mfma_f32_16x16x32_bf16 v[36:39], v[184:187], a[84:87], v[36:39]
    s_and_b32 s74, s16, 1
    s_xor_b32 s74, s74, 1
    v_mfma_f32_16x16x32_bf16 v[48:51], v[188:191], a[80:83], v[48:51]
    s_lshl_b32 s74, s74, 2
    v_add_u32 v251, s49, v250
    v_mfma_f32_16x16x32_bf16 v[52:55], v[188:191], a[84:87], v[52:55]
    v_bfe_u32 v104, v252, 4, 1
    v_lshl_add_u32 v255, v104, 9, v255
    s_waitcnt lgkmcnt(4)
    v_mfma_f32_16x16x32_bf16 v[0:3], v[192:195], a[96:99], v[0:3]
    ds_read_b64_tr_b16 v[160:161], v240 offset:24576
    ds_read_b64_tr_b16 v[162:163], v240 offset:24832
    v_mfma_f32_16x16x32_bf16 v[4:7], v[192:195], a[100:103], v[4:7]
    ds_read_b64_tr_b16 v[164:165], v240 offset:26624
    buffer_load_dwordx4 a[140:143], v250, s[36:39], s66 offen offset:1024 sc1
    v_mfma_f32_16x16x32_bf16 v[16:19], v[196:199], a[96:99], v[16:19]
    ds_read_b64_tr_b16 v[166:167], v240 offset:26880
    v_lshlrev_b32 v105, 1, v104
    v_mfma_f32_16x16x32_bf16 v[20:23], v[196:199], a[100:103], v[20:23]
    ds_read_b64_tr_b16 v[168:169], v241 offset:24576
    ds_read_b64_tr_b16 v[170:171], v241 offset:24832
    v_mfma_f32_16x16x32_bf16 v[32:35], v[200:203], a[96:99], v[32:35]
    ds_read_b64_tr_b16 v[172:173], v241 offset:26624
    s_add_u32 s66, s54, 131072
    v_mfma_f32_16x16x32_bf16 v[36:39], v[200:203], a[100:103], v[36:39]
    ds_read_b64_tr_b16 v[174:175], v241 offset:26880
    buffer_load_dwordx4 a[152:155], v250, s[36:39], s66 offen sc1
    v_mfma_f32_16x16x32_bf16 v[48:51], v[204:207], a[96:99], v[48:51]
    ds_read_b64_tr_b16 v[176:177], v240 offset:28672
    ds_read_b64_tr_b16 v[178:179], v240 offset:28928
    v_mfma_f32_16x16x32_bf16 v[52:55], v[204:207], a[100:103], v[52:55]
    ds_read_b64_tr_b16 v[180:181], v240 offset:30720
    v_and_b32 v106, 7, v252
    v_mfma_f32_16x16x32_bf16 v[0:3], v[208:211], a[112:115], v[0:3]
    ds_read_b64_tr_b16 v[182:183], v240 offset:30976
    v_xor_b32 v105, v105, v106
    v_mfma_f32_16x16x32_bf16 v[4:7], v[208:211], a[116:119], v[4:7]
    ds_read_b64_tr_b16 v[184:185], v241 offset:28672
    ds_read_b64_tr_b16 v[186:187], v241 offset:28928
    v_mfma_f32_16x16x32_bf16 v[16:19], v[212:215], a[112:115], v[16:19]
    ds_read_b64_tr_b16 v[188:189], v241 offset:30720
    buffer_load_dwordx4 a[156:159], v250, s[36:39], s66 offen offset:1024 sc1
    v_mfma_f32_16x16x32_bf16 v[20:23], v[212:215], a[116:119], v[20:23]
    ds_read_b64_tr_b16 v[190:191], v241 offset:30976
    v_xor_b32 v105, s74, v105
    s_waitcnt lgkmcnt(9)
    v_mfma_f32_16x16x32_bf16 v[32:35], v[216:219], a[112:115], v[32:35]
    v_lshrrev_b32 v107, 5, v252
    v_mfma_f32_16x16x32_bf16 v[36:39], v[216:219], a[116:119], v[36:39]
    s_add_u32 s66, s54, 524288
    v_lshl_add_u32 v255, v107, 4, v255
    v_mfma_f32_16x16x32_bf16 v[48:51], v[220:223], a[112:115], v[48:51]
    v_bfe_u32 v104, v252, 3, 2
    v_lshl_add_u32 v104, v107, 4, v104
    v_mfma_f32_16x16x32_bf16 v[52:55], v[220:223], a[116:119], v[52:55]
    buffer_load_dwordx4 a[168:171], v250, s[36:39], s66 offen sc1
    v_mul_u32_u24 v104, 1152, v104
    v_mfma_f32_16x16x32_bf16 v[0:3], v[160:163], a[128:131], v[0:3]
    ds_read_b64_tr_b16 v[192:193], v240 offset:32768
    ds_read_b64_tr_b16 v[194:195], v240 offset:33024
    v_mfma_f32_16x16x32_bf16 v[4:7], v[160:163], a[132:135], v[4:7]
    ds_read_b64_tr_b16 v[196:197], v240 offset:34816
    v_lshl_add_u32 v112, v105, 4, v104
    v_mfma_f32_16x16x32_bf16 v[16:19], v[164:167], a[128:131], v[16:19]
    ds_read_b64_tr_b16 v[198:199], v240 offset:35072
    v_xor_b32 v105, 4, v105
    v_mfma_f32_16x16x32_bf16 v[20:23], v[164:167], a[132:135], v[20:23]
    ds_read_b64_tr_b16 v[200:201], v241 offset:32768
    ds_read_b64_tr_b16 v[202:203], v241 offset:33024
    v_mfma_f32_16x16x32_bf16 v[32:35], v[168:171], a[128:131], v[32:35]
    ds_read_b64_tr_b16 v[204:205], v241 offset:34816
    buffer_load_dwordx4 a[172:175], v250, s[36:39], s66 offen offset:1024 sc1
    v_mfma_f32_16x16x32_bf16 v[36:39], v[168:171], a[132:135], v[36:39]
    ds_read_b64_tr_b16 v[206:207], v241 offset:35072
    v_lshl_add_u32 v106, v105, 4, v104
    s_waitcnt lgkmcnt(8)
    v_mfma_f32_16x16x32_bf16 v[48:51], v[172:175], a[128:131], v[48:51]
    ds_read_b64_tr_b16 v[208:209], v240 offset:36864
    ds_read_b64_tr_b16 v[210:211], v240 offset:37120
    v_mfma_f32_16x16x32_bf16 v[52:55], v[172:175], a[132:135], v[52:55]
    ds_read_b64_tr_b16 v[212:213], v240 offset:38912
    v_add_u32 v113, 35840, v112
    v_mfma_f32_16x16x32_bf16 v[0:3], v[176:179], a[144:147], v[0:3]
    ds_read_b64_tr_b16 v[214:215], v240 offset:39168
    s_add_u32 s66, s54, 655360
    v_mfma_f32_16x16x32_bf16 v[4:7], v[176:179], a[148:151], v[4:7]
    ds_read_b64_tr_b16 v[216:217], v241 offset:36864
    ds_read_b64_tr_b16 v[218:219], v241 offset:37120
    v_mfma_f32_16x16x32_bf16 v[16:19], v[180:183], a[144:147], v[16:19]
    ds_read_b64_tr_b16 v[220:221], v241 offset:38912
    buffer_load_dwordx4 a[184:187], v250, s[36:39], s66 offen sc1
    v_mfma_f32_16x16x32_bf16 v[20:23], v[180:183], a[148:151], v[20:23]
    ds_read_b64_tr_b16 v[222:223], v241 offset:39168
    v_add_u32 v114, 2560, v106
    v_mfma_f32_16x16x32_bf16 v[32:35], v[184:187], a[144:147], v[32:35]
    v_add_u32 v115, 38400, v106
    v_mfma_f32_16x16x32_bf16 v[36:39], v[184:187], a[148:151], v[36:39]
    v_mfma_f32_16x16x32_bf16 v[48:51], v[188:191], a[144:147], v[48:51]
    v_mfma_f32_16x16x32_bf16 v[52:55], v[188:191], a[148:151], v[52:55]
    buffer_load_dwordx4 a[188:191], v250, s[36:39], s66 offen offset:1024 sc1
    s_waitcnt lgkmcnt(4)
    v_mfma_f32_16x16x32_bf16 v[0:3], v[192:195], a[160:163], v[0:3]
    s_waitcnt vmcnt(7)
    s_waitcnt lgkmcnt(0)
    s_barrier
    v_mfma_f32_16x16x32_bf16 v[4:7], v[192:195], a[164:167], v[4:7]
    ds_read_b64_tr_b16 v[160:161], v238 offset:28672
    ds_read_b64_tr_b16 v[162:163], v238 offset:28928
    v_mfma_f32_16x16x32_bf16 v[16:19], v[196:199], a[160:163], v[16:19]
    ds_read_b64_tr_b16 v[164:165], v238 offset:30720
    v_mov_b32 v64, 3
    buffer_store_dword v64, off, s[36:39], s4 offset:0 sc1
    v_mfma_f32_16x16x32_bf16 v[20:23], v[196:199], a[164:167], v[20:23]
    ds_read_b64_tr_b16 v[166:167], v238 offset:30976
    ds_read_b64_tr_b16 v[168:169], v239 offset:28672
    v_mfma_f32_16x16x32_bf16 v[32:35], v[200:203], a[160:163], v[32:35]
    ds_read_b64_tr_b16 v[170:171], v239 offset:28928
    s_add_u32 s66, s55, 0
    v_mfma_f32_16x16x32_bf16 v[36:39], v[200:203], a[164:167], v[36:39]
    ds_read_b64_tr_b16 v[172:173], v239 offset:30720
    ds_read_b64_tr_b16 v[174:175], v239 offset:30976
    v_mfma_f32_16x16x32_bf16 v[48:51], v[204:207], a[160:163], v[48:51]
    ds_read_b64_tr_b16 v[176:177], v238 offset:32768
    buffer_load_dwordx4 a[200:203], v250, s[36:39], s66 offen sc1
    v_mfma_f32_16x16x32_bf16 v[52:55], v[204:207], a[164:167], v[52:55]
    ds_read_b64_tr_b16 v[178:179], v238 offset:33024
    ds_read_b64_tr_b16 v[180:181], v238 offset:34816
    v_mfma_f32_16x16x32_bf16 v[0:3], v[208:211], a[176:179], v[0:3]
    ds_read_b64_tr_b16 v[182:183], v238 offset:35072
    s_lshr_b32 s73, s2, 6
    v_mfma_f32_16x16x32_bf16 v[4:7], v[208:211], a[180:183], v[4:7]
    ds_read_b64_tr_b16 v[184:185], v239 offset:32768
    ds_read_b64_tr_b16 v[186:187], v239 offset:33024
    v_mfma_f32_16x16x32_bf16 v[16:19], v[212:215], a[176:179], v[16:19]
    ds_read_b64_tr_b16 v[188:189], v239 offset:34816
    buffer_load_dwordx4 a[204:207], v250, s[36:39], s66 offen offset:1024 sc1
    v_mfma_f32_16x16x32_bf16 v[20:23], v[212:215], a[180:183], v[20:23]
    ds_read_b64_tr_b16 v[190:191], v239 offset:35072
    s_xor_b32 s73, s73, s14
    v_mfma_f32_16x16x32_bf16 v[32:35], v[216:219], a[176:179], v[32:35]
    s_and_b32 s72, s73, 1
    s_lshl_b32 s95, s72, 10
    v_mfma_f32_16x16x32_bf16 v[36:39], v[216:219], a[180:183], v[36:39]
    s_add_u32 s66, s55, 131072
    s_lshr_b32 s73, s73, 1
    v_mfma_f32_16x16x32_bf16 v[48:51], v[220:223], a[176:179], v[48:51]
    s_cmp_eq_u32 s16, 1
    s_cselect_b32 s74, 10, 18
    v_mfma_f32_16x16x32_bf16 v[52:55], v[220:223], a[180:183], v[52:55]
    buffer_load_dwordx4 a[216:219], v250, s[36:39], s66 offen sc1
    s_mul_i32 s73, s73, s74
    s_waitcnt lgkmcnt(4)
    v_mfma_f32_16x16x32_bf16 v[0:3], v[160:163], a[192:195], v[0:3]
    ds_read_b64_tr_b16 v[192:193], v238 offset:36864
    ds_read_b64_tr_b16 v[194:195], v238 offset:37120
    v_mfma_f32_16x16x32_bf16 v[4:7], v[160:163], a[196:199], v[4:7]
    ds_read_b64_tr_b16 v[196:197], v238 offset:38912
    s_lshl_b32 s71, s73, 17
    v_mfma_f32_16x16x32_bf16 v[16:19], v[164:167], a[192:195], v[16:19]
    ds_read_b64_tr_b16 v[198:199], v238 offset:39168
    s_add_u32 s75, s18, 2097152
    v_mfma_f32_16x16x32_bf16 v[20:23], v[164:167], a[196:199], v[20:23]
    ds_read_b64_tr_b16 v[200:201], v239 offset:36864
    ds_read_b64_tr_b16 v[202:203], v239 offset:37120
    v_mfma_f32_16x16x32_bf16 v[32:35], v[168:171], a[192:195], v[32:35]
    ds_read_b64_tr_b16 v[204:205], v239 offset:38912
    buffer_load_dwordx4 a[220:223], v250, s[36:39], s66 offen offset:1024 sc1
    v_mfma_f32_16x16x32_bf16 v[36:39], v[168:171], a[196:199], v[36:39]
    ds_read_b64_tr_b16 v[206:207], v239 offset:39168
    s_add_u32 s40, s75, s71
    v_mfma_f32_16x16x32_bf16 v[48:51], v[172:175], a[192:195], v[48:51]
    ds_read_b64_tr_b16 v[208:209], v238 offset:40960
    ds_read_b64_tr_b16 v[210:211], v238 offset:41216
    v_mfma_f32_16x16x32_bf16 v[52:55], v[172:175], a[196:199], v[52:55]
    ds_read_b64_tr_b16 v[212:213], v238 offset:43008
    s_add_u32 s66, s55, 524288
    v_mfma_f32_16x16x32_bf16 v[0:3], v[176:179], a[208:211], v[0:3]
    ds_read_b64_tr_b16 v[214:215], v238 offset:43264
    s_sub_u32 s42, s75, s71
    v_mfma_f32_16x16x32_bf16 v[4:7], v[176:179], a[212:215], v[4:7]
    ds_read_b64_tr_b16 v[216:217], v239 offset:40960
    ds_read_b64_tr_b16 v[218:219], v239 offset:41216
    v_mfma_f32_16x16x32_bf16 v[16:19], v[180:183], a[208:211], v[16:19]
    ds_read_b64_tr_b16 v[220:221], v239 offset:43008
    buffer_load_dwordx4 a[232:235], v250, s[36:39], s66 offen sc1
    v_mfma_f32_16x16x32_bf16 v[20:23], v[180:183], a[212:215], v[20:23]
    ds_read_b64_tr_b16 v[222:223], v239 offset:43264
    s_lshl_b32 s74, s74, 17
    s_waitcnt lgkmcnt(9)
    v_mfma_f32_16x16x32_bf16 v[32:35], v[184:187], a[208:211], v[32:35]
    s_add_u32 s42, s42, s74
    v_mfma_f32_16x16x32_bf16 v[36:39], v[184:187], a[212:215], v[36:39]
    s_lshl_b32 s71, s72, 17
    s_xor_b32 s75, s71, 131072
    v_mfma_f32_16x16x32_bf16 v[48:51], v[188:191], a[208:211], v[48:51]
    buffer_load_dwordx4 a[236:239], v250, s[36:39], s66 offen offset:1024 sc1
    s_add_u32 s41, s40, s75
    v_mfma_f32_16x16x32_bf16 v[52:55], v[188:191], a[212:215], v[52:55]
    s_add_u32 s40, s40, s71
    s_add_u32 s7, s42, s75
    v_mfma_f32_16x16x32_bf16 v[0:3], v[192:195], a[224:227], v[0:3]
    ds_read_b64_tr_b16 v[8:9], v242 offset:8
    ds_read_b64_tr_b16 v[160:161], v238 offset:45056
    ds_read_b64_tr_b16 v[162:163], v238 offset:45312
    v_mfma_f32_16x16x32_bf16 v[4:7], v[192:195], a[228:231], v[4:7]
    ds_read_b64_tr_b16 v[10:11], v242 offset:0
    ds_read_b64_tr_b16 v[164:165], v238 offset:47104
    v_mfma_f32_16x16x32_bf16 v[16:19], v[196:199], a[224:227], v[16:19]
    ds_read_b128 v[12:15], v243 offset:192
    ds_read_b64_tr_b16 v[166:167], v238 offset:47360
    v_mfma_f32_16x16x32_bf16 v[20:23], v[196:199], a[228:231], v[20:23]
    ds_read_b64_tr_b16 v[24:25], v242 offset:520
    ds_read_b64_tr_b16 v[168:169], v239 offset:45056
    ds_read_b64_tr_b16 v[170:171], v239 offset:45312
    v_mfma_f32_16x16x32_bf16 v[32:35], v[200:203], a[224:227], v[32:35]
    ds_read_b64_tr_b16 v[26:27], v242 offset:512
    ds_read_b64_tr_b16 v[172:173], v239 offset:47104
    v_mfma_f32_16x16x32_bf16 v[36:39], v[200:203], a[228:231], v[36:39]
    ds_read_b128 v[28:31], v243 offset:704
    ds_read_b64_tr_b16 v[174:175], v239 offset:47360
    s_waitcnt lgkmcnt(14)
    v_mfma_f32_16x16x32_bf16 v[48:51], v[204:207], a[224:227], v[48:51]
    ds_read_b64_tr_b16 v[40:41], v242 offset:1032
    ds_read_b64_tr_b16 v[176:177], v238 offset:49152
    ds_read_b64_tr_b16 v[178:179], v238 offset:49408
    v_mfma_f32_16x16x32_bf16 v[52:55], v[204:207], a[228:231], v[52:55]
    ds_read_b64_tr_b16 v[42:43], v242 offset:1024
    ds_read_b64_tr_b16 v[180:181], v238 offset:51200
    v_mfma_f32_16x16x32_bf16 v[0:3], v[208:211], a[240:243], v[0:3]
    ds_read_b128 v[44:47], v243 offset:1216
    ds_read_b64_tr_b16 v[182:183], v238 offset:51456
    v_mfma_f32_16x16x32_bf16 v[4:7], v[208:211], a[244:247], v[4:7]
    ds_read_b64_tr_b16 v[56:57], v242 offset:1544
    ds_read_b64_tr_b16 v[184:185], v239 offset:49152
    ds_read_b64_tr_b16 v[186:187], v239 offset:49408
    v_mfma_f32_16x16x32_bf16 v[16:19], v[212:215], a[240:243], v[16:19]
    ds_read_b64_tr_b16 v[58:59], v242 offset:1536
    ds_read_b64_tr_b16 v[188:189], v239 offset:51200
    v_mfma_f32_16x16x32_bf16 v[20:23], v[212:215], a[244:247], v[20:23]
    ds_read_b128 v[60:63], v243 offset:1728
    ds_read_b64_tr_b16 v[190:191], v239 offset:51456
    v_mfma_f32_16x16x32_bf16 v[32:35], v[216:219], a[240:243], v[32:35]
    ds_read_b64_tr_b16 v[136:137], v242 offset:2056
    s_add_u32 s66, s55, 655360
    v_mfma_f32_16x16x32_bf16 v[36:39], v[216:219], a[244:247], v[36:39]
    ds_read_b64_tr_b16 v[138:139], v242 offset:2048
    buffer_load_dwordx4 a[248:251], v250, s[36:39], s66 offen sc1
    v_mfma_f32_16x16x32_bf16 v[48:51], v[220:223], a[240:243], v[48:51]
    ds_read_b128 v[140:143], v243 offset:2240
    s_add_u32 s42, s42, s71
    v_mfma_f32_16x16x32_bf16 v[52:55], v[220:223], a[244:247], v[52:55]
    ds_read_b64_tr_b16 v[152:153], v242 offset:2568
    s_add_u32 s73, s73, s72
    s_waitcnt lgkmcnt(11)
    v_mfma_f32_16x16x32_bf16 v[0:3], v[160:163], v[128:131], v[0:3]
    ds_read_b64_tr_b16 v[154:155], v242 offset:2560
    v_mfma_f32_16x16x32_bf16 v[4:7], v[160:163], v[132:135], v[4:7]
    ds_read_b128 v[156:159], v243 offset:2752
    buffer_load_dwordx4 a[252:255], v250, s[36:39], s66 offen offset:1024 sc1
    v_mfma_f32_16x16x32_bf16 v[16:19], v[164:167], v[128:131], v[16:19]
    ds_read_b64_tr_b16 v[192:193], v242 offset:3080
    s_mul_i32 s73, s73, 36864
    v_mfma_f32_16x16x32_bf16 v[20:23], v[164:167], v[132:135], v[20:23]
    ds_read_b64_tr_b16 v[194:195], v242 offset:3072
    s_and_b32 s72, s17, 1
    v_mfma_f32_16x16x32_bf16 v[32:35], v[168:171], v[128:131], v[32:35]
    ds_read_b128 v[196:199], v243 offset:3264
    s_add_u32 m0, s1, 114688
    v_mfma_f32_16x16x32_bf16 v[36:39], v[168:171], v[132:135], v[36:39]
    ds_read_b64_tr_b16 v[200:201], v242 offset:3592
    s_add_u32 s66, s58, s98
    v_mfma_f32_16x16x32_bf16 v[48:51], v[172:175], v[128:131], v[48:51]
    ds_read_b64_tr_b16 v[202:203], v242 offset:3584
    buffer_load_dwordx4 v112, s[20:23], s66 offen offset:0 lds
    v_mfma_f32_16x16x32_bf16 v[52:55], v[172:175], v[132:135], v[52:55]
    ds_read_b128 v[208:211], v243 offset:3776
    s_mul_i32 s72, s72, 9216
    v_mfma_f32_16x16x32_bf16 v[0:3], v[176:179], v[144:147], v[0:3]
    ds_read_b64_tr_b16 v[212:213], v244 offset:8
    s_add_u32 s73, s73, s72
    v_mfma_f32_16x16x32_bf16 v[16:19], v[180:183], v[144:147], v[16:19]
    ds_read_b64_tr_b16 v[214:215], v244 offset:0
    s_add_u32 s73, s73, s19
    s_waitcnt lgkmcnt(7)
    v_mfma_f32_16x16x32_bf16 v[32:35], v[184:187], v[144:147], v[32:35]
    ds_read_b128 v[216:219], v245 offset:3648
    v_mfma_f32_16x16x32_bf16 v[48:51], v[188:191], v[144:147], v[48:51]
    ds_read_b128 v[220:223], v247 offset:1600
    buffer_load_dwordx4 v113, s[20:23], s66 offen offset:1024 lds
    v_mfma_f32_16x16x32_bf16 v[4:7], v[176:179], v[148:151], v[4:7]
    v_mfma_f32_16x16x32_bf16 v[20:23], v[180:183], v[148:151], v[20:23]
    v_mfma_f32_16x16x32_bf16 v[36:39], v[184:187], v[148:151], v[36:39]
    v_mfma_f32_16x16x32_bf16 v[52:55], v[188:191], v[148:151], v[52:55]
    v_mfma_f32_16x16x32_bf16 v[64:67], v[8:11], v[12:15], 0
    ds_read_b64_tr_b16 v[128:129], v244 offset:520
    v_mul_f32 v0, v0, v16
    v_mfma_f32_16x16x32_bf16 v[68:71], v[24:27], v[12:15], 0
    ds_read_b64_tr_b16 v[130:131], v244 offset:512
    v_mul_f32 v1, v1, v17
    v_mfma_f32_16x16x32_bf16 v[72:75], v[24:27], v[28:31], 0
    ds_read_b128 v[132:135], v245 offset:3136
    v_mul_f32 v2, v2, v18
    v_mfma_f32_16x16x32_bf16 v[68:71], v[8:11], v[28:31], v[68:71]
    ds_read_b128 v[144:147], v247 offset:1088
    v_mul_f32 v3, v3, v19
    v_mfma_f32_16x16x32_bf16 v[72:75], v[40:43], v[12:15], v[72:75]
    ds_read_b64_tr_b16 v[148:149], v244 offset:1032
    v_mul_f32 v32, v32, v48
    v_mfma_f32_16x16x32_bf16 v[76:79], v[40:43], v[28:31], 0
    ds_read_b64_tr_b16 v[150:151], v244 offset:1024
    v_mul_f32 v33, v33, v49
    v_mfma_f32_16x16x32_bf16 v[80:83], v[40:43], v[44:47], 0
    ds_read_b128 v[160:163], v245 offset:2624
    v_mul_f32 v34, v34, v50
    v_mfma_f32_16x16x32_bf16 v[72:75], v[8:11], v[44:47], v[72:75]
    ds_read_b128 v[164:167], v247 offset:576
    v_mul_f32 v35, v35, v51
    v_mfma_f32_16x16x32_bf16 v[76:79], v[24:27], v[44:47], v[76:79]
    ds_read_b64_tr_b16 v[168:169], v244 offset:1544
    v_cvt_pk_bf16_f32 v16, v0, v1
    v_mfma_f32_16x16x32_bf16 v[76:79], v[56:59], v[12:15], v[76:79]
    ds_read_b64_tr_b16 v[170:171], v244 offset:1536
    v_cvt_pk_bf16_f32 v17, v2, v3
    v_mfma_f32_16x16x32_bf16 v[80:83], v[56:59], v[28:31], v[80:83]
    ds_read_b128 v[172:175], v245 offset:2112
    v_cvt_pk_bf16_f32 v18, v32, v33
    v_mfma_f32_16x16x32_bf16 v[84:87], v[56:59], v[44:47], 0
    ds_read_b128 v[176:179], v247 offset:64
    v_cvt_pk_bf16_f32 v19, v34, v35
    v_mfma_f32_16x16x32_bf16 v[88:91], v[56:59], v[60:63], 0
    ds_read_b64_tr_b16 v[180:181], v244 offset:2056
    buffer_store_dwordx4 v[16:19], v250, s[36:39], s34 offen offset:0 sc1
    v_mfma_f32_16x16x32_bf16 v[76:79], v[8:11], v[60:63], v[76:79]
    ds_read_b64_tr_b16 v[182:183], v244 offset:2048
    v_mul_f32 v4, v4, v20
    v_mfma_f32_16x16x32_bf16 v[80:83], v[24:27], v[60:63], v[80:83]
    ds_read_b128 v[184:187], v245 offset:1600
    v_mul_f32 v5, v5, v21
    v_mfma_f32_16x16x32_bf16 v[84:87], v[40:43], v[60:63], v[84:87]
    ds_read_b64_tr_b16 v[188:189], v244 offset:2568
    v_mul_f32 v6, v6, v22
    v_mfma_f32_16x16x32_bf16 v[80:83], v[136:139], v[12:15], v[80:83]
    ds_read_b64_tr_b16 v[190:191], v244 offset:2560
    v_mul_f32 v7, v7, v23
    v_mfma_f32_16x16x32_bf16 v[84:87], v[136:139], v[28:31], v[84:87]
    v_mul_f32 v36, v36, v52
    v_mul_f32 v37, v37, v53
    v_mfma_f32_16x16x32_bf16 v[88:91], v[136:139], v[44:47], v[88:91]
    v_mul_f32 v38, v38, v54
    v_mul_f32 v39, v39, v55
    v_mfma_f32_16x16x32_bf16 v[92:95], v[136:139], v[60:63], 0
    ds_read_b128 v[60:63], v245 offset:1088
    v_cvt_pk_bf16_f32 v20, v4, v5
    v_mfma_f32_16x16x32_bf16 v[80:83], v[8:11], v[140:143], v[80:83]
    ds_read_b64_tr_b16 v[136:137], v244 offset:3080
    v_cvt_pk_bf16_f32 v21, v6, v7
    v_mfma_f32_16x16x32_bf16 v[84:87], v[24:27], v[140:143], v[84:87]
    ds_read_b64_tr_b16 v[138:139], v244 offset:3072
    v_cvt_pk_bf16_f32 v22, v36, v37
    v_mfma_f32_16x16x32_bf16 v[88:91], v[40:43], v[140:143], v[88:91]
    v_cvt_pk_bf16_f32 v23, v38, v39
    buffer_store_dwordx4 v[20:23], v250, s[36:39], s34 offen offset:1024 sc1
    v_mfma_f32_16x16x32_bf16 v[92:95], v[56:59], v[140:143], v[92:95]
    ds_read_b128 v[56:59], v245 offset:576
    buffer_load_dword v207, v253, s[36:39], s48 offen sc1
    v_mfma_f32_16x16x32_bf16 v[84:87], v[152:155], v[12:15], v[84:87]
    ds_read_b64_tr_b16 v[140:141], v244 offset:3592
    s_add_u32 s94, s73, 590848
    v_mfma_f32_16x16x32_bf16 v[88:91], v[152:155], v[28:31], v[88:91]
    ds_read_b64_tr_b16 v[142:143], v244 offset:3584
    s_mov_b32 s96, 0x3f80
    v_mfma_f32_16x16x32_bf16 v[92:95], v[152:155], v[44:47], v[92:95]
    ds_read_b128 v[44:47], v245 offset:64
    buffer_load_dwordx4 v114, s[20:23], s66 offen offset:2048 lds
    v_mfma_f32_16x16x32_bf16 v[84:87], v[8:11], v[156:159], v[84:87]
    ds_read_b64_tr_b16 v[152:153], v242 offset:72
    s_and_b32 s43, s2, 0xe1
    v_mfma_f32_16x16x32_bf16 v[88:91], v[24:27], v[156:159], v[88:91]
    ds_read_b64_tr_b16 v[154:155], v242 offset:64
    s_lshl_b32 s43, s43, 8
    v_mfma_f32_16x16x32_bf16 v[92:95], v[40:43], v[156:159], v[92:95]
    ds_read_b128 v[40:43], v243 offset:128
    buffer_load_dwordx4 v115, s[20:23], s66 offen offset:3072 lds
    s_waitcnt lgkmcnt(7)
    v_mfma_f32_16x16x32_bf16 v[88:91], v[192:195], v[12:15], v[88:91]
    ds_read_b64_tr_b16 v[156:157], v242 offset:584
    v_mfma_f32_16x16x32_bf16 v[92:95], v[192:195], v[28:31], v[92:95]
    ds_read_b64_tr_b16 v[158:159], v242 offset:576
    s_add_u32 m0, s1, 131072
    v_mfma_f32_16x16x32_bf16 v[88:91], v[8:11], v[196:199], v[88:91]
    ds_read_b128 v[0:3], v243 offset:640
    s_add_u32 s66, s59, s98
    v_mfma_f32_16x16x32_bf16 v[92:95], v[24:27], v[196:199], v[92:95]
    ds_read_b64_tr_b16 v[4:5], v242 offset:1096
    buffer_load_dwordx4 v112, s[20:23], s66 offen offset:0 lds
    v_mfma_f32_16x16x32_bf16 v[92:95], v[200:203], v[12:15], v[92:95]
    ds_read_b64_tr_b16 v[6:7], v242 offset:1088
    s_lshl_b32 s72, s17, 2
    v_mfma_f32_16x16x32_bf16 v[92:95], v[8:11], v[208:211], v[92:95]
    ds_read_b128 v[12:15], v243 offset:1152
    s_add_u32 s43, s43, s72
    v_mfma_f32_16x16x32_bf16 v[100:103], v[212:215], v[216:219], 0
    ds_read_b64_tr_b16 v[8:9], v242 offset:1608
    s_add_u32 s43, s43, 196608
    v_mfma_f32_16x16x32_bf16 v[96:99], v[212:215], v[220:223], 0
    ds_read_b64_tr_b16 v[10:11], v242 offset:1600
    buffer_load_dwordx4 v113, s[20:23], s66 offen offset:1024 lds
    v_mfma_f32_16x16x32_bf16 v[100:103], v[128:131], v[132:135], v[100:103]
    ds_read_b128 v[16:19], v243 offset:1664
    s_mov_b32 s19, 0x3f800000
    v_mfma_f32_16x16x32_bf16 v[96:99], v[128:131], v[144:147], v[96:99]
    ds_read_b64_tr_b16 v[20:21], v242 offset:2120
    ds_read_b64 v[106:107], v248 offset:17120
    v_mfma_f32_16x16x32_bf16 v[100:103], v[148:151], v[160:163], v[100:103]
    ds_read_b64_tr_b16 v[22:23], v242 offset:2112
    buffer_load_dwordx4 v114, s[20:23], s66 offen offset:2048 lds
    v_mfma_f32_16x16x32_bf16 v[96:99], v[148:151], v[164:167], v[96:99]
    ds_read_b128 v[24:27], v243 offset:2176
    ds_read_b64 v[110:111], v248 offset:17632
    v_mfma_f32_16x16x32_bf16 v[100:103], v[168:171], v[172:175], v[100:103]
    ds_read_b64_tr_b16 v[28:29], v242 offset:2632
    ds_read_b64 v[118:119], v248 offset:18144
    v_mfma_f32_16x16x32_bf16 v[96:99], v[168:171], v[176:179], v[96:99]
    ds_read_b64_tr_b16 v[30:31], v242 offset:2624
    ds_read_b64 v[122:123], v248 offset:18656
    v_mfma_f32_16x16x32_bf16 v[100:103], v[180:183], v[184:187], v[100:103]
    ds_read_b128 v[32:35], v243 offset:2688
    buffer_load_dwordx4 v115, s[20:23], s66 offen offset:3072 lds
    v_mfma_f32_16x16x32_bf16 v[100:103], v[188:191], v[60:63], v[100:103]
    ds_read_b64_tr_b16 v[36:37], v242 offset:3144
    s_add_u32 m0, s1, 65536
    s_waitcnt lgkmcnt(11)
    v_mfma_f32_16x16x32_bf16 v[100:103], v[136:139], v[56:59], v[100:103]
    ds_read_b64_tr_b16 v[38:39], v242 offset:3136
    v_mfma_f32_16x16x32_bf16 v[100:103], v[140:143], v[44:47], v[100:103]
    ds_read_b128 v[48:51], v243 offset:3200
    s_add_u32 s66, s29, s98
    v_mfma_f32_16x16x32_bf16 v[64:67], v[152:155], v[40:43], v[64:67]
    ds_read_b64_tr_b16 v[44:45], v242 offset:3656
    buffer_load_dwordx4 v112, s[20:23], s66 offen offset:0 lds
    v_mfma_f32_16x16x32_bf16 v[68:71], v[156:159], v[40:43], v[68:71]
    ds_read_b64_tr_b16 v[46:47], v242 offset:3648
    ds_read_b32 v205, v246 offset:61088
    v_mfma_f32_16x16x32_bf16 v[72:75], v[156:159], v[0:3], v[72:75]
    ds_read_b128 v[52:55], v243 offset:3712
    v_mfma_f32_16x16x32_bf16 v[68:71], v[152:155], v[0:3], v[68:71]
    ds_read_b64_tr_b16 v[56:57], v244 offset:72
    buffer_load_dwordx4 v113, s[20:23], s66 offen offset:1024 lds
    v_mfma_f32_16x16x32_bf16 v[72:75], v[4:7], v[40:43], v[72:75]
    ds_read_b64_tr_b16 v[58:59], v244 offset:64
    v_mfma_f32_16x16x32_bf16 v[76:79], v[4:7], v[0:3], v[76:79]
    ds_read_b128 v[60:63], v245 offset:3584
    v_mfma_f32_16x16x32_bf16 v[80:83], v[4:7], v[12:15], v[80:83]
    ds_read_b128 v[128:131], v247 offset:1536
    v_mfma_f32_16x16x32_bf16 v[72:75], v[152:155], v[12:15], v[72:75]
    ds_read_b64_tr_b16 v[132:133], v244 offset:584
    buffer_load_dwordx4 v114, s[20:23], s66 offen offset:2048 lds
    v_mfma_f32_16x16x32_bf16 v[76:79], v[156:159], v[12:15], v[76:79]
    ds_read_b64_tr_b16 v[134:135], v244 offset:576
    v_mfma_f32_16x16x32_bf16 v[76:79], v[8:11], v[40:43], v[76:79]
    ds_read_b128 v[136:139], v245 offset:3072
    v_mfma_f32_16x16x32_bf16 v[80:83], v[8:11], v[0:3], v[80:83]
    ds_read_b128 v[140:143], v247 offset:1024
    buffer_load_dwordx4 v115, s[20:23], s66 offen offset:3072 lds
    v_mfma_f32_16x16x32_bf16 v[84:87], v[8:11], v[12:15], v[84:87]
    ds_read_b64_tr_b16 v[144:145], v244 offset:1096
    s_waitcnt lgkmcnt(7)
    v_lshlrev_b32 v104, 16, v106
    v_mfma_f32_16x16x32_bf16 v[88:91], v[8:11], v[16:19], v[88:91]
    ds_read_b64_tr_b16 v[146:147], v244 offset:1088
    s_add_u32 m0, s1, 147456
    v_mfma_f32_16x16x32_bf16 v[76:79], v[152:155], v[16:19], v[76:79]
    ds_read_b128 v[148:151], v245 offset:2560
    s_add_u32 s66, s0, s98
    v_mfma_f32_16x16x32_bf16 v[80:83], v[156:159], v[16:19], v[80:83]
    ds_read_b128 v[160:163], v247 offset:512
    buffer_load_dwordx4 v112, s[20:23], s66 offen offset:0 lds
    v_mfma_f32_16x16x32_bf16 v[84:87], v[4:7], v[16:19], v[84:87]
    ds_read_b64_tr_b16 v[164:165], v244 offset:1608
    v_and_b32 v105, s31, v106
    v_mfma_f32_16x16x32_bf16 v[80:83], v[20:23], v[40:43], v[80:83]
    ds_read_b64_tr_b16 v[166:167], v244 offset:1600
    v_lshlrev_b32 v106, 16, v107
    v_mfma_f32_16x16x32_bf16 v[84:87], v[20:23], v[0:3], v[84:87]
    ds_read_b128 v[168:171], v245 offset:2048
    buffer_load_dwordx4 v113, s[20:23], s66 offen offset:1024 lds
    v_mfma_f32_16x16x32_bf16 v[88:91], v[20:23], v[12:15], v[88:91]
    ds_read_b128 v[172:175], v247 offset:0
    v_and_b32 v107, s31, v107
    v_mfma_f32_16x16x32_bf16 v[92:95], v[20:23], v[16:19], v[92:95]
    ds_read_b64_tr_b16 v[176:177], v244 offset:2120
    v_pk_mul_f32 v[104:105], v[104:105], s[100:101] op_sel_hi:[1,0]
    v_mfma_f32_16x16x32_bf16 v[80:83], v[152:155], v[24:27], v[80:83]
    ds_read_b64_tr_b16 v[178:179], v244 offset:2112
    v_pk_mul_f32 v[106:107], v[106:107], s[100:101] op_sel_hi:[1,0]
    v_mfma_f32_16x16x32_bf16 v[84:87], v[156:159], v[24:27], v[84:87]
    ds_read_b128 v[16:19], v245 offset:1536
    buffer_load_dwordx4 v114, s[20:23], s66 offen offset:2048 lds
    v_mfma_f32_16x16x32_bf16 v[88:91], v[4:7], v[24:27], v[88:91]
    ds_read_b64_tr_b16 v[20:21], v244 offset:2632
    s_waitcnt vmcnt(13)
    v_mfma_f32_16x16x32_bf16 v[92:95], v[8:11], v[24:27], v[92:95]
    ds_read_b64_tr_b16 v[22:23], v244 offset:2624
    v_cmp_le_u32 vcc, 3, v207
    s_cmp_eq_u64 vcc, exec
    s_cbranch_scc0 gated_mix__ssm_conv_s4__glu_gated_bilinear__prompt_kernel_slow4
gated_mix__ssm_conv_s4__glu_gated_bilinear__prompt_kernel_back4:
    v_mfma_f32_16x16x32_bf16 v[84:87], v[28:31], v[40:43], v[84:87]
    ds_read_b128 v[8:11], v245 offset:1024
    v_cvt_pk_bf16_f32 v104, 0, v104
    v_mfma_f32_16x16x32_bf16 v[88:91], v[28:31], v[0:3], v[88:91]
    ds_read_b64_tr_b16 v[24:25], v244 offset:3144
    buffer_load_dwordx4 v115, s[20:23], s66 offen offset:3072 lds
    v_mfma_f32_16x16x32_bf16 v[92:95], v[28:31], v[12:15], v[92:95]
    ds_read_b64_tr_b16 v[26:27], v244 offset:3136
    s_add_u32 s66, s32, 262144
    v_mfma_f32_16x16x32_bf16 v[84:87], v[152:155], v[32:35], v[84:87]
    ds_read_b128 v[12:15], v245 offset:512
    v_cvt_pk_bf16_f32 v105, 0, v105
    v_mfma_f32_16x16x32_bf16 v[88:91], v[156:159], v[32:35], v[88:91]
    ds_read_b64_tr_b16 v[28:29], v244 offset:3656
    buffer_load_dwordx4 a[0:3], v250, s[36:39], s66 offen sc1
    v_mfma_f32_16x16x32_bf16 v[92:95], v[4:7], v[32:35], v[92:95]
    ds_read_b64_tr_b16 v[30:31], v244 offset:3648
    v_cvt_pk_bf16_f32 v106, 0, v106
    v_mfma_f32_16x16x32_bf16 v[88:91], v[36:39], v[40:43], v[88:91]
    ds_read_b128 v[4:7], v245 offset:0
    v_cvt_pk_bf16_f32 v107, 0, v107
    v_mfma_f32_16x16x32_bf16 v[92:95], v[36:39], v[0:3], v[92:95]
    ds_read_b64_tr_b16 v[32:33], v242 offset:136
    v_lshlrev_b32 v108, 16, v110
    v_mfma_f32_16x16x32_bf16 v[88:91], v[152:155], v[48:51], v[88:91]
    s_barrier
    ds_read_b64_tr_b16 v[34:35], v242 offset:128
    v_mfma_f32_16x16x32_bf16 v[92:95], v[156:159], v[48:51], v[92:95]
    ds_read_b128 v[0:3], v243 offset:64
    buffer_load_dwordx4 a[4:7], v250, s[36:39], s66 offen offset:1024 sc1
    v_mfma_f32_16x16x32_bf16 v[92:95], v[44:47], v[40:43], v[92:95]
    ds_read_b64_tr_b16 v[36:37], v242 offset:648
    v_mov_b32 v206, 4
    buffer_store_dword v206, off, s[36:39], s4 offset:0 sc1
    v_mfma_f32_16x16x32_bf16 v[92:95], v[152:155], v[52:55], v[92:95]
    ds_read_b64_tr_b16 v[38:39], v242 offset:640
    s_add_u32 s66, s32, 393216
    s_waitcnt lgkmcnt(7)
    v_mfma_f32_16x16x32_bf16 v[100:103], v[56:59], v[60:63], v[100:103]
    ds_read_b128 v[40:43], v243 offset:576
    v_mfma_f32_16x16x32_bf16 v[96:99], v[56:59], v[128:131], v[96:99]
    ds_read_b64_tr_b16 v[44:45], v242 offset:1160
    buffer_load_dwordx4 a[16:19], v250, s[36:39], s66 offen sc1
    v_mfma_f32_16x16x32_bf16 v[100:103], v[132:135], v[136:139], v[100:103]
    ds_read_b64_tr_b16 v[46:47], v242 offset:1152
    v_and_b32 v109, s31, v110
    v_mfma_f32_16x16x32_bf16 v[96:99], v[132:135], v[140:143], v[96:99]
    ds_read_b128 v[48:51], v243 offset:1088
    v_lshlrev_b32 v110, 16, v111
    v_mfma_f32_16x16x32_bf16 v[100:103], v[144:147], v[148:151], v[100:103]
    ds_read_b64_tr_b16 v[52:53], v242 offset:1672
    v_and_b32 v111, s31, v111
    v_mfma_f32_16x16x32_bf16 v[96:99], v[144:147], v[160:163], v[96:99]
    ds_read_b64_tr_b16 v[54:55], v242 offset:1664
    buffer_load_dwordx4 a[20:23], v250, s[36:39], s66 offen offset:1024 sc1
    v_mfma_f32_16x16x32_bf16 v[100:103], v[164:167], v[168:171], v[100:103]
    ds_read_b128 v[56:59], v243 offset:1600
    v_pk_mul_f32 v[108:109], v[108:109], s[100:101] op_sel_hi:[1,0]
    v_mfma_f32_16x16x32_bf16 v[96:99], v[164:167], v[172:175], v[96:99]
    ds_read_b64_tr_b16 v[60:61], v242 offset:2184
    s_add_u32 s66, s32, 786432
    v_mfma_f32_16x16x32_bf16 v[100:103], v[176:179], v[16:19], v[100:103]
    ds_read_b64_tr_b16 v[62:63], v242 offset:2176
    v_pk_mul_f32 v[110:111], v[110:111], s[100:101] op_sel_hi:[1,0]
    v_mfma_f32_16x16x32_bf16 v[100:103], v[20:23], v[8:11], v[100:103]
    ds_read_b128 v[16:19], v243 offset:2112
    buffer_load_dwordx4 a[32:35], v250, s[36:39], s66 offen sc1
    v_mfma_f32_16x16x32_bf16 v[100:103], v[24:27], v[12:15], v[100:103]
    ds_read_b64_tr_b16 v[8:9], v242 offset:2696
    v_cvt_pk_bf16_f32 v108, 0, v108
    s_waitcnt lgkmcnt(7)
    v_mfma_f32_16x16x32_bf16 v[100:103], v[28:31], v[4:7], v[100:103]
    ds_read_b64_tr_b16 v[10:11], v242 offset:2688
    v_mfma_f32_16x16x32_bf16 v[64:67], v[32:35], v[0:3], v[64:67]
    ds_read_b128 v[4:7], v243 offset:2624
    v_cvt_pk_bf16_f32 v109, 0, v109
    v_mfma_f32_16x16x32_bf16 v[68:71], v[36:39], v[0:3], v[68:71]
    ds_read_b64_tr_b16 v[12:13], v242 offset:3208
    buffer_load_dwordx4 a[36:39], v250, s[36:39], s66 offen offset:1024 sc1
    v_mfma_f32_16x16x32_bf16 v[72:75], v[36:39], v[40:43], v[72:75]
    ds_read_b64_tr_b16 v[14:15], v242 offset:3200
    v_cvt_pk_bf16_f32 v110, 0, v110
    v_mfma_f32_16x16x32_bf16 v[68:71], v[32:35], v[40:43], v[68:71]
    ds_read_b128 v[20:23], v243 offset:3136
    s_add_u32 s66, s32, 917504
    v_mfma_f32_16x16x32_bf16 v[72:75], v[44:47], v[0:3], v[72:75]
    ds_read_b64_tr_b16 v[24:25], v242 offset:3720
    v_cvt_pk_bf16_f32 v111, 0, v111
    v_mfma_f32_16x16x32_bf16 v[76:79], v[44:47], v[40:43], v[76:79]
    ds_read_b64_tr_b16 v[26:27], v242 offset:3712
    buffer_load_dwordx4 a[48:51], v250, s[36:39], s66 offen sc1
    v_mfma_f32_16x16x32_bf16 v[80:83], v[44:47], v[48:51], v[80:83]
    ds_read_b128 v[28:31], v243 offset:3648
    ds_write_b128 v249, v[96:99] offset:4096
    v_mfma_f32_16x16x32_bf16 v[72:75], v[32:35], v[48:51], v[72:75]
    ds_read_b64_tr_b16 v[220:221], v242 offset:200
    v_lshlrev_b32 v116, 16, v118
    v_mfma_f32_16x16x32_bf16 v[76:79], v[36:39], v[48:51], v[76:79]
    ds_read_b64_tr_b16 v[222:223], v242 offset:192
    ds_write_b128 v249, v[100:103] offset:5120
    s_waitcnt lgkmcnt(9)
    v_mfma_f32_16x16x32_bf16 v[76:79], v[52:55], v[0:3], v[76:79]
    ds_read_b128 v[216:219], v243 offset:0
    v_mfma_f32_16x16x32_bf16 v[80:83], v[52:55], v[40:43], v[80:83]
    ds_read_b64_tr_b16 v[212:213], v242 offset:712
    buffer_load_dwordx4 a[52:55], v250, s[36:39], s66 offen offset:1024 sc1
    v_mfma_f32_16x16x32_bf16 v[84:87], v[52:55], v[48:51], v[84:87]
    ds_read_b64_tr_b16 v[214:215], v242 offset:704
    s_add_u32 s66, s33, 262144
    v_mfma_f32_16x16x32_bf16 v[88:91], v[52:55], v[56:59], v[88:91]
    ds_read_b128 v[208:211], v243 offset:512
    v_and_b32 v117, s31, v118
    v_mfma_f32_16x16x32_bf16 v[76:79], v[32:35], v[56:59], v[76:79]
    ds_read_b64_tr_b16 v[200:201], v242 offset:1224
    buffer_load_dwordx4 a[64:67], v250, s[36:39], s66 offen sc1
    v_mfma_f32_16x16x32_bf16 v[80:83], v[36:39], v[56:59], v[80:83]
    ds_read_b64_tr_b16 v[202:203], v242 offset:1216
    v_lshlrev_b32 v118, 16, v119
    v_mfma_f32_16x16x32_bf16 v[84:87], v[44:47], v[56:59], v[84:87]
    ds_read_b128 v[196:199], v243 offset:1024
    v_and_b32 v119, s31, v119
    v_mfma_f32_16x16x32_bf16 v[80:83], v[60:63], v[0:3], v[80:83]
    ds_read_b64_tr_b16 v[192:193], v242 offset:1736
    v_pk_mul_f32 v[116:117], v[116:117], s[100:101] op_sel_hi:[1,0]
    v_mfma_f32_16x16x32_bf16 v[84:87], v[60:63], v[40:43], v[84:87]
    ds_read_b64_tr_b16 v[194:195], v242 offset:1728
    v_pk_mul_f32 v[118:119], v[118:119], s[100:101] op_sel_hi:[1,0]
    v_mfma_f32_16x16x32_bf16 v[88:91], v[60:63], v[48:51], v[88:91]
    ds_read_b128 v[188:191], v243 offset:1536
    buffer_load_dwordx4 a[68:71], v250, s[36:39], s66 offen offset:1024 sc1
    v_mfma_f32_16x16x32_bf16 v[92:95], v[60:63], v[56:59], v[92:95]
    ds_read_b64_tr_b16 v[184:185], v242 offset:2248
    v_cvt_pk_bf16_f32 v116, 0, v116
    v_mfma_f32_16x16x32_bf16 v[80:83], v[32:35], v[16:19], v[80:83]
    ds_read_b64_tr_b16 v[186:187], v242 offset:2240
    s_add_u32 s66, s33, 393216
    v_mfma_f32_16x16x32_bf16 v[84:87], v[36:39], v[16:19], v[84:87]
    ds_read_b128 v[180:183], v243 offset:2048
    v_cvt_pk_bf16_f32 v117, 0, v117
    v_mfma_f32_16x16x32_bf16 v[88:91], v[44:47], v[16:19], v[88:91]
    ds_read_b64_tr_b16 v[176:177], v242 offset:2760
    ds_read_b64_tr_b16 v[178:179], v242 offset:2752
    v_mfma_f32_16x16x32_bf16 v[92:95], v[52:55], v[16:19], v[92:95]
    ds_read_b128 v[172:175], v243 offset:2560
    buffer_load_dwordx4 a[80:83], v250, s[36:39], s66 offen sc1
    v_mfma_f32_16x16x32_bf16 v[84:87], v[8:11], v[0:3], v[84:87]
    ds_read_b64_tr_b16 v[168:169], v242 offset:3272
    ds_read_b64_tr_b16 v[170:171], v242 offset:3264
    v_mfma_f32_16x16x32_bf16 v[88:91], v[8:11], v[40:43], v[88:91]
    ds_read_b128 v[164:167], v243 offset:3072
    v_cvt_pk_bf16_f32 v118, 0, v118
    v_mfma_f32_16x16x32_bf16 v[92:95], v[8:11], v[48:51], v[92:95]
    ds_read_b64_tr_b16 v[160:161], v242 offset:3784
    ds_read_b64_tr_b16 v[162:163], v242 offset:3776
    v_mfma_f32_16x16x32_bf16 v[84:87], v[32:35], v[4:7], v[84:87]
    ds_read_b128 v[156:159], v243 offset:3584
    buffer_load_dwordx4 a[84:87], v250, s[36:39], s66 offen offset:1024 sc1
    v_mfma_f32_16x16x32_bf16 v[88:91], v[36:39], v[4:7], v[88:91]
    s_add_u32 s66, s33, 786432
    v_cvt_pk_bf16_f32 v119, 0, v119
    v_mfma_f32_16x16x32_bf16 v[92:95], v[44:47], v[4:7], v[92:95]
    v_lshlrev_b32 v120, 16, v122
    v_and_b32 v121, s31, v122
    s_waitcnt lgkmcnt(7)
    v_mfma_f32_16x16x32_bf16 v[88:91], v[12:15], v[0:3], v[88:91]
    buffer_load_dwordx4 a[96:99], v250, s[36:39], s66 offen sc1
    v_mfma_f32_16x16x32_bf16 v[92:95], v[12:15], v[40:43], v[92:95]
    v_lshlrev_b32 v122, 16, v123
    v_and_b32 v123, s31, v123
    v_mfma_f32_16x16x32_bf16 v[88:91], v[32:35], v[20:23], v[88:91]
    v_pk_mul_f32 v[120:121], v[120:121], s[100:101] op_sel_hi:[1,0]
    v_pk_mul_f32 v[122:123], v[122:123], s[100:101] op_sel_hi:[1,0]
    v_mfma_f32_16x16x32_bf16 v[92:95], v[36:39], v[20:23], v[92:95]
    v_cvt_pk_bf16_f32 v120, 0, v120
    v_cvt_pk_bf16_f32 v121, 0, v121
    v_mfma_f32_16x16x32_bf16 v[92:95], v[24:27], v[0:3], v[92:95]
    buffer_load_dwordx4 a[100:103], v250, s[36:39], s66 offen offset:1024 sc1
    v_cvt_pk_bf16_f32 v122, 0, v122
    v_mfma_f32_16x16x32_bf16 v[92:95], v[32:35], v[28:31], v[92:95]
    v_cvt_pk_bf16_f32 v123, 0, v123
    v_lshlrev_b32 v204, 16, v205
    s_waitcnt vmcnt(23)
    s_waitcnt lgkmcnt(0)
    s_barrier
    s_bitcmp1_b32 s17, 0
    s_cbranch_scc1 gated_mix__ssm_conv_s4__glu_gated_bilinear__prompt_kernel_r3b
    v_mfma_f32_16x16x32_bf16 v[80:83], v[220:223], v[180:183], v[80:83]
    s_add_u32 m0, s1, 0
    s_add_u32 s66, s58, 1024
    v_mfma_f32_16x16x32_bf16 v[84:87], v[220:223], v[172:175], v[84:87]
    v_and_b32 v205, s31, v205
    v_pk_mul_f32 v[204:205], v[204:205], s[100:101] op_sel:[0,1] op_sel_hi:[1,1]
    v_mfma_f32_16x16x32_bf16 v[88:91], v[220:223], v[164:167], v[88:91]
    buffer_load_dwordx4 v112, s[20:23], s66 offen offset:0 lds
    v_cvt_pk_bf16_f32 v204, 0, v204
    v_mfma_f32_16x16x32_bf16 v[92:95], v[220:223], v[156:159], v[92:95]
    v_cvt_pk_bf16_f32 v205, 0, v205
    v_mfma_f32_16x16x32_bf16 v[80:83], v[212:215], v[188:191], v[80:83]
    v_mfma_f32_16x16x32_bf16 v[84:87], v[212:215], v[180:183], v[84:87]
    buffer_load_dwordx4 v113, s[20:23], s66 offen offset:1024 lds
    v_mfma_f32_16x16x32_bf16 v[88:91], v[212:215], v[172:175], v[88:91]
    v_mfma_f32_16x16x32_bf16 v[92:95], v[212:215], v[164:167], v[92:95]
    v_mfma_f32_16x16x32_bf16 v[80:83], v[200:203], v[196:199], v[80:83]
    v_mfma_f32_16x16x32_bf16 v[84:87], v[200:203], v[188:191], v[84:87]
    buffer_load_dwordx4 v114, s[20:23], s66 offen offset:2048 lds
    v_mfma_f32_16x16x32_bf16 v[88:91], v[200:203], v[180:183], v[88:91]
    v_mfma_f32_16x16x32_bf16 v[92:95], v[200:203], v[172:175], v[92:95]
    v_mfma_f32_16x16x32_bf16 v[80:83], v[192:195], v[208:211], v[80:83]
    ds_read_b64_tr_b16 v[0:1], v228 offset:53248
    v_mfma_f32_16x16x32_bf16 v[84:87], v[192:195], v[196:199], v[84:87]
    ds_read_b64_tr_b16 v[2:3], v228 offset:53760
    buffer_load_dwordx4 v115, s[20:23], s66 offen offset:3072 lds
    v_mfma_f32_16x16x32_bf16 v[88:91], v[192:195], v[188:191], v[88:91]
    ds_read_b64_tr_b16 v[4:5], v229 offset:53248
    s_add_u32 m0, s1, 16384
    v_mfma_f32_16x16x32_bf16 v[92:95], v[192:195], v[180:183], v[92:95]
    ds_read_b64_tr_b16 v[6:7], v229 offset:53760
    s_add_u32 s66, s58, s98
    v_mfma_f32_16x16x32_bf16 v[80:83], v[184:187], v[216:219], v[80:83]
    ds_read_b64_tr_b16 v[8:9], v230 offset:53248
    s_add_u32 s66, s66, 73728
    v_mfma_f32_16x16x32_bf16 v[84:87], v[184:187], v[208:211], v[84:87]
    ds_read_b64_tr_b16 v[10:11], v230 offset:53760
    buffer_load_dwordx4 v112, s[20:23], s66 offen offset:0 lds
    v_mfma_f32_16x16x32_bf16 v[88:91], v[184:187], v[196:199], v[88:91]
    ds_read_b64_tr_b16 v[12:13], v231 offset:53248
    v_mfma_f32_16x16x32_bf16 v[92:95], v[184:187], v[188:191], v[92:95]
    ds_read_b64_tr_b16 v[14:15], v231 offset:53760
    v_mfma_f32_16x16x32_bf16 v[84:87], v[176:179], v[216:219], v[84:87]
    ds_read_b64_tr_b16 v[16:17], v228 offset:54272
    buffer_load_dwordx4 v113, s[20:23], s66 offen offset:1024 lds
    v_mfma_f32_16x16x32_bf16 v[88:91], v[176:179], v[208:211], v[88:91]
    ds_write_b128 v249, v[80:83] offset:0
    v_mfma_f32_16x16x32_bf16 v[92:95], v[176:179], v[196:199], v[92:95]
    ds_read_b64_tr_b16 v[18:19], v228 offset:54784
    v_mfma_f32_16x16x32_bf16 v[88:91], v[168:171], v[216:219], v[88:91]
    ds_read_b64_tr_b16 v[20:21], v229 offset:54272
    buffer_load_dwordx4 v114, s[20:23], s66 offen offset:2048 lds
    v_mfma_f32_16x16x32_bf16 v[92:95], v[168:171], v[208:211], v[92:95]
    ds_read_b64_tr_b16 v[22:23], v229 offset:54784
    v_mfma_f32_16x16x32_bf16 v[92:95], v[160:163], v[216:219], v[92:95]
    ds_write_b128 v249, v[84:87] offset:1024
    v_mfma_f32_16x16x32_bf16 v[64:67], v[220:223], v[216:219], v[64:67]
    ds_read_b64_tr_b16 v[24:25], v230 offset:54272
    v_mfma_f32_16x16x32_bf16 v[68:71], v[220:223], v[208:211], v[68:71]
    ds_read_b64_tr_b16 v[26:27], v230 offset:54784
    buffer_load_dwordx4 v115, s[20:23], s66 offen offset:3072 lds
    v_mfma_f32_16x16x32_bf16 v[72:75], v[220:223], v[196:199], v[72:75]
    ds_write_b128 v249, v[88:91] offset:2048
    v_mfma_f32_16x16x32_bf16 v[76:79], v[220:223], v[188:191], v[76:79]
    ds_read_b64_tr_b16 v[28:29], v231 offset:54272
    s_add_u32 m0, s1, 32768
    v_mfma_f32_16x16x32_bf16 v[68:71], v[212:215], v[216:219], v[68:71]
    ds_write_b128 v249, v[92:95] offset:3072
    s_add_u32 s66, s59, s98
    v_mfma_f32_16x16x32_bf16 v[72:75], v[212:215], v[208:211], v[72:75]
    ds_read_b64_tr_b16 v[30:31], v231 offset:54784
    s_add_u32 s66, s66, 73728
    v_mfma_f32_16x16x32_bf16 v[76:79], v[212:215], v[196:199], v[76:79]
    buffer_load_dwordx4 v112, s[20:23], s66 offen offset:0 lds
    v_mfma_f32_16x16x32_bf16 v[72:75], v[200:203], v[216:219], v[72:75]
    v_mfma_f32_16x16x32_bf16 v[76:79], v[200:203], v[208:211], v[76:79]
    buffer_load_dwordx4 v113, s[20:23], s66 offen offset:1024 lds
    v_mfma_f32_16x16x32_bf16 v[76:79], v[192:195], v[216:219], v[76:79]
    s_branch gated_mix__ssm_conv_s4__glu_gated_bilinear__prompt_kernel_r3e
gated_mix__ssm_conv_s4__glu_gated_bilinear__prompt_kernel_r3b:
    v_mfma_f32_16x16x32_bf16 v[64:67], v[220:223], v[216:219], v[64:67]
    s_add_u32 m0, s1, 0
    s_add_u32 s66, s58, 1024
    v_mfma_f32_16x16x32_bf16 v[68:71], v[220:223], v[208:211], v[68:71]
    v_and_b32 v205, s31, v205
    v_pk_mul_f32 v[204:205], v[204:205], s[100:101] op_sel:[0,1] op_sel_hi:[1,1]
    v_mfma_f32_16x16x32_bf16 v[72:75], v[220:223], v[196:199], v[72:75]
    buffer_load_dwordx4 v112, s[20:23], s66 offen offset:0 lds
    v_cvt_pk_bf16_f32 v204, 0, v204
    v_mfma_f32_16x16x32_bf16 v[76:79], v[220:223], v[188:191], v[76:79]
    v_cvt_pk_bf16_f32 v205, 0, v205
    v_mfma_f32_16x16x32_bf16 v[68:71], v[212:215], v[216:219], v[68:71]
    v_mfma_f32_16x16x32_bf16 v[72:75], v[212:215], v[208:211], v[72:75]
    buffer_load_dwordx4 v113, s[20:23], s66 offen offset:1024 lds
    v_mfma_f32_16x16x32_bf16 v[76:79], v[212:215], v[196:199], v[76:79]
    v_mfma_f32_16x16x32_bf16 v[72:75], v[200:203], v[216:219], v[72:75]
    v_mfma_f32_16x16x32_bf16 v[76:79], v[200:203], v[208:211], v[76:79]
    v_mfma_f32_16x16x32_bf16 v[76:79], v[192:195], v[216:219], v[76:79]
    buffer_load_dwordx4 v114, s[20:23], s66 offen offset:2048 lds
    v_mfma_f32_16x16x32_bf16 v[80:83], v[220:223], v[180:183], v[80:83]
    v_mfma_f32_16x16x32_bf16 v[84:87], v[220:223], v[172:175], v[84:87]
    v_mfma_f32_16x16x32_bf16 v[88:91], v[220:223], v[164:167], v[88:91]
    ds_read_b64_tr_b16 v[0:1], v228 offset:53248
    v_mfma_f32_16x16x32_bf16 v[92:95], v[220:223], v[156:159], v[92:95]
    ds_read_b64_tr_b16 v[2:3], v228 offset:53760
    buffer_load_dwordx4 v115, s[20:23], s66 offen offset:3072 lds
    v_mfma_f32_16x16x32_bf16 v[80:83], v[212:215], v[188:191], v[80:83]
    ds_read_b64_tr_b16 v[4:5], v229 offset:53248
    s_add_u32 m0, s1, 16384
    v_mfma_f32_16x16x32_bf16 v[84:87], v[212:215], v[180:183], v[84:87]
    ds_read_b64_tr_b16 v[6:7], v229 offset:53760
    s_add_u32 s66, s58, s98
    v_mfma_f32_16x16x32_bf16 v[88:91], v[212:215], v[172:175], v[88:91]
    ds_read_b64_tr_b16 v[8:9], v230 offset:53248
    s_add_u32 s66, s66, 73728
    v_mfma_f32_16x16x32_bf16 v[92:95], v[212:215], v[164:167], v[92:95]
    ds_read_b64_tr_b16 v[10:11], v230 offset:53760
    buffer_load_dwordx4 v112, s[20:23], s66 offen offset:0 lds
    v_mfma_f32_16x16x32_bf16 v[80:83], v[200:203], v[196:199], v[80:83]
    ds_read_b64_tr_b16 v[12:13], v231 offset:53248
    v_mfma_f32_16x16x32_bf16 v[84:87], v[200:203], v[188:191], v[84:87]
    ds_read_b64_tr_b16 v[14:15], v231 offset:53760
    v_mfma_f32_16x16x32_bf16 v[88:91], v[200:203], v[180:183], v[88:91]
    ds_read_b64_tr_b16 v[16:17], v228 offset:54272
    buffer_load_dwordx4 v113, s[20:23], s66 offen offset:1024 lds
    v_mfma_f32_16x16x32_bf16 v[92:95], v[200:203], v[172:175], v[92:95]
    ds_write_b128 v249, v[64:67] offset:0
    v_mfma_f32_16x16x32_bf16 v[80:83], v[192:195], v[208:211], v[80:83]
    ds_read_b64_tr_b16 v[18:19], v228 offset:54784
    v_mfma_f32_16x16x32_bf16 v[84:87], v[192:195], v[196:199], v[84:87]
    ds_read_b64_tr_b16 v[20:21], v229 offset:54272
    buffer_load_dwordx4 v114, s[20:23], s66 offen offset:2048 lds
    v_mfma_f32_16x16x32_bf16 v[88:91], v[192:195], v[188:191], v[88:91]
    ds_read_b64_tr_b16 v[22:23], v229 offset:54784
    v_mfma_f32_16x16x32_bf16 v[92:95], v[192:195], v[180:183], v[92:95]
    ds_write_b128 v249, v[68:71] offset:1024
    v_mfma_f32_16x16x32_bf16 v[64:67], v[184:187], v[216:219], v[80:83]
    ds_read_b64_tr_b16 v[24:25], v230 offset:54272
    v_mfma_f32_16x16x32_bf16 v[84:87], v[184:187], v[208:211], v[84:87]
    ds_read_b64_tr_b16 v[26:27], v230 offset:54784
    buffer_load_dwordx4 v115, s[20:23], s66 offen offset:3072 lds
    v_mfma_f32_16x16x32_bf16 v[88:91], v[184:187], v[196:199], v[88:91]
    ds_write_b128 v249, v[72:75] offset:2048
    v_mfma_f32_16x16x32_bf16 v[92:95], v[184:187], v[188:191], v[92:95]
    ds_read_b64_tr_b16 v[28:29], v231 offset:54272
    s_add_u32 m0, s1, 32768
    v_mfma_f32_16x16x32_bf16 v[68:71], v[176:179], v[216:219], v[84:87]
    ds_write_b128 v249, v[76:79] offset:3072
    s_add_u32 s66, s59, s98
    v_mfma_f32_16x16x32_bf16 v[88:91], v[176:179], v[208:211], v[88:91]
    ds_read_b64_tr_b16 v[30:31], v231 offset:54784
    s_add_u32 s66, s66, 73728
    v_mfma_f32_16x16x32_bf16 v[92:95], v[176:179], v[196:199], v[92:95]
    buffer_load_dwordx4 v112, s[20:23], s66 offen offset:0 lds
    v_mfma_f32_16x16x32_bf16 v[72:75], v[168:171], v[216:219], v[88:91]
    v_mfma_f32_16x16x32_bf16 v[92:95], v[168:171], v[208:211], v[92:95]
    buffer_load_dwordx4 v113, s[20:23], s66 offen offset:1024 lds
    v_mfma_f32_16x16x32_bf16 v[76:79], v[160:163], v[216:219], v[92:95]
gated_mix__ssm_conv_s4__glu_gated_bilinear__prompt_kernel_r3e:
    s_waitcnt lgkmcnt(3)
    v_mfma_f32_16x16x32_bf16 v[160:163], v[0:3], a[8:11], 0
    ds_read_b64_tr_b16 v[32:33], v232 offset:0
    v_mfma_f32_16x16x32_bf16 v[164:167], v[0:3], a[12:15], 0
    ds_read_b64_tr_b16 v[34:35], v232 offset:512
    v_mfma_f32_16x16x32_bf16 v[168:171], v[4:7], a[8:11], 0
    ds_read_b64_tr_b16 v[36:37], v233 offset:0
    buffer_load_dwordx4 v114, s[20:23], s66 offen offset:2048 lds
    v_mfma_f32_16x16x32_bf16 v[172:175], v[4:7], a[12:15], 0
    ds_read_b64_tr_b16 v[38:39], v233 offset:512
    v_mfma_f32_16x16x32_bf16 v[176:179], v[8:11], a[8:11], 0
    ds_read_b64_tr_b16 v[40:41], v234 offset:0
    v_mfma_f32_16x16x32_bf16 v[180:183], v[8:11], a[12:15], 0
    ds_read_b64_tr_b16 v[42:43], v234 offset:512
    buffer_load_dwordx4 v115, s[20:23], s66 offen offset:3072 lds
    v_mfma_f32_16x16x32_bf16 v[184:187], v[12:15], a[8:11], 0
    ds_read_b64_tr_b16 v[44:45], v235 offset:0
    v_mfma_f32_16x16x32_bf16 v[188:191], v[12:15], a[12:15], 0
    ds_read_b64_tr_b16 v[46:47], v235 offset:512
    s_add_u32 m0, s1, 49152
    s_waitcnt lgkmcnt(7)
    v_mfma_f32_16x16x32_bf16 v[160:163], v[16:19], a[24:27], v[160:163]
    ds_read_b64_tr_b16 v[0:1], v232 offset:1024
    v_mfma_f32_16x16x32_bf16 v[164:167], v[16:19], a[28:31], v[164:167]
    ds_read_b64_tr_b16 v[2:3], v232 offset:1536
    s_add_u32 s66, s0, s98
    v_mfma_f32_16x16x32_bf16 v[168:171], v[20:23], a[24:27], v[168:171]
    ds_read_b64_tr_b16 v[4:5], v233 offset:1024
    s_add_u32 s66, s66, 73728
    v_mfma_f32_16x16x32_bf16 v[172:175], v[20:23], a[28:31], v[172:175]
    ds_read_b64_tr_b16 v[6:7], v233 offset:1536
    buffer_load_dwordx4 v112, s[20:23], s66 offen offset:0 lds
    v_mfma_f32_16x16x32_bf16 v[176:179], v[24:27], a[24:27], v[176:179]
    ds_read_b64_tr_b16 v[8:9], v234 offset:1024
    v_mfma_f32_16x16x32_bf16 v[180:183], v[24:27], a[28:31], v[180:183]
    ds_read_b64_tr_b16 v[10:11], v234 offset:1536
    buffer_load_dwordx4 v113, s[20:23], s66 offen offset:1024 lds
    v_mfma_f32_16x16x32_bf16 v[184:187], v[28:31], a[24:27], v[184:187]
    ds_read_b64_tr_b16 v[12:13], v235 offset:1024
    v_mfma_f32_16x16x32_bf16 v[188:191], v[28:31], a[28:31], v[188:191]
    ds_read_b64_tr_b16 v[14:15], v235 offset:1536
    s_waitcnt lgkmcnt(7)
    v_mfma_f32_16x16x32_bf16 v[160:163], v[32:35], a[40:43], v[160:163]
    ds_read_b64_tr_b16 v[16:17], v232 offset:8192
    v_mfma_f32_16x16x32_bf16 v[164:167], v[32:35], a[44:47], v[164:167]
    ds_read_b64_tr_b16 v[18:19], v232 offset:8704
    buffer_load_dwordx4 v114, s[20:23], s66 offen offset:2048 lds
    v_mfma_f32_16x16x32_bf16 v[168:171], v[36:39], a[40:43], v[168:171]
    ds_read_b64_tr_b16 v[20:21], v233 offset:8192
    v_mfma_f32_16x16x32_bf16 v[172:175], v[36:39], a[44:47], v[172:175]
    ds_read_b64_tr_b16 v[22:23], v233 offset:8704
    v_mfma_f32_16x16x32_bf16 v[176:179], v[40:43], a[40:43], v[176:179]
    ds_read_b64_tr_b16 v[24:25], v234 offset:8192
    buffer_load_dwordx4 v115, s[20:23], s66 offen offset:3072 lds
    v_mfma_f32_16x16x32_bf16 v[180:183], v[40:43], a[44:47], v[180:183]
    ds_read_b64_tr_b16 v[26:27], v234 offset:8704
    v_mfma_f32_16x16x32_bf16 v[184:187], v[44:47], a[40:43], v[184:187]
    ds_read_b64_tr_b16 v[28:29], v235 offset:8192
    s_add_u32 s66, s33, 917504
    v_mfma_f32_16x16x32_bf16 v[188:191], v[44:47], a[44:47], v[188:191]
    ds_read_b64_tr_b16 v[30:31], v235 offset:8704
    s_waitcnt lgkmcnt(7)
    v_mfma_f32_16x16x32_bf16 v[160:163], v[0:3], a[56:59], v[160:163]
    ds_read_b64_tr_b16 v[32:33], v232 offset:9216
    v_mfma_f32_16x16x32_bf16 v[164:167], v[0:3], a[60:63], v[164:167]
    ds_read_b64_tr_b16 v[34:35], v232 offset:9728
    buffer_load_dwordx4 a[112:115], v250, s[36:39], s66 offen sc1
    v_mfma_f32_16x16x32_bf16 v[168:171], v[4:7], a[56:59], v[168:171]
    ds_read_b64_tr_b16 v[36:37], v233 offset:9216
    v_mfma_f32_16x16x32_bf16 v[172:175], v[4:7], a[60:63], v[172:175]
    ds_read_b64_tr_b16 v[38:39], v233 offset:9728
    v_mfma_f32_16x16x32_bf16 v[176:179], v[8:11], a[56:59], v[176:179]
    ds_read_b64_tr_b16 v[40:41], v234 offset:9216
    buffer_load_dwordx4 a[116:119], v250, s[36:39], s66 offen offset:1024 sc1
    v_mfma_f32_16x16x32_bf16 v[180:183], v[8:11], a[60:63], v[180:183]
    ds_read_b64_tr_b16 v[42:43], v234 offset:9728
    v_mfma_f32_16x16x32_bf16 v[184:187], v[12:15], a[56:59], v[184:187]
    ds_read_b64_tr_b16 v[44:45], v235 offset:9216
    s_add_u32 s66, s54, 262144
    v_mfma_f32_16x16x32_bf16 v[188:191], v[12:15], a[60:63], v[188:191]
    ds_read_b64_tr_b16 v[46:47], v235 offset:9728
    s_waitcnt lgkmcnt(7)
    v_mfma_f32_16x16x32_bf16 v[160:163], v[16:19], a[72:75], v[160:163]
    ds_read_b64_tr_b16 v[0:1], v232 offset:16384
    v_mfma_f32_16x16x32_bf16 v[164:167], v[16:19], a[76:79], v[164:167]
    ds_read_b64_tr_b16 v[2:3], v232 offset:16896
    buffer_load_dwordx4 a[128:131], v250, s[36:39], s66 offen sc1
    v_mfma_f32_16x16x32_bf16 v[168:171], v[20:23], a[72:75], v[168:171]
    ds_read_b64_tr_b16 v[4:5], v233 offset:16384
    v_mfma_f32_16x16x32_bf16 v[172:175], v[20:23], a[76:79], v[172:175]
    ds_read_b64_tr_b16 v[6:7], v233 offset:16896
    v_mfma_f32_16x16x32_bf16 v[176:179], v[24:27], a[72:75], v[176:179]
    ds_read_b64_tr_b16 v[8:9], v234 offset:16384
    buffer_load_dwordx4 a[132:135], v250, s[36:39], s66 offen offset:1024 sc1
    v_mfma_f32_16x16x32_bf16 v[180:183], v[24:27], a[76:79], v[180:183]
    ds_read_b64_tr_b16 v[10:11], v234 offset:16896
    v_mfma_f32_16x16x32_bf16 v[184:187], v[28:31], a[72:75], v[184:187]
    ds_read_b64_tr_b16 v[12:13], v235 offset:16384
    s_add_u32 s66, s54, 393216
    v_mfma_f32_16x16x32_bf16 v[188:191], v[28:31], a[76:79], v[188:191]
    ds_read_b64_tr_b16 v[14:15], v235 offset:16896
    s_waitcnt lgkmcnt(7)
    v_mfma_f32_16x16x32_bf16 v[160:163], v[32:35], a[88:91], v[160:163]
    ds_read_b64_tr_b16 v[16:17], v232 offset:17408
    v_mfma_f32_16x16x32_bf16 v[164:167], v[32:35], a[92:95], v[164:167]
    ds_read_b64_tr_b16 v[18:19], v232 offset:17920
    buffer_load_dwordx4 a[144:147], v250, s[36:39], s66 offen sc1
    v_mfma_f32_16x16x32_bf16 v[168:171], v[36:39], a[88:91], v[168:171]
    ds_read_b64_tr_b16 v[20:21], v233 offset:17408
    v_mfma_f32_16x16x32_bf16 v[172:175], v[36:39], a[92:95], v[172:175]
    ds_read_b64_tr_b16 v[22:23], v233 offset:17920
    v_mfma_f32_16x16x32_bf16 v[176:179], v[40:43], a[88:91], v[176:179]
    ds_read_b64_tr_b16 v[24:25], v234 offset:17408
    buffer_load_dwordx4 a[148:151], v250, s[36:39], s66 offen offset:1024 sc1
    v_mfma_f32_16x16x32_bf16 v[180:183], v[40:43], a[92:95], v[180:183]
    ds_read_b64_tr_b16 v[26:27], v234 offset:17920
    v_mfma_f32_16x16x32_bf16 v[184:187], v[44:47], a[88:91], v[184:187]
    ds_read_b64_tr_b16 v[28:29], v235 offset:17408
    s_add_u32 s66, s54, 786432
    v_mfma_f32_16x16x32_bf16 v[188:191], v[44:47], a[92:95], v[188:191]
    ds_read_b64_tr_b16 v[30:31], v235 offset:17920
    s_waitcnt lgkmcnt(7)
    v_mfma_f32_16x16x32_bf16 v[160:163], v[0:3], a[104:107], v[160:163]
    s_waitcnt vmcnt(37)
    s_barrier
    v_mfma_f32_16x16x32_bf16 v[164:167], v[0:3], a[108:111], v[164:167]
    ds_read_b64_tr_b16 v[32:33], v232 offset:24576
    buffer_load_dwordx4 a[160:163], v250, s[36:39], s66 offen sc1
    v_mfma_f32_16x16x32_bf16 v[168:171], v[4:7], a[104:107], v[168:171]
    ds_read_b64_tr_b16 v[34:35], v232 offset:25088
    ds_read_b128 v[124:127], v251 offset:0
    v_mfma_f32_16x16x32_bf16 v[172:175], v[4:7], a[108:111], v[172:175]
    ds_read_b64_tr_b16 v[36:37], v233 offset:24576
    ds_read_b128 v[192:195], v251 offset:1024
    v_mfma_f32_16x16x32_bf16 v[176:179], v[8:11], a[104:107], v[176:179]
    ds_read_b64_tr_b16 v[38:39], v233 offset:25088
    buffer_load_dwordx4 a[164:167], v250, s[36:39], s66 offen offset:1024 sc1
    v_mfma_f32_16x16x32_bf16 v[180:183], v[8:11], a[108:111], v[180:183]
    ds_read_b64_tr_b16 v[40:41], v234 offset:24576
    ds_read_b128 v[196:199], v251 offset:2048
    v_mfma_f32_16x16x32_bf16 v[184:187], v[12:15], a[104:107], v[184:187]
    ds_read_b64_tr_b16 v[42:43], v234 offset:25088
    s_add_u32 s66, s54, 917504
    v_mfma_f32_16x16x32_bf16 v[188:191], v[12:15], a[108:111], v[188:191]
    ds_read_b64_tr_b16 v[44:45], v235 offset:24576
    ds_read_b64_tr_b16 v[46:47], v235 offset:25088
    s_waitcnt lgkmcnt(11)
    v_mfma_f32_16x16x32_bf16 v[160:163], v[16:19], a[120:123], v[160:163]
    ds_read_b64_tr_b16 v[0:1], v232 offset:25600
    v_mfma_f32_16x16x32_bf16 v[164:167], v[16:19], a[124:127], v[164:167]
    ds_read_b64_tr_b16 v[2:3], v232 offset:26112
    buffer_load_dwordx4 a[176:179], v250, s[36:39], s66 offen sc1
    v_mfma_f32_16x16x32_bf16 v[168:171], v[20:23], a[120:123], v[168:171]
    ds_read_b64_tr_b16 v[4:5], v233 offset:25600
    ds_read_b128 v[200:203], v251 offset:3072
    v_mfma_f32_16x16x32_bf16 v[172:175], v[20:23], a[124:127], v[172:175]
    ds_read_b64_tr_b16 v[6:7], v233 offset:26112
    ds_read_b64 v[80:81], v254 offset:0
    v_mfma_f32_16x16x32_bf16 v[176:179], v[24:27], a[120:123], v[176:179]
    ds_read_b64_tr_b16 v[8:9], v234 offset:25600
    buffer_load_dwordx4 a[180:183], v250, s[36:39], s66 offen offset:1024 sc1
    v_mfma_f32_16x16x32_bf16 v[180:183], v[24:27], a[124:127], v[180:183]
    ds_read_b64_tr_b16 v[10:11], v234 offset:26112
    ds_read_b64 v[82:83], v254 offset:6144
    v_mfma_f32_16x16x32_bf16 v[184:187], v[28:31], a[120:123], v[184:187]
    ds_read_b64_tr_b16 v[12:13], v235 offset:25600
    s_add_u32 s66, s55, 262144
    v_mfma_f32_16x16x32_bf16 v[188:191], v[28:31], a[124:127], v[188:191]
    ds_read_b64_tr_b16 v[14:15], v235 offset:26112
    ds_read_b64 v[84:85], v254 offset:12288
    s_waitcnt lgkmcnt(11)
    v_mfma_f32_16x16x32_bf16 v[160:163], v[32:35], a[136:139], v[160:163]
    ds_read_b64_tr_b16 v[16:17], v232 offset:32768
    v_mfma_f32_16x16x32_bf16 v[164:167], v[32:35], a[140:143], v[164:167]
    ds_read_b64_tr_b16 v[18:19], v232 offset:33280
    buffer_load_dwordx4 a[192:195], v250, s[36:39], s66 offen sc1
    v_mfma_f32_16x16x32_bf16 v[168:171], v[36:39], a[136:139], v[168:171]
    ds_read_b64_tr_b16 v[20:21], v233 offset:32768
    ds_read_b64 v[86:87], v254 offset:18432
    v_mfma_f32_16x16x32_bf16 v[172:175], v[36:39], a[140:143], v[172:175]
    ds_read_b64_tr_b16 v[22:23], v233 offset:33280
    v_mfma_f32_16x16x32_bf16 v[176:179], v[40:43], a[136:139], v[176:179]
    ds_read_b64_tr_b16 v[24:25], v234 offset:32768
    buffer_load_dwordx4 a[196:199], v250, s[36:39], s66 offen offset:1024 sc1
    v_mfma_f32_16x16x32_bf16 v[180:183], v[40:43], a[140:143], v[180:183]
    ds_read_b64_tr_b16 v[26:27], v234 offset:33280
    v_mfma_f32_16x16x32_bf16 v[184:187], v[44:47], a[136:139], v[184:187]
    ds_read_b64_tr_b16 v[28:29], v235 offset:32768
    s_add_u32 s66, s55, 393216
    v_mfma_f32_16x16x32_bf16 v[188:191], v[44:47], a[140:143], v[188:191]
    ds_read_b64_tr_b16 v[30:31], v235 offset:33280
    s_waitcnt lgkmcnt(8)
    v_mfma_f32_16x16x32_bf16 v[160:163], v[0:3], a[152:155], v[160:163]
    ds_read_b64_tr_b16 v[32:33], v232 offset:33792
    v_mfma_f32_16x16x32_bf16 v[164:167], v[0:3], a[156:159], v[164:167]
    ds_read_b64_tr_b16 v[34:35], v232 offset:34304
    buffer_load_dwordx4 a[208:211], v250, s[36:39], s66 offen sc1
    v_mfma_f32_16x16x32_bf16 v[168:171], v[4:7], a[152:155], v[168:171]
    ds_read_b64_tr_b16 v[36:37], v233 offset:33792
    v_pk_add_f32 v[64:65], v[64:65], v[124:125]
    v_mfma_f32_16x16x32_bf16 v[172:175], v[4:7], a[156:159], v[172:175]
    ds_read_b64_tr_b16 v[38:39], v233 offset:34304
    v_pk_add_f32 v[66:67], v[66:67], v[126:127]
    v_mfma_f32_16x16x32_bf16 v[176:179], v[8:11], a[152:155], v[176:179]
    ds_read_b64_tr_b16 v[40:41], v234 offset:33792
    v_cvt_pk_bf16_f32 v64, 0, v64
    v_mfma_f32_16x16x32_bf16 v[180:183], v[8:11], a[156:159], v[180:183]
    ds_read_b64_tr_b16 v[42:43], v234 offset:34304
    buffer_load_dwordx4 a[212:215], v250, s[36:39], s66 offen offset:1024 sc1
    v_mfma_f32_16x16x32_bf16 v[184:187], v[12:15], a[152:155], v[184:187]
    ds_read_b64_tr_b16 v[44:45], v235 offset:33792
    v_cvt_pk_bf16_f32 v65, 0, v65
    v_mfma_f32_16x16x32_bf16 v[188:191], v[12:15], a[156:159], v[188:191]
    ds_read_b64_tr_b16 v[46:47], v235 offset:34304
    s_add_u32 s66, s55, 786432
    s_waitcnt lgkmcnt(7)
    v_mfma_f32_16x16x32_bf16 v[160:163], v[16:19], a[168:171], v[160:163]
    ds_read_b64_tr_b16 v[0:1], v228 offset:4096
    v_mfma_f32_16x16x32_bf16 v[164:167], v[16:19], a[172:175], v[164:167]
    ds_read_b64_tr_b16 v[2:3], v228 offset:4608
    buffer_load_dwordx4 a[224:227], v250, s[36:39], s66 offen sc1
    v_mfma_f32_16x16x32_bf16 v[168:171], v[20:23], a[168:171], v[168:171]
    ds_read_b64_tr_b16 v[4:5], v229 offset:4096
    v_cvt_pk_bf16_f32 v66, 0, v66
    v_mfma_f32_16x16x32_bf16 v[172:175], v[20:23], a[172:175], v[172:175]
    ds_read_b64_tr_b16 v[6:7], v229 offset:4608
    v_cvt_pk_bf16_f32 v67, 0, v67
    v_mfma_f32_16x16x32_bf16 v[176:179], v[24:27], a[168:171], v[176:179]
    ds_read_b64_tr_b16 v[8:9], v230 offset:4096
    v_pk_add_f32 v[64:65], v[64:65], v[104:105]
    v_mfma_f32_16x16x32_bf16 v[180:183], v[24:27], a[172:175], v[180:183]
    ds_read_b64_tr_b16 v[10:11], v230 offset:4608
    buffer_load_dwordx4 a[228:231], v250, s[36:39], s66 offen offset:1024 sc1
    v_mfma_f32_16x16x32_bf16 v[184:187], v[28:31], a[168:171], v[184:187]
    ds_read_b64_tr_b16 v[12:13], v231 offset:4096
    v_pk_add_f32 v[66:67], v[66:67], v[106:107]
    v_mfma_f32_16x16x32_bf16 v[188:191], v[28:31], a[172:175], v[188:191]
    ds_read_b64_tr_b16 v[14:15], v231 offset:4608
    s_add_u32 s66, s55, 917504
    s_waitcnt lgkmcnt(7)
    v_mfma_f32_16x16x32_bf16 v[160:163], v[32:35], a[184:187], v[160:163]
    ds_read_b64_tr_b16 v[16:17], v228 offset:5120
    v_mfma_f32_16x16x32_bf16 v[164:167], v[32:35], a[188:191], v[164:167]
    ds_read_b64_tr_b16 v[18:19], v228 offset:5632
    buffer_load_dwordx4 a[240:243], v250, s[36:39], s66 offen sc1
    v_mfma_f32_16x16x32_bf16 v[168:171], v[36:39], a[184:187], v[168:171]
    ds_read_b64_tr_b16 v[20:21], v229 offset:5120
    v_cvt_pk_bf16_f32 v124, v64, v65
    v_mfma_f32_16x16x32_bf16 v[172:175], v[36:39], a[188:191], v[172:175]
    ds_read_b64_tr_b16 v[22:23], v229 offset:5632
    v_cvt_pk_bf16_f32 v125, v66, v67
    v_mfma_f32_16x16x32_bf16 v[176:179], v[40:43], a[184:187], v[176:179]
    ds_read_b64_tr_b16 v[24:25], v230 offset:5120
    v_pk_add_f32 v[68:69], v[68:69], v[192:193]
    v_mfma_f32_16x16x32_bf16 v[180:183], v[40:43], a[188:191], v[180:183]
    ds_read_b64_tr_b16 v[26:27], v230 offset:5632
    buffer_load_dwordx4 a[244:247], v250, s[36:39], s66 offen offset:1024 sc1
    v_mfma_f32_16x16x32_bf16 v[184:187], v[44:47], a[184:187], v[184:187]
    ds_read_b64_tr_b16 v[28:29], v231 offset:5120
    v_pk_add_f32 v[70:71], v[70:71], v[194:195]
    v_mfma_f32_16x16x32_bf16 v[188:191], v[44:47], a[188:191], v[188:191]
    ds_read_b64_tr_b16 v[30:31], v231 offset:5632
    s_add_u32 m0, s1, 114688
    s_waitcnt lgkmcnt(7)
    v_mfma_f32_16x16x32_bf16 v[160:163], v[0:3], a[200:203], v[160:163]
    ds_read_b64_tr_b16 v[32:33], v228 offset:12288
    v_mfma_f32_16x16x32_bf16 v[164:167], v[0:3], a[204:207], v[164:167]
    ds_read_b64_tr_b16 v[34:35], v228 offset:12800
    s_add_u32 m0, m0, s95
    v_mfma_f32_16x16x32_bf16 v[168:171], v[4:7], a[200:203], v[168:171]
    ds_read_b64_tr_b16 v[36:37], v229 offset:12288
    s_add_u32 s66, s97, s98
    v_mfma_f32_16x16x32_bf16 v[172:175], v[4:7], a[204:207], v[172:175]
    ds_read_b64_tr_b16 v[38:39], v229 offset:12800
    buffer_load_dwordx4 v112, s[20:23], s66 offen offset:0 lds
    v_mfma_f32_16x16x32_bf16 v[176:179], v[8:11], a[200:203], v[176:179]
    ds_read_b64_tr_b16 v[40:41], v230 offset:12288
    v_cvt_pk_bf16_f32 v68, 0, v68
    v_mfma_f32_16x16x32_bf16 v[180:183], v[8:11], a[204:207], v[180:183]
    ds_read_b64_tr_b16 v[42:43], v230 offset:12800
    buffer_load_dwordx4 v114, s[20:23], s66 offen offset:2048 lds
    v_mfma_f32_16x16x32_bf16 v[184:187], v[12:15], a[200:203], v[184:187]
    ds_read_b64_tr_b16 v[44:45], v231 offset:12288
    v_cvt_pk_bf16_f32 v69, 0, v69
    v_mfma_f32_16x16x32_bf16 v[188:191], v[12:15], a[204:207], v[188:191]
    ds_read_b64_tr_b16 v[46:47], v231 offset:12800
    s_sub_u32 m0, m0, s95
    s_waitcnt lgkmcnt(7)
    v_mfma_f32_16x16x32_bf16 v[160:163], v[16:19], a[216:219], v[160:163]
    ds_read_b64_tr_b16 v[0:1], v228 offset:13312
    v_mfma_f32_16x16x32_bf16 v[164:167], v[16:19], a[220:223], v[164:167]
    ds_read_b64_tr_b16 v[2:3], v228 offset:13824
    s_sub_u32 m0, m0, s95
    v_mfma_f32_16x16x32_bf16 v[168:171], v[20:23], a[216:219], v[168:171]
    ds_read_b64_tr_b16 v[4:5], v229 offset:13312
    s_nop 0
    v_mfma_f32_16x16x32_bf16 v[172:175], v[20:23], a[220:223], v[172:175]
    ds_read_b64_tr_b16 v[6:7], v229 offset:13824
    buffer_load_dwordx4 v113, s[20:23], s66 offen offset:1024 lds
    v_mfma_f32_16x16x32_bf16 v[176:179], v[24:27], a[216:219], v[176:179]
    ds_read_b64_tr_b16 v[8:9], v230 offset:13312
    v_cvt_pk_bf16_f32 v70, 0, v70
    v_mfma_f32_16x16x32_bf16 v[180:183], v[24:27], a[220:223], v[180:183]
    ds_read_b64_tr_b16 v[10:11], v230 offset:13824
    buffer_load_dwordx4 v115, s[20:23], s66 offen offset:3072 lds
    v_mfma_f32_16x16x32_bf16 v[184:187], v[28:31], a[216:219], v[184:187]
    ds_read_b64_tr_b16 v[12:13], v231 offset:13312
    v_cvt_pk_bf16_f32 v71, 0, v71
    v_mfma_f32_16x16x32_bf16 v[188:191], v[28:31], a[220:223], v[188:191]
    ds_read_b64_tr_b16 v[14:15], v231 offset:13824
    v_pk_add_f32 v[68:69], v[68:69], v[108:109]
    s_waitcnt lgkmcnt(7)
    v_mfma_f32_16x16x32_bf16 v[160:163], v[32:35], a[232:235], v[160:163]
    s_waitcnt vmcnt(30)
    s_barrier
    v_mfma_f32_16x16x32_bf16 v[164:167], v[32:35], a[236:239], v[164:167]
    ds_read_b64_tr_b16 v[16:17], v224 offset:0
    s_add_u32 m0, s1, 81920
    v_mfma_f32_16x16x32_bf16 v[168:171], v[36:39], a[232:235], v[168:171]
    ds_read_b64_tr_b16 v[18:19], v224 offset:512
    s_add_u32 s66, s29, s98
    v_mfma_f32_16x16x32_bf16 v[172:175], v[36:39], a[236:239], v[172:175]
    ds_read_b64_tr_b16 v[20:21], v225 offset:0
    s_add_u32 s66, s66, 73728
    v_mfma_f32_16x16x32_bf16 v[176:179], v[40:43], a[232:235], v[176:179]
    ds_read_b64_tr_b16 v[22:23], v225 offset:512
    buffer_load_dwordx4 v112, s[20:23], s66 offen offset:0 lds
    v_mfma_f32_16x16x32_bf16 v[180:183], v[40:43], a[236:239], v[180:183]
    ds_read_b64_tr_b16 v[24:25], v226 offset:0
    v_pk_add_f32 v[70:71], v[70:71], v[110:111]
    v_mfma_f32_16x16x32_bf16 v[184:187], v[44:47], a[232:235], v[184:187]
    ds_read_b64_tr_b16 v[26:27], v226 offset:512
    buffer_load_dwordx4 v113, s[20:23], s66 offen offset:1024 lds
    v_mfma_f32_16x16x32_bf16 v[188:191], v[44:47], a[236:239], v[188:191]
    ds_read_b64_tr_b16 v[28:29], v227 offset:0
    ds_read_b64_tr_b16 v[30:31], v227 offset:512
    s_waitcnt lgkmcnt(8)
    v_mfma_f32_16x16x32_bf16 v[160:163], v[0:3], a[248:251], v[160:163]
    ds_read_b64_tr_b16 v[32:33], v224 offset:1024
    v_mfma_f32_16x16x32_bf16 v[164:167], v[0:3], a[252:255], v[164:167]
    ds_read_b64_tr_b16 v[34:35], v224 offset:1536
    v_cvt_pk_bf16_f32 v126, v68, v69
    v_mfma_f32_16x16x32_bf16 v[168:171], v[4:7], a[248:251], v[168:171]
    ds_read_b64_tr_b16 v[36:37], v225 offset:1024
    buffer_load_dwordx4 v114, s[20:23], s66 offen offset:2048 lds
    v_mfma_f32_16x16x32_bf16 v[172:175], v[4:7], a[252:255], v[172:175]
    ds_read_b64_tr_b16 v[38:39], v225 offset:1536
    v_cvt_pk_bf16_f32 v127, v70, v71
    v_mfma_f32_16x16x32_bf16 v[176:179], v[8:11], a[248:251], v[176:179]
    ds_read_b64_tr_b16 v[40:41], v226 offset:1024
    v_mfma_f32_16x16x32_bf16 v[180:183], v[8:11], a[252:255], v[180:183]
    ds_read_b64_tr_b16 v[42:43], v226 offset:1536
    buffer_load_dwordx4 v115, s[20:23], s66 offen offset:3072 lds
    v_mfma_f32_16x16x32_bf16 v[184:187], v[12:15], a[248:251], v[184:187]
    ds_read_b64_tr_b16 v[44:45], v227 offset:1024
    v_permlane16_swap_b32 v124, v126
    v_mfma_f32_16x16x32_bf16 v[188:191], v[12:15], a[252:255], v[188:191]
    ds_read_b64_tr_b16 v[46:47], v227 offset:1536
    s_add_u32 m0, s1, 98304
    s_waitcnt lgkmcnt(7)
    v_mfma_f32_16x16x32_bf16 v[208:211], v[16:19], a[8:11], 0
    ds_read_b64_tr_b16 v[0:1], v224 offset:8192
    v_mfma_f32_16x16x32_bf16 v[212:215], v[16:19], a[12:15], 0
    ds_read_b64_tr_b16 v[2:3], v224 offset:8704
    s_add_u32 s66, s58, 74752
    v_mfma_f32_16x16x32_bf16 v[216:219], v[20:23], a[8:11], 0
    ds_read_b64_tr_b16 v[4:5], v225 offset:8192
    buffer_load_dwordx4 v112, s[20:23], s66 offen offset:0 lds
    v_mfma_f32_16x16x32_bf16 v[220:223], v[20:23], a[12:15], 0
    ds_read_b64_tr_b16 v[6:7], v225 offset:8704
    v_permlane16_swap_b32 v125, v127
    v_mfma_f32_16x16x32_bf16 v[48:51], v[24:27], a[8:11], 0
    ds_read_b64_tr_b16 v[8:9], v226 offset:8192
    buffer_load_dwordx4 v113, s[20:23], s66 offen offset:1024 lds
    v_mfma_f32_16x16x32_bf16 v[52:55], v[24:27], a[12:15], 0
    ds_read_b64_tr_b16 v[10:11], v226 offset:8704
    buffer_store_dwordx4 v[124:127], v255, s[36:39], s28 offen offset:0 sc1
    v_mfma_f32_16x16x32_bf16 v[56:59], v[28:31], a[8:11], 0
    ds_read_b64_tr_b16 v[12:13], v227 offset:8192
    v_pk_add_f32 v[72:73], v[72:73], v[196:197]
    v_mfma_f32_16x16x32_bf16 v[60:63], v[28:31], a[12:15], 0
    ds_read_b64_tr_b16 v[14:15], v227 offset:8704
    v_pk_add_f32 v[74:75], v[74:75], v[198:199]
    s_waitcnt lgkmcnt(7)
    v_mfma_f32_16x16x32_bf16 v[208:211], v[32:35], a[24:27], v[208:211]
    ds_read_b64_tr_b16 v[16:17], v224 offset:9216
    v_mfma_f32_16x16x32_bf16 v[212:215], v[32:35], a[28:31], v[212:215]
    ds_read_b64_tr_b16 v[18:19], v224 offset:9728
    v_cvt_pk_bf16_f32 v72, 0, v72
    v_mfma_f32_16x16x32_bf16 v[216:219], v[36:39], a[24:27], v[216:219]
    ds_read_b64_tr_b16 v[20:21], v225 offset:9216
    v_cvt_pk_bf16_f32 v73, 0, v73
    v_mfma_f32_16x16x32_bf16 v[220:223], v[36:39], a[28:31], v[220:223]
    ds_read_b64_tr_b16 v[22:23], v225 offset:9728
    v_cvt_pk_bf16_f32 v74, 0, v74
    v_mfma_f32_16x16x32_bf16 v[48:51], v[40:43], a[24:27], v[48:51]
    ds_read_b64_tr_b16 v[24:25], v226 offset:9216
    v_cvt_pk_bf16_f32 v75, 0, v75
    v_mfma_f32_16x16x32_bf16 v[52:55], v[40:43], a[28:31], v[52:55]
    ds_read_b64_tr_b16 v[26:27], v226 offset:9728
    buffer_load_dwordx4 v114, s[20:23], s66 offen offset:2048 lds
    v_mfma_f32_16x16x32_bf16 v[56:59], v[44:47], a[24:27], v[56:59]
    ds_read_b64_tr_b16 v[28:29], v227 offset:9216
    v_pk_add_f32 v[72:73], v[72:73], v[116:117]
    v_mfma_f32_16x16x32_bf16 v[60:63], v[44:47], a[28:31], v[60:63]
    ds_read_b64_tr_b16 v[30:31], v227 offset:9728
    v_pk_add_f32 v[74:75], v[74:75], v[118:119]
    s_waitcnt lgkmcnt(7)
    v_mfma_f32_16x16x32_bf16 v[208:211], v[0:3], a[40:43], v[208:211]
    ds_read_b64_tr_b16 v[32:33], v224 offset:16384
    v_mfma_f32_16x16x32_bf16 v[212:215], v[0:3], a[44:47], v[212:215]
    ds_read_b64_tr_b16 v[34:35], v224 offset:16896
    buffer_load_dwordx4 v115, s[20:23], s66 offen offset:3072 lds
    v_mfma_f32_16x16x32_bf16 v[216:219], v[4:7], a[40:43], v[216:219]
    ds_read_b64_tr_b16 v[36:37], v225 offset:16384
    v_cvt_pk_bf16_f32 v196, v72, v73
    v_mfma_f32_16x16x32_bf16 v[220:223], v[4:7], a[44:47], v[220:223]
    ds_read_b64_tr_b16 v[38:39], v225 offset:16896
    v_cvt_pk_bf16_f32 v197, v74, v75
    v_mfma_f32_16x16x32_bf16 v[48:51], v[8:11], a[40:43], v[48:51]
    ds_read_b64_tr_b16 v[40:41], v226 offset:16384
    v_pk_add_f32 v[76:77], v[76:77], v[200:201]
    v_mfma_f32_16x16x32_bf16 v[52:55], v[8:11], a[44:47], v[52:55]
    ds_read_b64_tr_b16 v[42:43], v226 offset:16896
    buffer_load_dword v207, v253, s[36:39], s48 offen sc1
    v_mfma_f32_16x16x32_bf16 v[56:59], v[12:15], a[40:43], v[56:59]
    ds_read_b64_tr_b16 v[44:45], v227 offset:16384
    s_and_b32 m0, s1, 4096
    v_mfma_f32_16x16x32_bf16 v[60:63], v[12:15], a[44:47], v[60:63]
    ds_read_b64_tr_b16 v[46:47], v227 offset:16896
    s_add_u32 m0, m0, 131072
    s_waitcnt lgkmcnt(7)
    v_mfma_f32_16x16x32_bf16 v[208:211], v[16:19], a[56:59], v[208:211]
    ds_read_b64_tr_b16 v[0:1], v224 offset:17408
    v_mfma_f32_16x16x32_bf16 v[212:215], v[16:19], a[60:63], v[212:215]
    ds_read_b64_tr_b16 v[2:3], v224 offset:17920
    s_mov_b32 s66, s94
    v_mfma_f32_16x16x32_bf16 v[216:219], v[20:23], a[56:59], v[216:219]
    ds_read_b64_tr_b16 v[4:5], v225 offset:17408
    buffer_load_dwordx4 v112, s[20:23], s66 offen offset:0 lds
    v_mfma_f32_16x16x32_bf16 v[220:223], v[20:23], a[60:63], v[220:223]
    ds_read_b64_tr_b16 v[6:7], v225 offset:17920
    v_pk_add_f32 v[78:79], v[78:79], v[202:203]
    v_mfma_f32_16x16x32_bf16 v[48:51], v[24:27], a[56:59], v[48:51]
    ds_read_b64_tr_b16 v[8:9], v226 offset:17408
    buffer_load_dwordx4 v114, s[20:23], s66 offen offset:2048 lds
    v_mfma_f32_16x16x32_bf16 v[52:55], v[24:27], a[60:63], v[52:55]
    ds_read_b64_tr_b16 v[10:11], v226 offset:17920
    v_cvt_pk_bf16_f32 v76, 0, v76
    v_mfma_f32_16x16x32_bf16 v[56:59], v[28:31], a[56:59], v[56:59]
    ds_read_b64_tr_b16 v[12:13], v227 offset:17408
    s_add_u32 m0, s1, 147456
    v_mfma_f32_16x16x32_bf16 v[60:63], v[28:31], a[60:63], v[60:63]
    ds_read_b64_tr_b16 v[14:15], v227 offset:17920
    s_add_u32 s66, s58, s99
    s_waitcnt lgkmcnt(7)
    v_mfma_f32_16x16x32_bf16 v[160:163], v[32:35], a[0:3], v[160:163]
    ds_read_b64_tr_b16 v[16:17], v224 offset:24576
    v_mfma_f32_16x16x32_bf16 v[164:167], v[32:35], a[4:7], v[164:167]
    ds_read_b64_tr_b16 v[18:19], v224 offset:25088
    buffer_load_dwordx4 v112, s[20:23], s66 offen offset:0 lds
    v_mfma_f32_16x16x32_bf16 v[168:171], v[36:39], a[0:3], v[168:171]
    ds_read_b64_tr_b16 v[20:21], v225 offset:24576
    v_cvt_pk_bf16_f32 v77, 0, v77
    v_mfma_f32_16x16x32_bf16 v[172:175], v[36:39], a[4:7], v[172:175]
    ds_read_b64_tr_b16 v[22:23], v225 offset:25088
    buffer_load_dwordx4 v113, s[20:23], s66 offen offset:1024 lds
    v_mfma_f32_16x16x32_bf16 v[176:179], v[40:43], a[0:3], v[176:179]
    ds_read_b64_tr_b16 v[24:25], v226 offset:24576
    v_cvt_pk_bf16_f32 v78, 0, v78
    v_mfma_f32_16x16x32_bf16 v[180:183], v[40:43], a[4:7], v[180:183]
    ds_read_b64_tr_b16 v[26:27], v226 offset:25088
    v_cvt_pk_bf16_f32 v79, 0, v79
    v_mfma_f32_16x16x32_bf16 v[184:187], v[44:47], a[0:3], v[184:187]
    ds_read_b64_tr_b16 v[28:29], v227 offset:24576
    v_pk_add_f32 v[76:77], v[76:77], v[120:121]
    v_mfma_f32_16x16x32_bf16 v[188:191], v[44:47], a[4:7], v[188:191]
    ds_read_b64_tr_b16 v[30:31], v227 offset:25088
    buffer_load_dwordx4 v114, s[20:23], s66 offen offset:2048 lds
    s_waitcnt lgkmcnt(7)
    v_mfma_f32_16x16x32_bf16 v[160:163], v[0:3], a[16:19], v[160:163]
    ds_read_b64_tr_b16 v[32:33], v224 offset:25600
    v_mfma_f32_16x16x32_bf16 v[164:167], v[0:3], a[20:23], v[164:167]
    ds_read_b64_tr_b16 v[34:35], v224 offset:26112
    v_pk_add_f32 v[78:79], v[78:79], v[122:123]
    v_mfma_f32_16x16x32_bf16 v[168:171], v[4:7], a[16:19], v[168:171]
    ds_read_b64_tr_b16 v[36:37], v225 offset:25600
    buffer_load_dwordx4 v115, s[20:23], s66 offen offset:3072 lds
    v_mfma_f32_16x16x32_bf16 v[172:175], v[4:7], a[20:23], v[172:175]
    ds_read_b64_tr_b16 v[38:39], v225 offset:26112
    v_cvt_pk_bf16_f32 v198, v76, v77
    v_mfma_f32_16x16x32_bf16 v[176:179], v[8:11], a[16:19], v[176:179]
    ds_read_b64_tr_b16 v[40:41], v226 offset:25600
    v_cvt_pk_bf16_f32 v199, v78, v79
    v_mfma_f32_16x16x32_bf16 v[180:183], v[8:11], a[20:23], v[180:183]
    ds_read_b64_tr_b16 v[42:43], v226 offset:26112
    v_mfma_f32_16x16x32_bf16 v[184:187], v[12:15], a[16:19], v[184:187]
    ds_read_b64_tr_b16 v[44:45], v227 offset:25600
    v_permlane16_swap_b32 v196, v198
    v_mfma_f32_16x16x32_bf16 v[188:191], v[12:15], a[20:23], v[188:191]
    ds_read_b64_tr_b16 v[46:47], v227 offset:26112
    v_permlane16_swap_b32 v197, v199
    s_waitcnt lgkmcnt(7)
    v_mfma_f32_16x16x32_bf16 v[160:163], v[16:19], a[32:35], v[160:163]
    s_waitcnt vmcnt(38)
    s_barrier
    v_mfma_f32_16x16x32_bf16 v[164:167], v[16:19], a[36:39], v[164:167]
    ds_read_b64_tr_b16 v[0:1], v224 offset:32768
    s_add_u32 m0, s1, 65536
    v_mfma_f32_16x16x32_bf16 v[168:171], v[20:23], a[32:35], v[168:171]
    ds_read_b64_tr_b16 v[2:3], v224 offset:33280
    s_add_u32 s66, s59, s99
    v_mfma_f32_16x16x32_bf16 v[172:175], v[20:23], a[36:39], v[172:175]
    ds_read_b64_tr_b16 v[4:5], v225 offset:32768
    buffer_load_dwordx4 v112, s[20:23], s66 offen offset:0 lds
    v_mfma_f32_16x16x32_bf16 v[176:179], v[24:27], a[32:35], v[176:179]
    ds_read_b64_tr_b16 v[6:7], v225 offset:33280
    buffer_store_dwordx4 v[196:199], v255, s[36:39], s28 offen offset:1024 sc1
    v_mfma_f32_16x16x32_bf16 v[180:183], v[24:27], a[36:39], v[180:183]
    ds_read_b64_tr_b16 v[8:9], v226 offset:32768
    v_pk_add_f32 v[80:81], v[80:81], v[82:83]
    v_mfma_f32_16x16x32_bf16 v[184:187], v[28:31], a[32:35], v[184:187]
    ds_read_b64_tr_b16 v[10:11], v226 offset:33280
    v_pk_add_f32 v[84:85], v[84:85], v[86:87]
    v_mfma_f32_16x16x32_bf16 v[188:191], v[28:31], a[36:39], v[188:191]
    ds_read_b64_tr_b16 v[12:13], v227 offset:32768
    ds_read_b64_tr_b16 v[14:15], v227 offset:33280
    s_waitcnt lgkmcnt(8)
    v_mfma_f32_16x16x32_bf16 v[160:163], v[32:35], a[48:51], v[160:163]
    ds_read_b64_tr_b16 v[16:17], v224 offset:33792
    v_mfma_f32_16x16x32_bf16 v[164:167], v[32:35], a[52:55], v[164:167]
    ds_read_b64_tr_b16 v[18:19], v224 offset:34304
    v_pk_add_f32 v[80:81], v[80:81], v[84:85]
    v_mfma_f32_16x16x32_bf16 v[168:171], v[36:39], a[48:51], v[168:171]
    ds_read_b64_tr_b16 v[20:21], v225 offset:33792
    buffer_load_dwordx4 v113, s[20:23], s66 offen offset:1024 lds
    v_mfma_f32_16x16x32_bf16 v[172:175], v[36:39], a[52:55], v[172:175]
    ds_read_b64_tr_b16 v[22:23], v225 offset:34304
    v_cvt_pk_bf16_f32 v80, 0, v80
    v_mfma_f32_16x16x32_bf16 v[176:179], v[40:43], a[48:51], v[176:179]
    ds_read_b64_tr_b16 v[24:25], v226 offset:33792
    v_cvt_pk_bf16_f32 v81, 0, v81
    v_mfma_f32_16x16x32_bf16 v[180:183], v[40:43], a[52:55], v[180:183]
    ds_read_b64_tr_b16 v[26:27], v226 offset:34304
    v_pk_add_f32 v[80:81], v[80:81], v[204:205]
    v_mfma_f32_16x16x32_bf16 v[184:187], v[44:47], a[48:51], v[184:187]
    ds_read_b64_tr_b16 v[28:29], v227 offset:33792
    buffer_load_dwordx4 v114, s[20:23], s66 offen offset:2048 lds
    v_mfma_f32_16x16x32_bf16 v[188:191], v[44:47], a[52:55], v[188:191]
    ds_read_b64_tr_b16 v[30:31], v227 offset:34304
    v_cvt_pk_bf16_f32 v80, v80, v81
    s_waitcnt lgkmcnt(7)
    v_mfma_f32_16x16x32_bf16 v[160:163], v[0:3], a[64:67], v[160:163]
    ds_read_b64_tr_b16 v[32:33], v224 offset:40960
    v_mfma_f32_16x16x32_bf16 v[164:167], v[0:3], a[68:71], v[164:167]
    ds_read_b64_tr_b16 v[34:35], v224 offset:41472
    buffer_store_dword v80, v246, s[36:39], s78 offen sc1
    v_mfma_f32_16x16x32_bf16 v[168:171], v[4:7], a[64:67], v[168:171]
    ds_read_b64_tr_b16 v[36:37], v225 offset:40960
    v_mfma_f32_16x16x32_bf16 v[172:175], v[4:7], a[68:71], v[172:175]
    ds_read_b64_tr_b16 v[38:39], v225 offset:41472
    buffer_load_dwordx4 v115, s[20:23], s66 offen offset:3072 lds
    v_mfma_f32_16x16x32_bf16 v[176:179], v[8:11], a[64:67], v[176:179]
    ds_read_b64_tr_b16 v[40:41], v226 offset:40960
    v_mfma_f32_16x16x32_bf16 v[180:183], v[8:11], a[68:71], v[180:183]
    ds_read_b64_tr_b16 v[42:43], v226 offset:41472
    s_add_u32 m0, s1, 0
    v_mfma_f32_16x16x32_bf16 v[184:187], v[12:15], a[64:67], v[184:187]
    ds_read_b64_tr_b16 v[44:45], v227 offset:40960
    s_add_u32 s66, s0, s99
    v_mfma_f32_16x16x32_bf16 v[188:191], v[12:15], a[68:71], v[188:191]
    ds_read_b64_tr_b16 v[46:47], v227 offset:41472
    buffer_load_dwordx4 v112, s[20:23], s66 offen offset:0 lds
    s_waitcnt lgkmcnt(7)
    v_mfma_f32_16x16x32_bf16 v[160:163], v[16:19], a[80:83], v[160:163]
    ds_read_b64_tr_b16 v[0:1], v224 offset:41984
    v_mfma_f32_16x16x32_bf16 v[164:167], v[16:19], a[84:87], v[164:167]
    ds_read_b64_tr_b16 v[2:3], v224 offset:42496
    v_mfma_f32_16x16x32_bf16 v[168:171], v[20:23], a[80:83], v[168:171]
    ds_read_b64_tr_b16 v[4:5], v225 offset:41984
    v_mfma_f32_16x16x32_bf16 v[172:175], v[20:23], a[84:87], v[172:175]
    ds_read_b64_tr_b16 v[6:7], v225 offset:42496
    buffer_load_dwordx4 v113, s[20:23], s66 offen offset:1024 lds
    v_mfma_f32_16x16x32_bf16 v[176:179], v[24:27], a[80:83], v[176:179]
    ds_read_b64_tr_b16 v[8:9], v226 offset:41984
    v_mfma_f32_16x16x32_bf16 v[180:183], v[24:27], a[84:87], v[180:183]
    ds_read_b64_tr_b16 v[10:11], v226 offset:42496
    v_mfma_f32_16x16x32_bf16 v[184:187], v[28:31], a[80:83], v[184:187]
    ds_read_b64_tr_b16 v[12:13], v227 offset:41984
    buffer_load_dwordx4 v114, s[20:23], s66 offen offset:2048 lds
    v_mfma_f32_16x16x32_bf16 v[188:191], v[28:31], a[84:87], v[188:191]
    ds_read_b64_tr_b16 v[14:15], v227 offset:42496
    s_waitcnt lgkmcnt(7)
    v_mfma_f32_16x16x32_bf16 v[160:163], v[32:35], a[96:99], v[160:163]
    ds_read_b64_tr_b16 v[16:17], v224 offset:49152
    v_mfma_f32_16x16x32_bf16 v[164:167], v[32:35], a[100:103], v[164:167]
    ds_read_b64_tr_b16 v[18:19], v224 offset:49664
    s_waitcnt vmcnt(15)
    v_mfma_f32_16x16x32_bf16 v[168:171], v[36:39], a[96:99], v[168:171]
    ds_read_b64_tr_b16 v[20:21], v225 offset:49152
    buffer_load_dwordx4 v115, s[20:23], s66 offen offset:3072 lds
    v_mfma_f32_16x16x32_bf16 v[172:175], v[36:39], a[100:103], v[172:175]
    ds_read_b64_tr_b16 v[22:23], v225 offset:49664
    v_cmp_le_u32 vcc, 4, v207
    s_cmp_eq_u64 vcc, exec
    s_cbranch_scc0 gated_mix__ssm_conv_s4__glu_gated_bilinear__prompt_kernel_slow5
gated_mix__ssm_conv_s4__glu_gated_bilinear__prompt_kernel_back5:
    v_mfma_f32_16x16x32_bf16 v[176:179], v[40:43], a[96:99], v[176:179]
    ds_read_b64_tr_b16 v[24:25], v226 offset:49152
    v_mfma_f32_16x16x32_bf16 v[180:183], v[40:43], a[100:103], v[180:183]
    ds_read_b64_tr_b16 v[26:27], v226 offset:49664
    s_mov_b32 s66, s40
    v_mfma_f32_16x16x32_bf16 v[184:187], v[44:47], a[96:99], v[184:187]
    ds_read_b64_tr_b16 v[28:29], v227 offset:49152
    buffer_load_dwordx4 v[128:131], v250, s[36:39], s66 offen sc1
    v_mfma_f32_16x16x32_bf16 v[188:191], v[44:47], a[100:103], v[188:191]
    ds_read_b64_tr_b16 v[30:31], v227 offset:49664
    s_waitcnt lgkmcnt(7)
    v_mfma_f32_16x16x32_bf16 v[160:163], v[0:3], a[112:115], v[160:163]
    ds_read_b64_tr_b16 v[32:33], v224 offset:50176
    v_mfma_f32_16x16x32_bf16 v[164:167], v[0:3], a[116:119], v[164:167]
    ds_read_b64_tr_b16 v[34:35], v224 offset:50688
    v_mfma_f32_16x16x32_bf16 v[168:171], v[4:7], a[112:115], v[168:171]
    ds_read_b64_tr_b16 v[36:37], v225 offset:50176
    buffer_load_dwordx4 v[132:135], v250, s[36:39], s66 offen offset:1024 sc1
    v_mfma_f32_16x16x32_bf16 v[172:175], v[4:7], a[116:119], v[172:175]
    ds_read_b64_tr_b16 v[38:39], v225 offset:50688
    v_mfma_f32_16x16x32_bf16 v[176:179], v[8:11], a[112:115], v[176:179]
    ds_read_b64_tr_b16 v[40:41], v226 offset:50176
    s_mov_b32 s66, s41
    v_mfma_f32_16x16x32_bf16 v[180:183], v[8:11], a[116:119], v[180:183]
    ds_read_b64_tr_b16 v[42:43], v226 offset:50688
    v_mfma_f32_16x16x32_bf16 v[184:187], v[12:15], a[112:115], v[184:187]
    ds_read_b64_tr_b16 v[44:45], v227 offset:50176
    buffer_load_dwordx4 v[136:139], v250, s[36:39], s66 offen sc1
    v_mfma_f32_16x16x32_bf16 v[188:191], v[12:15], a[116:119], v[188:191]
    ds_read_b64_tr_b16 v[46:47], v227 offset:50688
    s_waitcnt lgkmcnt(7)
    v_mfma_f32_16x16x32_bf16 v[160:163], v[16:19], a[128:131], v[160:163]
    ds_read_b64_tr_b16 v[0:1], v224 offset:57344
    v_mfma_f32_16x16x32_bf16 v[164:167], v[16:19], a[132:135], v[164:167]
    ds_read_b64_tr_b16 v[2:3], v224 offset:57856
    v_mfma_f32_16x16x32_bf16 v[168:171], v[20:23], a[128:131], v[168:171]
    ds_read_b64_tr_b16 v[4:5], v225 offset:57344
    buffer_load_dwordx4 v[140:143], v250, s[36:39], s66 offen offset:1024 sc1
    v_mfma_f32_16x16x32_bf16 v[172:175], v[20:23], a[132:135], v[172:175]
    ds_read_b64_tr_b16 v[6:7], v225 offset:57856
    v_mfma_f32_16x16x32_bf16 v[176:179], v[24:27], a[128:131], v[176:179]
    ds_read_b64_tr_b16 v[8:9], v226 offset:57344
    s_mov_b32 s66, s42
    v_mfma_f32_16x16x32_bf16 v[180:183], v[24:27], a[132:135], v[180:183]
    ds_read_b64_tr_b16 v[10:11], v226 offset:57856
    v_mfma_f32_16x16x32_bf16 v[184:187], v[28:31], a[128:131], v[184:187]
    ds_read_b64_tr_b16 v[12:13], v227 offset:57344
    buffer_load_dwordx4 v[144:147], v250, s[36:39], s66 offen sc1
    v_mfma_f32_16x16x32_bf16 v[188:191], v[28:31], a[132:135], v[188:191]
    ds_read_b64_tr_b16 v[14:15], v227 offset:57856
    s_waitcnt lgkmcnt(7)
    v_mfma_f32_16x16x32_bf16 v[160:163], v[32:35], a[144:147], v[160:163]
    ds_read_b64_tr_b16 v[16:17], v224 offset:58368
    v_mfma_f32_16x16x32_bf16 v[164:167], v[32:35], a[148:151], v[164:167]
    ds_read_b64_tr_b16 v[18:19], v224 offset:58880
    v_mfma_f32_16x16x32_bf16 v[168:171], v[36:39], a[144:147], v[168:171]
    ds_read_b64_tr_b16 v[20:21], v225 offset:58368
    buffer_load_dwordx4 v[148:151], v250, s[36:39], s66 offen offset:1024 sc1
    v_mfma_f32_16x16x32_bf16 v[172:175], v[36:39], a[148:151], v[172:175]
    ds_read_b64_tr_b16 v[22:23], v225 offset:58880
    v_mfma_f32_16x16x32_bf16 v[176:179], v[40:43], a[144:147], v[176:179]
    ds_read_b64_tr_b16 v[24:25], v226 offset:58368
    s_mov_b32 s66, s7
    v_mfma_f32_16x16x32_bf16 v[180:183], v[40:43], a[148:151], v[180:183]
    ds_read_b64_tr_b16 v[26:27], v226 offset:58880
    v_mfma_f32_16x16x32_bf16 v[184:187], v[44:47], a[144:147], v[184:187]
    ds_read_b64_tr_b16 v[28:29], v227 offset:58368
    buffer_load_dwordx4 v[152:155], v250, s[36:39], s66 offen sc1
    v_mfma_f32_16x16x32_bf16 v[188:191], v[44:47], a[148:151], v[188:191]
    ds_read_b64_tr_b16 v[30:31], v227 offset:58880
    s_waitcnt lgkmcnt(7)
    v_mfma_f32_16x16x32_bf16 v[160:163], v[0:3], a[160:163], v[160:163]
    s_waitcnt vmcnt(12)
    s_barrier
    v_mfma_f32_16x16x32_bf16 v[164:167], v[0:3], a[164:167], v[164:167]
    ds_read_b64_tr_b16 v[32:33], v228 offset:20480
    v_lshrrev_b32 v100, 4, v252
    v_mfma_f32_16x16x32_bf16 v[168:171], v[4:7], a[160:163], v[168:171]
    ds_read_b64_tr_b16 v[34:35], v228 offset:20992
    buffer_load_dwordx4 v[156:159], v250, s[36:39], s66 offen offset:1024 sc1
    v_mfma_f32_16x16x32_bf16 v[172:175], v[4:7], a[164:167], v[172:175]
    ds_read_b64_tr_b16 v[36:37], v229 offset:20480
    v_and_b32 v101, 15, v252
    v_mfma_f32_16x16x32_bf16 v[176:179], v[8:11], a[160:163], v[176:179]
    ds_read_b64_tr_b16 v[38:39], v229 offset:20992
    v_mov_b32 v207, 1
    buffer_store_dword v207, off, s[36:39], s4 offset:4 sc1
    v_mfma_f32_16x16x32_bf16 v[180:183], v[8:11], a[164:167], v[180:183]
    ds_read_b64_tr_b16 v[40:41], v230 offset:20480
    s_add_u32 m0, s1, 16384
    v_mfma_f32_16x16x32_bf16 v[184:187], v[12:15], a[160:163], v[184:187]
    ds_read_b64_tr_b16 v[42:43], v230 offset:20992
    s_add_u32 s66, s29, s99
    v_mfma_f32_16x16x32_bf16 v[188:191], v[12:15], a[164:167], v[188:191]
    ds_read_b64_tr_b16 v[44:45], v231 offset:20480
    ds_read_b64_tr_b16 v[46:47], v231 offset:20992
    s_waitcnt lgkmcnt(8)
    v_mfma_f32_16x16x32_bf16 v[160:163], v[16:19], a[176:179], v[160:163]
    ds_read_b64_tr_b16 v[0:1], v228 offset:21504
    v_mfma_f32_16x16x32_bf16 v[164:167], v[16:19], a[180:183], v[164:167]
    ds_read_b64_tr_b16 v[2:3], v228 offset:22016
    buffer_load_dwordx4 v112, s[20:23], s66 offen offset:0 lds
    v_mfma_f32_16x16x32_bf16 v[168:171], v[20:23], a[176:179], v[168:171]
    ds_read_b64_tr_b16 v[4:5], v229 offset:21504
    v_add_u32 v248, s8, v252
    v_mfma_f32_16x16x32_bf16 v[172:175], v[20:23], a[180:183], v[172:175]
    ds_read_b64_tr_b16 v[6:7], v229 offset:22016
    buffer_load_dwordx4 v113, s[20:23], s66 offen offset:1024 lds
    v_mfma_f32_16x16x32_bf16 v[176:179], v[24:27], a[176:179], v[176:179]
    ds_read_b64_tr_b16 v[8:9], v230 offset:21504
    v_and_b32 v248, 255, v248
    v_mfma_f32_16x16x32_bf16 v[180:183], v[24:27], a[180:183], v[180:183]
    ds_read_b64_tr_b16 v[10:11], v230 offset:22016
    v_and_b32 v102, 3, v252
    v_mfma_f32_16x16x32_bf16 v[184:187], v[28:31], a[176:179], v[184:187]
    ds_read_b64_tr_b16 v[12:13], v231 offset:21504
    v_cmp_gt_u32 s[74:75], 32, v252
    v_mfma_f32_16x16x32_bf16 v[188:191], v[28:31], a[180:183], v[188:191]
    ds_read_b64_tr_b16 v[14:15], v231 offset:22016
    buffer_load_dwordx4 v114, s[20:23], s66 offen offset:2048 lds
    s_waitcnt lgkmcnt(7)
    v_mfma_f32_16x16x32_bf16 v[160:163], v[32:35], a[192:195], v[160:163]
    ds_read_b64_tr_b16 v[16:17], v228 offset:28672
    v_mfma_f32_16x16x32_bf16 v[164:167], v[32:35], a[196:199], v[164:167]
    ds_read_b64_tr_b16 v[18:19], v228 offset:29184
    v_add_u32 v102, s9, v102
    v_mfma_f32_16x16x32_bf16 v[168:171], v[36:39], a[192:195], v[168:171]
    ds_read_b64_tr_b16 v[20:21], v229 offset:28672
    buffer_load_dwordx4 v115, s[20:23], s66 offen offset:3072 lds
    v_mfma_f32_16x16x32_bf16 v[172:175], v[36:39], a[196:199], v[172:175]
    ds_read_b64_tr_b16 v[22:23], v229 offset:29184
    v_lshrrev_b32 v249, 1, v252
    v_mfma_f32_16x16x32_bf16 v[176:179], v[40:43], a[192:195], v[176:179]
    ds_read_b64_tr_b16 v[24:25], v230 offset:28672
    s_add_u32 m0, s1, 32768
    v_mfma_f32_16x16x32_bf16 v[180:183], v[40:43], a[196:199], v[180:183]
    ds_read_b64_tr_b16 v[26:27], v230 offset:29184
    s_add_u32 s66, s58, s99
    v_mfma_f32_16x16x32_bf16 v[184:187], v[44:47], a[192:195], v[184:187]
    ds_read_b64_tr_b16 v[28:29], v231 offset:28672
    s_add_u32 s66, s66, 73728
    v_mfma_f32_16x16x32_bf16 v[188:191], v[44:47], a[196:199], v[188:191]
    ds_read_b64_tr_b16 v[30:31], v231 offset:29184
    buffer_load_dwordx4 v112, s[20:23], s66 offen offset:0 lds
    s_waitcnt lgkmcnt(7)
    v_mfma_f32_16x16x32_bf16 v[160:163], v[0:3], a[208:211], v[160:163]
    ds_read_b64_tr_b16 v[32:33], v228 offset:29696
    v_mfma_f32_16x16x32_bf16 v[164:167], v[0:3], a[212:215], v[164:167]
    ds_read_b64_tr_b16 v[34:35], v228 offset:30208
    buffer_load_dwordx4 v113, s[20:23], s66 offen offset:1024 lds
    v_mfma_f32_16x16x32_bf16 v[168:171], v[4:7], a[208:211], v[168:171]
    ds_read_b64_tr_b16 v[36:37], v229 offset:29696
    v_cndmask_b32 v248, v102, v248, s[74:75]
    v_mfma_f32_16x16x32_bf16 v[172:175], v[4:7], a[212:215], v[172:175]
    ds_read_b64_tr_b16 v[38:39], v229 offset:30208
    v_lshlrev_b32 v248, 7, v248
    v_mfma_f32_16x16x32_bf16 v[176:179], v[8:11], a[208:211], v[176:179]
    ds_read_b64_tr_b16 v[40:41], v230 offset:29696
    v_lshlrev_b32 v249, 12, v249
    v_mfma_f32_16x16x32_bf16 v[180:183], v[8:11], a[212:215], v[180:183]
    ds_read_b64_tr_b16 v[42:43], v230 offset:30208
    buffer_load_dwordx4 v114, s[20:23], s66 offen offset:2048 lds
    v_mfma_f32_16x16x32_bf16 v[184:187], v[12:15], a[208:211], v[184:187]
    ds_read_b64_tr_b16 v[44:45], v231 offset:29696
    v_and_b32 v102, 1, v252
    v_mfma_f32_16x16x32_bf16 v[188:191], v[12:15], a[212:215], v[188:191]
    ds_read_b64_tr_b16 v[46:47], v231 offset:30208
    v_lshl_add_u32 v249, v102, 4, v249
    s_waitcnt lgkmcnt(7)
    v_mfma_f32_16x16x32_bf16 v[160:163], v[16:19], a[224:227], v[160:163]
    ds_read_b64_tr_b16 v[0:1], v228 offset:36864
    v_mfma_f32_16x16x32_bf16 v[164:167], v[16:19], a[228:231], v[164:167]
    ds_read_b64_tr_b16 v[2:3], v228 offset:37376
    buffer_load_dwordx4 v115, s[20:23], s66 offen offset:3072 lds
    v_mfma_f32_16x16x32_bf16 v[168:171], v[20:23], a[224:227], v[168:171]
    ds_read_b64_tr_b16 v[4:5], v229 offset:36864
    v_lshlrev_b32 v242, 2, v101
    v_mfma_f32_16x16x32_bf16 v[172:175], v[20:23], a[228:231], v[172:175]
    ds_read_b64_tr_b16 v[6:7], v229 offset:37376
    v_lshrrev_b32 v103, 1, v100
    v_mfma_f32_16x16x32_bf16 v[176:179], v[24:27], a[224:227], v[176:179]
    ds_read_b64_tr_b16 v[8:9], v230 offset:36864
    v_lshl_add_u32 v104, v103, 4, v101
    v_mfma_f32_16x16x32_bf16 v[180:183], v[24:27], a[228:231], v[180:183]
    ds_read_b64_tr_b16 v[10:11], v230 offset:37376
    v_lshlrev_b32 v243, 2, v104
    v_mfma_f32_16x16x32_bf16 v[184:187], v[28:31], a[224:227], v[184:187]
    ds_read_b64_tr_b16 v[12:13], v231 offset:36864
    v_and_b32 v105, 1, v100
    v_mfma_f32_16x16x32_bf16 v[188:191], v[28:31], a[228:231], v[188:191]
    ds_read_b64_tr_b16 v[14:15], v231 offset:37376
    v_and_b32 v244, 30, v104
    s_waitcnt lgkmcnt(7)
    v_mfma_f32_16x16x32_bf16 v[160:163], v[32:35], a[240:243], v[160:163]
    ds_read_b64_tr_b16 v[16:17], v228 offset:37888
    v_mfma_f32_16x16x32_bf16 v[164:167], v[32:35], a[244:247], v[164:167]
    ds_read_b64_tr_b16 v[18:19], v228 offset:38400
    v_lshlrev_b32 v244, 1, v244
    v_mfma_f32_16x16x32_bf16 v[168:171], v[36:39], a[240:243], v[168:171]
    ds_read_b64_tr_b16 v[20:21], v229 offset:37888
    v_lshl_add_u32 v244, v105, 13, v244
    v_mfma_f32_16x16x32_bf16 v[172:175], v[36:39], a[244:247], v[172:175]
    ds_read_b64_tr_b16 v[22:23], v229 offset:38400
    v_mul_u32_u24 v245, 1152, v101
    v_mfma_f32_16x16x32_bf16 v[176:179], v[40:43], a[240:243], v[176:179]
    ds_read_b64_tr_b16 v[24:25], v230 offset:37888
    v_lshl_add_u32 v245, v105, 5, v245
    v_mfma_f32_16x16x32_bf16 v[180:183], v[40:43], a[244:247], v[180:183]
    ds_read_b64_tr_b16 v[26:27], v230 offset:38400
    v_lshl_add_u32 v245, v103, 4, v245
    v_mfma_f32_16x16x32_bf16 v[184:187], v[44:47], a[240:243], v[184:187]
    ds_read_b64_tr_b16 v[28:29], v231 offset:37888
    v_mul_u32_u24 v247, 1152, v104
    v_mfma_f32_16x16x32_bf16 v[188:191], v[44:47], a[244:247], v[188:191]
    ds_read_b64_tr_b16 v[30:31], v231 offset:38400
    v_lshl_add_u32 v247, v105, 2, v247
    s_waitcnt lgkmcnt(7)
    v_mfma_f32_16x16x32_bf16 v[208:211], v[0:3], a[0:3], v[208:211]
    ds_read_b64_tr_b16 v[32:33], v228 offset:45056
    v_mfma_f32_16x16x32_bf16 v[212:215], v[0:3], a[4:7], v[212:215]
    ds_read_b64_tr_b16 v[34:35], v228 offset:45568
    v_lshlrev_b32 v101, 4, v101
    v_mfma_f32_16x16x32_bf16 v[216:219], v[4:7], a[0:3], v[216:219]
    ds_read_b64_tr_b16 v[36:37], v229 offset:45056
    v_lshl_add_u32 v206, v100, 14, v101
    v_mfma_f32_16x16x32_bf16 v[220:223], v[4:7], a[4:7], v[220:223]
    ds_read_b64_tr_b16 v[38:39], v229 offset:45568
    v_mfma_f32_16x16x32_bf16 v[48:51], v[8:11], a[0:3], v[48:51]
    ds_read_b64_tr_b16 v[40:41], v230 offset:45056
    v_mfma_f32_16x16x32_bf16 v[52:55], v[8:11], a[4:7], v[52:55]
    ds_read_b64_tr_b16 v[42:43], v230 offset:45568
    v_mfma_f32_16x16x32_bf16 v[56:59], v[12:15], a[0:3], v[56:59]
    ds_read_b64_tr_b16 v[44:45], v231 offset:45056
    v_mfma_f32_16x16x32_bf16 v[60:63], v[12:15], a[4:7], v[60:63]
    ds_read_b64_tr_b16 v[46:47], v231 offset:45568
    s_waitcnt lgkmcnt(7)
    v_mfma_f32_16x16x32_bf16 v[208:211], v[16:19], a[16:19], v[208:211]
    ds_read_b64_tr_b16 v[0:1], v228 offset:46080
    v_mfma_f32_16x16x32_bf16 v[212:215], v[16:19], a[20:23], v[212:215]
    ds_read_b64_tr_b16 v[2:3], v228 offset:46592
    v_mfma_f32_16x16x32_bf16 v[216:219], v[20:23], a[16:19], v[216:219]
    ds_read_b64_tr_b16 v[4:5], v229 offset:46080
    v_mfma_f32_16x16x32_bf16 v[220:223], v[20:23], a[20:23], v[220:223]
    ds_read_b64_tr_b16 v[6:7], v229 offset:46592
    v_mfma_f32_16x16x32_bf16 v[48:51], v[24:27], a[16:19], v[48:51]
    ds_read_b64_tr_b16 v[8:9], v230 offset:46080
    v_mfma_f32_16x16x32_bf16 v[52:55], v[24:27], a[20:23], v[52:55]
    ds_read_b64_tr_b16 v[10:11], v230 offset:46592
    v_mfma_f32_16x16x32_bf16 v[56:59], v[28:31], a[16:19], v[56:59]
    ds_read_b64_tr_b16 v[12:13], v231 offset:46080
    v_mfma_f32_16x16x32_bf16 v[60:63], v[28:31], a[20:23], v[60:63]
    ds_read_b64_tr_b16 v[14:15], v231 offset:46592
    s_waitcnt lgkmcnt(7)
    v_mfma_f32_16x16x32_bf16 v[208:211], v[32:35], a[32:35], v[208:211]
    s_barrier
    v_mfma_f32_16x16x32_bf16 v[212:215], v[32:35], a[36:39], v[212:215]
    ds_read_b64_tr_b16 v[16:17], v232 offset:8192
    s_add_u32 m0, s1, 49152
    v_mfma_f32_16x16x32_bf16 v[216:219], v[36:39], a[32:35], v[216:219]
    ds_read_b64_tr_b16 v[18:19], v232 offset:8704
    s_add_u32 s66, s59, s99
    v_mfma_f32_16x16x32_bf16 v[220:223], v[36:39], a[36:39], v[220:223]
    ds_read_b64_tr_b16 v[20:21], v233 offset:8192
    s_add_u32 s66, s66, 73728
    v_mfma_f32_16x16x32_bf16 v[48:51], v[40:43], a[32:35], v[48:51]
    ds_read_b64_tr_b16 v[22:23], v233 offset:8704
    buffer_load_dwordx4 v112, s[20:23], s66 offen offset:0 lds
    v_mfma_f32_16x16x32_bf16 v[52:55], v[40:43], a[36:39], v[52:55]
    ds_read_b64_tr_b16 v[24:25], v234 offset:8192
    v_mfma_f32_16x16x32_bf16 v[56:59], v[44:47], a[32:35], v[56:59]
    ds_read_b64_tr_b16 v[26:27], v234 offset:8704
    buffer_load_dwordx4 v113, s[20:23], s66 offen offset:1024 lds
    v_mfma_f32_16x16x32_bf16 v[60:63], v[44:47], a[36:39], v[60:63]
    ds_read_b64_tr_b16 v[28:29], v235 offset:8192
    ds_read_b64_tr_b16 v[30:31], v235 offset:8704
    s_waitcnt lgkmcnt(8)
    v_mfma_f32_16x16x32_bf16 v[208:211], v[0:3], a[48:51], v[208:211]
    ds_read_b64_tr_b16 v[32:33], v228 offset:53248
    v_mfma_f32_16x16x32_bf16 v[212:215], v[0:3], a[52:55], v[212:215]
    ds_read_b64_tr_b16 v[34:35], v228 offset:53760
    v_mfma_f32_16x16x32_bf16 v[216:219], v[4:7], a[48:51], v[216:219]
    ds_read_b64_tr_b16 v[36:37], v229 offset:53248
    buffer_load_dwordx4 v114, s[20:23], s66 offen offset:2048 lds
    v_mfma_f32_16x16x32_bf16 v[220:223], v[4:7], a[52:55], v[220:223]
    ds_read_b64_tr_b16 v[38:39], v229 offset:53760
    v_mfma_f32_16x16x32_bf16 v[48:51], v[8:11], a[48:51], v[48:51]
    ds_read_b64_tr_b16 v[40:41], v230 offset:53248
    v_mfma_f32_16x16x32_bf16 v[52:55], v[8:11], a[52:55], v[52:55]
    ds_read_b64_tr_b16 v[42:43], v230 offset:53760
    buffer_load_dwordx4 v115, s[20:23], s66 offen offset:3072 lds
    v_mfma_f32_16x16x32_bf16 v[56:59], v[12:15], a[48:51], v[56:59]
    ds_read_b64_tr_b16 v[44:45], v231 offset:53248
    v_mfma_f32_16x16x32_bf16 v[60:63], v[12:15], a[52:55], v[60:63]
    ds_read_b64_tr_b16 v[46:47], v231 offset:53760
    s_add_u32 m0, s1, 81920
    s_waitcnt vmcnt(19)
    s_waitcnt lgkmcnt(7)
    v_mfma_f32_16x16x32_bf16 v[208:211], v[16:19], v[128:131], v[208:211]
    ds_read_b64_tr_b16 v[0:1], v228 offset:54272
    v_mfma_f32_16x16x32_bf16 v[212:215], v[16:19], v[132:135], v[212:215]
    ds_read_b64_tr_b16 v[2:3], v228 offset:54784
    s_add_u32 s66, s0, s99
    v_mfma_f32_16x16x32_bf16 v[216:219], v[20:23], v[128:131], v[216:219]
    ds_read_b64_tr_b16 v[4:5], v229 offset:54272
    s_add_u32 s66, s66, 73728
    v_mfma_f32_16x16x32_bf16 v[220:223], v[20:23], v[132:135], v[220:223]
    ds_read_b64_tr_b16 v[6:7], v229 offset:54784
    buffer_load_dwordx4 v112, s[20:23], s66 offen offset:0 lds
    v_mfma_f32_16x16x32_bf16 v[48:51], v[24:27], v[128:131], v[48:51]
    ds_read_b64_tr_b16 v[8:9], v230 offset:54272
    v_mfma_f32_16x16x32_bf16 v[52:55], v[24:27], v[132:135], v[52:55]
    ds_read_b64_tr_b16 v[10:11], v230 offset:54784
    buffer_load_dwordx4 v113, s[20:23], s66 offen offset:1024 lds
    v_mfma_f32_16x16x32_bf16 v[56:59], v[28:31], v[128:131], v[56:59]
    ds_read_b64_tr_b16 v[12:13], v231 offset:54272
    v_mfma_f32_16x16x32_bf16 v[60:63], v[28:31], v[132:135], v[60:63]
    ds_read_b64_tr_b16 v[14:15], v231 offset:54784
    s_waitcnt lgkmcnt(7)
    v_mfma_f32_16x16x32_bf16 v[160:163], v[32:35], v[128:131], v[160:163]
    ds_read_b64_tr_b16 v[16:17], v232 offset:0
    v_mfma_f32_16x16x32_bf16 v[164:167], v[32:35], v[132:135], v[164:167]
    ds_read_b64_tr_b16 v[18:19], v232 offset:512
    buffer_load_dwordx4 v114, s[20:23], s66 offen offset:2048 lds
    v_mfma_f32_16x16x32_bf16 v[168:171], v[36:39], v[128:131], v[168:171]
    ds_read_b64_tr_b16 v[20:21], v233 offset:0
    v_mfma_f32_16x16x32_bf16 v[172:175], v[36:39], v[132:135], v[172:175]
    ds_read_b64_tr_b16 v[22:23], v233 offset:512
    v_mfma_f32_16x16x32_bf16 v[176:179], v[40:43], v[128:131], v[176:179]
    ds_read_b64_tr_b16 v[24:25], v234 offset:0
    buffer_load_dwordx4 v115, s[20:23], s66 offen offset:3072 lds
    v_mfma_f32_16x16x32_bf16 v[180:183], v[40:43], v[132:135], v[180:183]
    ds_read_b64_tr_b16 v[26:27], v234 offset:512
    v_cvt_pk_bf16_f32 v208, v208, v209
    v_mfma_f32_16x16x32_bf16 v[184:187], v[44:47], v[128:131], v[184:187]
    ds_read_b64_tr_b16 v[28:29], v235 offset:0
    v_cvt_pk_bf16_f32 v209, v210, v211
    v_mfma_f32_16x16x32_bf16 v[188:191], v[44:47], v[132:135], v[188:191]
    ds_read_b64_tr_b16 v[30:31], v235 offset:512
    v_cvt_pk_bf16_f32 v210, v212, v213
    s_waitcnt vmcnt(21)
    s_waitcnt lgkmcnt(7)
    v_mfma_f32_16x16x32_bf16 v[160:163], v[0:3], v[136:139], v[160:163]
    ds_read_b64_tr_b16 v[32:33], v232 offset:1024
    v_mfma_f32_16x16x32_bf16 v[164:167], v[0:3], v[140:143], v[164:167]
    ds_read_b64_tr_b16 v[34:35], v232 offset:1536
    v_cvt_pk_bf16_f32 v211, v214, v215
    v_mfma_f32_16x16x32_bf16 v[168:171], v[4:7], v[136:139], v[168:171]
    ds_read_b64_tr_b16 v[36:37], v233 offset:1024
    s_xor_b32 s71, s81, 0
    v_mfma_f32_16x16x32_bf16 v[172:175], v[4:7], v[140:143], v[172:175]
    ds_read_b64_tr_b16 v[38:39], v233 offset:1536
    buffer_store_dwordx4 v[208:211], v206, s[36:39], s71 offen sc1
    v_mfma_f32_16x16x32_bf16 v[176:179], v[8:11], v[136:139], v[176:179]
    ds_read_b64_tr_b16 v[40:41], v234 offset:1024
    v_cvt_pk_bf16_f32 v216, v216, v217
    v_mfma_f32_16x16x32_bf16 v[180:183], v[8:11], v[140:143], v[180:183]
    ds_read_b64_tr_b16 v[42:43], v234 offset:1536
    v_cvt_pk_bf16_f32 v217, v218, v219
    v_mfma_f32_16x16x32_bf16 v[184:187], v[12:15], v[136:139], v[184:187]
    ds_read_b64_tr_b16 v[44:45], v235 offset:1024
    v_cvt_pk_bf16_f32 v218, v220, v221
    v_mfma_f32_16x16x32_bf16 v[188:191], v[12:15], v[140:143], v[188:191]
    ds_read_b64_tr_b16 v[46:47], v235 offset:1536
    v_cvt_pk_bf16_f32 v219, v222, v223
    s_waitcnt vmcnt(20)
    s_waitcnt lgkmcnt(7)
    v_mfma_f32_16x16x32_bf16 v[160:163], v[16:19], v[144:147], v[160:163]
    ds_read_b64_tr_b16 v[0:1], v232 offset:24576
    v_mfma_f32_16x16x32_bf16 v[164:167], v[16:19], v[148:151], v[164:167]
    ds_read_b64_tr_b16 v[2:3], v232 offset:25088
    s_xor_b32 s71, s81, 65536
    v_mfma_f32_16x16x32_bf16 v[168:171], v[20:23], v[144:147], v[168:171]
    ds_read_b64_tr_b16 v[4:5], v233 offset:24576
    buffer_store_dwordx4 v[216:219], v206, s[36:39], s71 offen sc1
    v_mfma_f32_16x16x32_bf16 v[172:175], v[20:23], v[148:151], v[172:175]
    ds_read_b64_tr_b16 v[6:7], v233 offset:25088
    v_cvt_pk_bf16_f32 v48, v48, v49
    v_mfma_f32_16x16x32_bf16 v[176:179], v[24:27], v[144:147], v[176:179]
    ds_read_b64_tr_b16 v[8:9], v232 offset:25600
    v_cvt_pk_bf16_f32 v49, v50, v51
    v_mfma_f32_16x16x32_bf16 v[180:183], v[24:27], v[148:151], v[180:183]
    ds_read_b64_tr_b16 v[10:11], v232 offset:26112
    v_cvt_pk_bf16_f32 v50, v52, v53
    v_mfma_f32_16x16x32_bf16 v[184:187], v[28:31], v[144:147], v[184:187]
    ds_read_b64_tr_b16 v[12:13], v233 offset:25600
    v_cvt_pk_bf16_f32 v51, v54, v55
    v_mfma_f32_16x16x32_bf16 v[188:191], v[28:31], v[148:151], v[188:191]
    ds_read_b64_tr_b16 v[14:15], v233 offset:26112
    s_xor_b32 s71, s81, 131072
    s_waitcnt vmcnt(19)
    s_waitcnt lgkmcnt(7)
    v_mfma_f32_16x16x32_bf16 v[160:163], v[32:35], v[152:155], v[160:163]
    ds_read_b64_tr_b16 v[16:17], v232 offset:32768
    v_mfma_f32_16x16x32_bf16 v[164:167], v[32:35], v[156:159], v[164:167]
    ds_read_b64_tr_b16 v[18:19], v232 offset:33280
    buffer_store_dwordx4 v[48:51], v206, s[36:39], s71 offen sc1
    v_mfma_f32_16x16x32_bf16 v[168:171], v[36:39], v[152:155], v[168:171]
    ds_read_b64_tr_b16 v[20:21], v233 offset:32768
    v_cvt_pk_bf16_f32 v56, v56, v57
    v_mfma_f32_16x16x32_bf16 v[172:175], v[36:39], v[156:159], v[172:175]
    ds_read_b64_tr_b16 v[22:23], v233 offset:33280
    v_cvt_pk_bf16_f32 v57, v58, v59
    v_mfma_f32_16x16x32_bf16 v[176:179], v[40:43], v[152:155], v[176:179]
    ds_read_b64_tr_b16 v[24:25], v232 offset:33792
    v_cvt_pk_bf16_f32 v58, v60, v61
    v_mfma_f32_16x16x32_bf16 v[180:183], v[40:43], v[156:159], v[180:183]
    ds_read_b64_tr_b16 v[26:27], v232 offset:34304
    v_cvt_pk_bf16_f32 v59, v62, v63
    v_mfma_f32_16x16x32_bf16 v[184:187], v[44:47], v[152:155], v[184:187]
    ds_read_b64_tr_b16 v[28:29], v233 offset:33792
    s_xor_b32 s71, s81, 196608
    v_mfma_f32_16x16x32_bf16 v[188:191], v[44:47], v[156:159], v[188:191]
    ds_read_b64_tr_b16 v[30:31], v233 offset:34304
    buffer_store_dwordx4 v[56:59], v206, s[36:39], s71 offen sc1
    s_waitcnt lgkmcnt(7)
    v_mfma_f32_16x16x32_bf16 v[208:211], v[0:3], a[8:11], 0
    s_waitcnt vmcnt(16)
    s_barrier
    v_mfma_f32_16x16x32_bf16 v[212:215], v[0:3], a[12:15], 0
    ds_read_b64_tr_b16 v[32:33], v228 offset:4096
    s_add_u32 m0, s1, 98304
    v_mfma_f32_16x16x32_bf16 v[216:219], v[4:7], a[8:11], 0
    ds_read_b64_tr_b16 v[34:35], v228 offset:4608
    s_add_u32 s66, s29, s99
    v_mfma_f32_16x16x32_bf16 v[220:223], v[4:7], a[12:15], 0
    ds_read_b64_tr_b16 v[36:37], v229 offset:4096
    s_add_u32 s66, s66, 73728
    v_mfma_f32_16x16x32_bf16 v[208:211], v[8:11], a[24:27], v[208:211]
    ds_read_b64_tr_b16 v[38:39], v229 offset:4608
    buffer_load_dwordx4 v112, s[20:23], s66 offen offset:0 lds
    v_mfma_f32_16x16x32_bf16 v[212:215], v[8:11], a[28:31], v[212:215]
    ds_read_b64_tr_b16 v[40:41], v228 offset:5120
    v_mfma_f32_16x16x32_bf16 v[216:219], v[12:15], a[24:27], v[216:219]
    ds_read_b64_tr_b16 v[42:43], v228 offset:5632
    buffer_load_dwordx4 v113, s[20:23], s66 offen offset:1024 lds
    v_mfma_f32_16x16x32_bf16 v[220:223], v[12:15], a[28:31], v[220:223]
    ds_read_b64_tr_b16 v[44:45], v229 offset:5120
    ds_read_b64_tr_b16 v[46:47], v229 offset:5632
    s_waitcnt lgkmcnt(8)
    v_mfma_f32_16x16x32_bf16 v[208:211], v[16:19], a[40:43], v[208:211]
    ds_read_b64_tr_b16 v[0:1], v228 offset:12288
    v_mfma_f32_16x16x32_bf16 v[212:215], v[16:19], a[44:47], v[212:215]
    ds_read_b64_tr_b16 v[2:3], v228 offset:12800
    v_cvt_pk_bf16_f32 v160, v160, v161
    v_mfma_f32_16x16x32_bf16 v[216:219], v[20:23], a[40:43], v[216:219]
    ds_read_b64_tr_b16 v[4:5], v229 offset:12288
    buffer_load_dwordx4 v114, s[20:23], s66 offen offset:2048 lds
    v_mfma_f32_16x16x32_bf16 v[220:223], v[20:23], a[44:47], v[220:223]
    ds_read_b64_tr_b16 v[6:7], v229 offset:12800
    v_cvt_pk_bf16_f32 v161, v162, v163
    v_mfma_f32_16x16x32_bf16 v[208:211], v[24:27], a[56:59], v[208:211]
    ds_read_b64_tr_b16 v[8:9], v228 offset:13312
    v_cvt_pk_bf16_f32 v162, v168, v169
    v_mfma_f32_16x16x32_bf16 v[212:215], v[24:27], a[60:63], v[212:215]
    ds_read_b64_tr_b16 v[10:11], v228 offset:13824
    v_cvt_pk_bf16_f32 v163, v170, v171
    v_mfma_f32_16x16x32_bf16 v[216:219], v[28:31], a[56:59], v[216:219]
    ds_read_b64_tr_b16 v[12:13], v229 offset:13312
    buffer_load_dwordx4 v115, s[20:23], s66 offen offset:3072 lds
    v_mfma_f32_16x16x32_bf16 v[220:223], v[28:31], a[60:63], v[220:223]
    ds_read_b64_tr_b16 v[14:15], v229 offset:13824
    s_add_u32 m0, s1, 114688
    s_waitcnt lgkmcnt(7)
    v_mfma_f32_16x16x32_bf16 v[208:211], v[32:35], a[72:75], v[208:211]
    ds_read_b64_tr_b16 v[16:17], v224 offset:0
    v_mfma_f32_16x16x32_bf16 v[212:215], v[32:35], a[76:79], v[212:215]
    ds_read_b64_tr_b16 v[18:19], v224 offset:512
    s_add_u32 m0, m0, s95
    v_mfma_f32_16x16x32_bf16 v[216:219], v[36:39], a[72:75], v[216:219]
    ds_read_b64_tr_b16 v[20:21], v225 offset:0
    s_add_u32 s66, s97, s99
    v_mfma_f32_16x16x32_bf16 v[220:223], v[36:39], a[76:79], v[220:223]
    ds_read_b64_tr_b16 v[22:23], v225 offset:512
    buffer_load_dwordx4 v112, s[20:23], s66 offen offset:0 lds
    v_mfma_f32_16x16x32_bf16 v[208:211], v[40:43], a[88:91], v[208:211]
    ds_read_b64_tr_b16 v[24:25], v224 offset:1024
    buffer_store_dwordx4 v[160:163], v250, s[36:39], s44 offen offset:0 sc1
    v_mfma_f32_16x16x32_bf16 v[212:215], v[40:43], a[92:95], v[212:215]
    ds_read_b64_tr_b16 v[26:27], v224 offset:1536
    v_cvt_pk_bf16_f32 v164, v164, v165
    v_mfma_f32_16x16x32_bf16 v[216:219], v[44:47], a[88:91], v[216:219]
    ds_read_b64_tr_b16 v[28:29], v225 offset:1024
    v_cvt_pk_bf16_f32 v165, v166, v167
    v_mfma_f32_16x16x32_bf16 v[220:223], v[44:47], a[92:95], v[220:223]
    ds_read_b64_tr_b16 v[30:31], v225 offset:1536
    v_cvt_pk_bf16_f32 v166, v172, v173
    s_waitcnt lgkmcnt(7)
    v_mfma_f32_16x16x32_bf16 v[208:211], v[0:3], a[104:107], v[208:211]
    ds_read_b64_tr_b16 v[32:33], v224 offset:8192
    v_mfma_f32_16x16x32_bf16 v[212:215], v[0:3], a[108:111], v[212:215]
    ds_read_b64_tr_b16 v[34:35], v224 offset:8704
    v_cvt_pk_bf16_f32 v167, v174, v175
    v_mfma_f32_16x16x32_bf16 v[216:219], v[4:7], a[104:107], v[216:219]
    ds_read_b64_tr_b16 v[36:37], v225 offset:8192
    buffer_load_dwordx4 v114, s[20:23], s66 offen offset:2048 lds
    v_mfma_f32_16x16x32_bf16 v[220:223], v[4:7], a[108:111], v[220:223]
    ds_read_b64_tr_b16 v[38:39], v225 offset:8704
    buffer_store_dwordx4 v[164:167], v250, s[36:39], s44 offen offset:1024 sc1
    v_mfma_f32_16x16x32_bf16 v[208:211], v[8:11], a[120:123], v[208:211]
    ds_read_b64_tr_b16 v[40:41], v224 offset:9216
    v_cvt_pk_bf16_f32 v176, v176, v177
    v_mfma_f32_16x16x32_bf16 v[212:215], v[8:11], a[124:127], v[212:215]
    ds_read_b64_tr_b16 v[42:43], v224 offset:9728
    v_cvt_pk_bf16_f32 v177, v178, v179
    v_mfma_f32_16x16x32_bf16 v[216:219], v[12:15], a[120:123], v[216:219]
    ds_read_b64_tr_b16 v[44:45], v225 offset:9216
    v_cvt_pk_bf16_f32 v178, v184, v185
    v_mfma_f32_16x16x32_bf16 v[220:223], v[12:15], a[124:127], v[220:223]
    ds_read_b64_tr_b16 v[46:47], v225 offset:9728
    v_cvt_pk_bf16_f32 v179, v186, v187
    s_waitcnt lgkmcnt(7)
    v_mfma_f32_16x16x32_bf16 v[208:211], v[16:19], a[136:139], v[208:211]
    ds_read_b64_tr_b16 v[0:1], v224 offset:16384
    v_mfma_f32_16x16x32_bf16 v[212:215], v[16:19], a[140:143], v[212:215]
    ds_read_b64_tr_b16 v[2:3], v224 offset:16896
    s_sub_u32 m0, m0, s95
    v_mfma_f32_16x16x32_bf16 v[216:219], v[20:23], a[136:139], v[216:219]
    ds_read_b64_tr_b16 v[4:5], v225 offset:16384
    s_sub_u32 m0, m0, s95
    v_mfma_f32_16x16x32_bf16 v[220:223], v[20:23], a[140:143], v[220:223]
    ds_read_b64_tr_b16 v[6:7], v225 offset:16896
    s_nop 0
    v_mfma_f32_16x16x32_bf16 v[208:211], v[24:27], a[152:155], v[208:211]
    ds_read_b64_tr_b16 v[8:9], v224 offset:17408
    buffer_load_dwordx4 v113, s[20:23], s66 offen offset:1024 lds
    v_mfma_f32_16x16x32_bf16 v[212:215], v[24:27], a[156:159], v[212:215]
    ds_read_b64_tr_b16 v[10:11], v224 offset:17920
    buffer_store_dwordx4 v[176:179], v250, s[36:39], s45 offen offset:0 sc1
    v_mfma_f32_16x16x32_bf16 v[216:219], v[28:31], a[152:155], v[216:219]
    ds_read_b64_tr_b16 v[12:13], v225 offset:17408
    v_cvt_pk_bf16_f32 v180, v180, v181
    v_mfma_f32_16x16x32_bf16 v[220:223], v[28:31], a[156:159], v[220:223]
    ds_read_b64_tr_b16 v[14:15], v225 offset:17920
    v_cvt_pk_bf16_f32 v181, v182, v183
    s_waitcnt lgkmcnt(7)
    v_mfma_f32_16x16x32_bf16 v[208:211], v[32:35], a[168:171], v[208:211]
    ds_read_b64_tr_b16 v[16:17], v224 offset:24576
    v_mfma_f32_16x16x32_bf16 v[212:215], v[32:35], a[172:175], v[212:215]
    ds_read_b64_tr_b16 v[18:19], v224 offset:25088
    v_cvt_pk_bf16_f32 v182, v188, v189
    v_mfma_f32_16x16x32_bf16 v[216:219], v[36:39], a[168:171], v[216:219]
    ds_read_b64_tr_b16 v[20:21], v225 offset:24576
    v_cvt_pk_bf16_f32 v183, v190, v191
    v_mfma_f32_16x16x32_bf16 v[220:223], v[36:39], a[172:175], v[220:223]
    ds_read_b64_tr_b16 v[22:23], v225 offset:25088
    buffer_store_dwordx4 v[180:183], v250, s[36:39], s45 offen offset:1024 sc1
    v_mfma_f32_16x16x32_bf16 v[208:211], v[40:43], a[184:187], v[208:211]
    ds_read_b64_tr_b16 v[24:25], v224 offset:25600
    v_and_b32 v246, 1, v252
    v_mfma_f32_16x16x32_bf16 v[212:215], v[40:43], a[188:191], v[212:215]
    ds_read_b64_tr_b16 v[26:27], v224 offset:26112
    v_lshlrev_b32 v246, 4, v246
    v_mfma_f32_16x16x32_bf16 v[216:219], v[44:47], a[184:187], v[216:219]
    ds_read_b64_tr_b16 v[28:29], v225 offset:25600
    v_xor_b32 v246, 16, v246
    v_mfma_f32_16x16x32_bf16 v[220:223], v[44:47], a[188:191], v[220:223]
    ds_read_b64_tr_b16 v[30:31], v225 offset:26112
    v_lshl_add_u32 v254, v252, 3, s10
    s_waitcnt lgkmcnt(7)
    v_mfma_f32_16x16x32_bf16 v[208:211], v[0:3], a[200:203], v[208:211]
    s_waitcnt vmcnt(15)
    s_barrier
    v_mfma_f32_16x16x32_bf16 v[212:215], v[0:3], a[204:207], v[212:215]
    ds_read_b64_tr_b16 v[32:33], v224 offset:32768
    s_sub_u32 s71, s10, s3
    v_mfma_f32_16x16x32_bf16 v[216:219], v[4:7], a[200:203], v[216:219]
    ds_read_b64_tr_b16 v[34:35], v224 offset:33280
    buffer_load_dwordx4 v115, s[20:23], s66 offen offset:3072 lds
    v_mfma_f32_16x16x32_bf16 v[220:223], v[4:7], a[204:207], v[220:223]
    ds_read_b64_tr_b16 v[36:37], v225 offset:32768
    v_add_u32 v251, s71, v250
    v_mfma_f32_16x16x32_bf16 v[208:211], v[8:11], a[216:219], v[208:211]
    ds_read_b64_tr_b16 v[38:39], v225 offset:33280
    buffer_load_dword v207, v248, s[36:39], s69 offen offset:4 sc1
    v_mfma_f32_16x16x32_bf16 v[212:215], v[8:11], a[220:223], v[212:215]
    ds_read_b64_tr_b16 v[40:41], v224 offset:33792
    v_mfma_f32_16x16x32_bf16 v[216:219], v[12:15], a[216:219], v[216:219]
    ds_read_b64_tr_b16 v[42:43], v224 offset:34304
    v_mfma_f32_16x16x32_bf16 v[220:223], v[12:15], a[220:223], v[220:223]
    ds_read_b64_tr_b16 v[44:45], v225 offset:33792
    ds_read_b64_tr_b16 v[46:47], v225 offset:34304
    s_waitcnt lgkmcnt(8)
    v_mfma_f32_16x16x32_bf16 v[208:211], v[16:19], a[232:235], v[208:211]
    ds_read_b64_tr_b16 v[0:1], v224 offset:40960
    v_mfma_f32_16x16x32_bf16 v[212:215], v[16:19], a[236:239], v[212:215]
    ds_read_b64_tr_b16 v[2:3], v224 offset:41472
    v_mov_b32 v177, 1
    v_mfma_f32_16x16x32_bf16 v[216:219], v[20:23], a[232:235], v[216:219]
    ds_read_b64_tr_b16 v[4:5], v225 offset:40960
    s_and_b32 s71, s2, 0x1e
    v_mfma_f32_16x16x32_bf16 v[220:223], v[20:23], a[236:239], v[220:223]
    ds_read_b64_tr_b16 v[6:7], v225 offset:41472
    s_lshl_b32 s71, s71, 3
    v_mfma_f32_16x16x32_bf16 v[208:211], v[24:27], a[248:251], v[208:211]
    ds_read_b64_tr_b16 v[8:9], v224 offset:41984
    s_add_u32 s71, s71, s43
    v_mfma_f32_16x16x32_bf16 v[212:215], v[24:27], a[252:255], v[212:215]
    ds_read_b64_tr_b16 v[10:11], v224 offset:42496
    s_waitcnt vmcnt(2)
    buffer_store_dword v177, off, s[36:39], s71 sc1
    v_mfma_f32_16x16x32_bf16 v[216:219], v[28:31], a[248:251], v[216:219]
    ds_read_b64_tr_b16 v[12:13], v225 offset:41984
    v_and_b32 v176, 15, v252
    v_mfma_f32_16x16x32_bf16 v[220:223], v[28:31], a[252:255], v[220:223]
    ds_read_b64_tr_b16 v[14:15], v225 offset:42496
    v_lshlrev_b32 v176, 4, v176
    s_waitcnt lgkmcnt(7)
    v_mfma_f32_16x16x32_bf16 v[208:211], v[32:35], a[0:3], v[208:211]
    ds_read_b64_tr_b16 v[16:17], v224 offset:49152
    v_mfma_f32_16x16x32_bf16 v[212:215], v[32:35], a[4:7], v[212:215]
    ds_read_b64_tr_b16 v[18:19], v224 offset:49664
    v_mfma_f32_16x16x32_bf16 v[216:219], v[36:39], a[0:3], v[216:219]
    ds_read_b64_tr_b16 v[20:21], v225 offset:49152
    v_mfma_f32_16x16x32_bf16 v[220:223], v[36:39], a[4:7], v[220:223]
    ds_read_b64_tr_b16 v[22:23], v225 offset:49664
    v_mfma_f32_16x16x32_bf16 v[208:211], v[40:43], a[16:19], v[208:211]
    ds_read_b64_tr_b16 v[24:25], v224 offset:50176
    v_mfma_f32_16x16x32_bf16 v[212:215], v[40:43], a[20:23], v[212:215]
    ds_read_b64_tr_b16 v[26:27], v224 offset:50688
    v_mfma_f32_16x16x32_bf16 v[216:219], v[44:47], a[16:19], v[216:219]
    ds_read_b64_tr_b16 v[28:29], v225 offset:50176
    v_mfma_f32_16x16x32_bf16 v[220:223], v[44:47], a[20:23], v[220:223]
    ds_read_b64_tr_b16 v[30:31], v225 offset:50688
    s_waitcnt lgkmcnt(7)
    v_mfma_f32_16x16x32_bf16 v[208:211], v[0:3], a[32:35], v[208:211]
    ds_read_b64_tr_b16 v[32:33], v224 offset:57344
    v_mfma_f32_16x16x32_bf16 v[212:215], v[0:3], a[36:39], v[212:215]
    ds_read_b64_tr_b16 v[34:35], v224 offset:57856
    s_waitcnt vmcnt(1)
    v_mfma_f32_16x16x32_bf16 v[216:219], v[4:7], a[32:35], v[216:219]
    ds_read_b64_tr_b16 v[36:37], v225 offset:57344
    v_cmp_le_u32 vcc, 1, v207
    s_cmp_eq_u64 vcc, exec
    s_cbranch_scc0 gated_mix__ssm_conv_s4__glu_gated_bilinear__prompt_kernel_slow7
gated_mix__ssm_conv_s4__glu_gated_bilinear__prompt_kernel_back7:
    v_mfma_f32_16x16x32_bf16 v[220:223], v[4:7], a[36:39], v[220:223]
    ds_read_b64_tr_b16 v[38:39], v225 offset:57856
    buffer_load_dwordx4 v[200:203], v249, s[36:39], s60 offen offset:0 sc1
    v_mfma_f32_16x16x32_bf16 v[208:211], v[8:11], a[48:51], v[208:211]
    ds_read_b64_tr_b16 v[40:41], v224 offset:58368
    buffer_load_dwordx4 v[80:83], v249, s[36:39], s60 offen offset:32 sc1
    v_mfma_f32_16x16x32_bf16 v[212:215], v[8:11], a[52:55], v[212:215]
    ds_read_b64_tr_b16 v[42:43], v224 offset:58880
    buffer_load_dword v88, v242, s[36:39], s61 offen sc1
    v_mfma_f32_16x16x32_bf16 v[216:219], v[12:15], a[48:51], v[216:219]
    ds_read_b64_tr_b16 v[44:45], v225 offset:58368
    buffer_load_dword v90, v242, s[36:39], s61 offen offset:64 sc1
    v_mfma_f32_16x16x32_bf16 v[220:223], v[12:15], a[52:55], v[220:223]
    ds_read_b64_tr_b16 v[46:47], v225 offset:58880
    buffer_load_dword v92, v243, s[36:39], s61 offen sc1
    s_waitcnt lgkmcnt(7)
    v_mfma_f32_16x16x32_bf16 v[208:211], v[16:19], a[64:67], v[208:211]
    ds_read_b64_tr_b16 v[0:1], v228 offset:20480
    v_mfma_f32_16x16x32_bf16 v[212:215], v[16:19], a[68:71], v[212:215]
    ds_read_b64_tr_b16 v[2:3], v228 offset:20992
    buffer_load_dword v94, v244, s[36:39], s64 offen sc1
    v_mfma_f32_16x16x32_bf16 v[216:219], v[20:23], a[64:67], v[216:219]
    ds_read_b64_tr_b16 v[4:5], v229 offset:20480
    buffer_load_dword v95, v244, s[36:39], s30 offen sc1
    v_mfma_f32_16x16x32_bf16 v[220:223], v[20:23], a[68:71], v[220:223]
    ds_read_b64_tr_b16 v[6:7], v229 offset:20992
    v_mfma_f32_16x16x32_bf16 v[208:211], v[24:27], a[80:83], v[208:211]
    ds_read_b64_tr_b16 v[8:9], v228 offset:21504
    v_mfma_f32_16x16x32_bf16 v[212:215], v[24:27], a[84:87], v[212:215]
    ds_read_b64_tr_b16 v[10:11], v228 offset:22016
    v_mfma_f32_16x16x32_bf16 v[216:219], v[28:31], a[80:83], v[216:219]
    ds_read_b64_tr_b16 v[12:13], v229 offset:21504
    v_mfma_f32_16x16x32_bf16 v[220:223], v[28:31], a[84:87], v[220:223]
    ds_read_b64_tr_b16 v[14:15], v229 offset:22016
    s_waitcnt lgkmcnt(7)
    v_mfma_f32_16x16x32_bf16 v[208:211], v[32:35], a[96:99], v[208:211]
    ds_read_b64_tr_b16 v[16:17], v228 offset:28672
    v_mfma_f32_16x16x32_bf16 v[212:215], v[32:35], a[100:103], v[212:215]
    ds_read_b64_tr_b16 v[18:19], v228 offset:29184
    v_mfma_f32_16x16x32_bf16 v[216:219], v[36:39], a[96:99], v[216:219]
    ds_read_b64_tr_b16 v[20:21], v229 offset:28672
    v_mfma_f32_16x16x32_bf16 v[220:223], v[36:39], a[100:103], v[220:223]
    ds_read_b64_tr_b16 v[22:23], v229 offset:29184
    v_mfma_f32_16x16x32_bf16 v[208:211], v[40:43], a[112:115], v[208:211]
    ds_read_b64_tr_b16 v[24:25], v228 offset:29696
    v_mfma_f32_16x16x32_bf16 v[212:215], v[40:43], a[116:119], v[212:215]
    ds_read_b64_tr_b16 v[26:27], v228 offset:30208
    v_mfma_f32_16x16x32_bf16 v[216:219], v[44:47], a[112:115], v[216:219]
    ds_read_b64_tr_b16 v[28:29], v229 offset:29696
    v_mfma_f32_16x16x32_bf16 v[220:223], v[44:47], a[116:119], v[220:223]
    ds_read_b64_tr_b16 v[30:31], v229 offset:30208
    s_waitcnt lgkmcnt(7)
    v_mfma_f32_16x16x32_bf16 v[208:211], v[0:3], a[128:131], v[208:211]
    s_barrier
    v_mfma_f32_16x16x32_bf16 v[212:215], v[0:3], a[132:135], v[212:215]
    ds_read_b64_tr_b16 v[32:33], v228 offset:36864
    v_mfma_f32_16x16x32_bf16 v[216:219], v[4:7], a[128:131], v[216:219]
    ds_read_b64_tr_b16 v[34:35], v228 offset:37376
    v_mfma_f32_16x16x32_bf16 v[220:223], v[4:7], a[132:135], v[220:223]
    ds_read_b64_tr_b16 v[36:37], v229 offset:36864
    v_mfma_f32_16x16x32_bf16 v[208:211], v[8:11], a[144:147], v[208:211]
    ds_read_b64_tr_b16 v[38:39], v229 offset:37376
    v_mfma_f32_16x16x32_bf16 v[212:215], v[8:11], a[148:151], v[212:215]
    ds_read_b64_tr_b16 v[40:41], v228 offset:37888
    v_mfma_f32_16x16x32_bf16 v[216:219], v[12:15], a[144:147], v[216:219]
    ds_read_b64_tr_b16 v[42:43], v228 offset:38400
    v_mfma_f32_16x16x32_bf16 v[220:223], v[12:15], a[148:151], v[220:223]
    ds_read_b64_tr_b16 v[44:45], v229 offset:37888
    ds_read_b64_tr_b16 v[46:47], v229 offset:38400
    s_waitcnt lgkmcnt(8)
    v_mfma_f32_16x16x32_bf16 v[208:211], v[16:19], a[160:163], v[208:211]
    ds_read_b64_tr_b16 v[0:1], v228 offset:45056
    v_mfma_f32_16x16x32_bf16 v[212:215], v[16:19], a[164:167], v[212:215]
    ds_read_b64_tr_b16 v[2:3], v228 offset:45568
    s_waitcnt vmcnt(6)
    ds_write_b128 v251, v[200:203] offset:0
    v_mfma_f32_16x16x32_bf16 v[216:219], v[20:23], a[160:163], v[216:219]
    ds_read_b64_tr_b16 v[4:5], v229 offset:45056
    s_waitcnt vmcnt(5)
    ds_write_b128 v251, v[80:83] offset:1024
    v_mfma_f32_16x16x32_bf16 v[220:223], v[20:23], a[164:167], v[220:223]
    ds_read_b64_tr_b16 v[6:7], v229 offset:45568
    buffer_load_dword v178, v176, s[36:39], s43 offen sc1
    v_mfma_f32_16x16x32_bf16 v[208:211], v[24:27], a[176:179], v[208:211]
    ds_read_b64_tr_b16 v[8:9], v228 offset:46080
    s_waitcnt vmcnt(1)
    v_sub_f32 v89, 1.0, v88
    v_mfma_f32_16x16x32_bf16 v[212:215], v[24:27], a[180:183], v[212:215]
    ds_read_b64_tr_b16 v[10:11], v228 offset:46592
    v_sub_f32 v91, 1.0, v90
    v_mfma_f32_16x16x32_bf16 v[216:219], v[28:31], a[176:179], v[216:219]
    ds_read_b64_tr_b16 v[12:13], v229 offset:46080
    v_sub_f32 v93, 1.0, v92
    v_mfma_f32_16x16x32_bf16 v[220:223], v[28:31], a[180:183], v[220:223]
    ds_read_b64_tr_b16 v[14:15], v229 offset:46592
    v_cvt_pk_bf16_f32 v89, 0, v89
    s_waitcnt lgkmcnt(9)
    v_mfma_f32_16x16x32_bf16 v[208:211], v[32:35], a[192:195], v[208:211]
    ds_read_b64_tr_b16 v[16:17], v228 offset:53248
    v_mfma_f32_16x16x32_bf16 v[212:215], v[32:35], a[196:199], v[212:215]
    ds_read_b64_tr_b16 v[18:19], v228 offset:53760
    v_cvt_pk_bf16_f32 v91, 0, v91
    v_mfma_f32_16x16x32_bf16 v[216:219], v[36:39], a[192:195], v[216:219]
    ds_read_b64_tr_b16 v[20:21], v229 offset:53248
    v_cvt_pk_bf16_f32 v93, 0, v93
    v_mfma_f32_16x16x32_bf16 v[220:223], v[36:39], a[196:199], v[220:223]
    ds_read_b64_tr_b16 v[22:23], v229 offset:53760
    v_mfma_f32_16x16x32_bf16 v[208:211], v[40:43], a[208:211], v[208:211]
    ds_read_b64_tr_b16 v[24:25], v228 offset:54272
    v_mfma_f32_16x16x32_bf16 v[212:215], v[40:43], a[212:215], v[212:215]
    ds_read_b64_tr_b16 v[26:27], v228 offset:54784
    v_mfma_f32_16x16x32_bf16 v[216:219], v[44:47], a[208:211], v[216:219]
    ds_read_b64_tr_b16 v[28:29], v229 offset:54272
    s_waitcnt lgkmcnt(7)
    ds_read_b64_tr_b16 v[200:201], v254 offset:0
    v_mfma_f32_16x16x32_bf16 v[220:223], v[44:47], a[212:215], v[220:223]
    ds_read_b64_tr_b16 v[30:31], v229 offset:54784
    ds_read_b64_tr_b16 v[202:203], v254 offset:512
    v_mfma_f32_16x16x32_bf16 v[208:211], v[0:3], a[224:227], v[208:211]
    ds_read_b64_tr_b16 v[32:33], v232 offset:0
    ds_read_b64_tr_b16 v[80:81], v254 offset:1024
    v_mfma_f32_16x16x32_bf16 v[212:215], v[0:3], a[228:231], v[212:215]
    ds_read_b64_tr_b16 v[34:35], v232 offset:512
    ds_read_b64_tr_b16 v[82:83], v254 offset:1536
    v_mfma_f32_16x16x32_bf16 v[216:219], v[4:7], a[224:227], v[216:219]
    ds_read_b64_tr_b16 v[36:37], v233 offset:0
    v_lshlrev_b32 v94, v246, v94
    v_mfma_f32_16x16x32_bf16 v[220:223], v[4:7], a[228:231], v[220:223]
    ds_read_b64_tr_b16 v[38:39], v233 offset:512
    v_and_b32 v94, s31, v94
    v_mfma_f32_16x16x32_bf16 v[208:211], v[8:11], a[240:243], v[208:211]
    ds_read_b64_tr_b16 v[40:41], v232 offset:1024
    v_mul_f32 v94, v94, v92
    v_mfma_f32_16x16x32_bf16 v[212:215], v[8:11], a[244:247], v[212:215]
    ds_read_b64_tr_b16 v[42:43], v232 offset:1536
    v_cvt_pk_bf16_f32 v94, 0, v94
    v_mfma_f32_16x16x32_bf16 v[216:219], v[12:15], a[240:243], v[216:219]
    ds_read_b64_tr_b16 v[44:45], v233 offset:1024
    v_lshlrev_b32 v95, v246, v95
    v_mfma_f32_16x16x32_bf16 v[220:223], v[12:15], a[244:247], v[220:223]
    ds_read_b64_tr_b16 v[46:47], v233 offset:1536
    v_and_b32 v95, s31, v95
    s_waitcnt lgkmcnt(9)
    v_mfma_f32_16x16x32_bf16 v[208:211], v[16:19], v[128:131], v[208:211]
    ds_read_b64_tr_b16 v[0:1], v234 offset:24576
    v_mfma_f32_16x16x32_bf16 v[212:215], v[16:19], v[132:135], v[212:215]
    ds_read_b64_tr_b16 v[2:3], v234 offset:25088
    v_mul_f32 v95, v95, v92
    v_mfma_f32_16x16x32_bf16 v[216:219], v[20:23], v[128:131], v[216:219]
    ds_read_b64_tr_b16 v[4:5], v235 offset:24576
    v_cvt_pk_bf16_f32 v95, 0, v95
    v_mfma_f32_16x16x32_bf16 v[220:223], v[20:23], v[132:135], v[220:223]
    ds_read_b64_tr_b16 v[6:7], v235 offset:25088
    v_lshlrev_b32 v64, 16, v200
    v_mfma_f32_16x16x32_bf16 v[208:211], v[24:27], v[136:139], v[208:211]
    ds_read_b64_tr_b16 v[8:9], v234 offset:25600
    v_and_b32 v65, s31, v200
    v_mfma_f32_16x16x32_bf16 v[212:215], v[24:27], v[140:143], v[212:215]
    ds_read_b64_tr_b16 v[10:11], v234 offset:26112
    v_lshlrev_b32 v66, 16, v201
    v_mfma_f32_16x16x32_bf16 v[216:219], v[28:31], v[136:139], v[216:219]
    ds_read_b64_tr_b16 v[12:13], v235 offset:25600
    v_and_b32 v67, s31, v201
    v_mfma_f32_16x16x32_bf16 v[220:223], v[28:31], v[140:143], v[220:223]
    ds_read_b64_tr_b16 v[14:15], v235 offset:26112
    v_lshlrev_b32 v68, 16, v202
    s_waitcnt lgkmcnt(7)
    v_mfma_f32_16x16x32_bf16 v[208:211], v[32:35], v[144:147], v[208:211]
    ds_read_b64_tr_b16 v[16:17], v234 offset:32768
    v_mfma_f32_16x16x32_bf16 v[212:215], v[32:35], v[148:151], v[212:215]
    ds_read_b64_tr_b16 v[18:19], v234 offset:33280
    v_and_b32 v69, s31, v202
    v_mfma_f32_16x16x32_bf16 v[216:219], v[36:39], v[144:147], v[216:219]
    ds_read_b64_tr_b16 v[20:21], v235 offset:32768
    v_lshlrev_b32 v70, 16, v203
    v_mfma_f32_16x16x32_bf16 v[220:223], v[36:39], v[148:151], v[220:223]
    ds_read_b64_tr_b16 v[22:23], v235 offset:33280
    v_and_b32 v71, s31, v203
    v_mfma_f32_16x16x32_bf16 v[208:211], v[40:43], v[152:155], v[208:211]
    ds_read_b64_tr_b16 v[24:25], v234 offset:33792
    v_pk_mul_f32 v[64:65], v[64:65], v[88:89] op_sel_hi:[1,0]
    v_mfma_f32_16x16x32_bf16 v[212:215], v[40:43], v[156:159], v[212:215]
    ds_read_b64_tr_b16 v[26:27], v234 offset:34304
    v_pk_mul_f32 v[66:67], v[66:67], v[88:89] op_sel_hi:[1,0]
    v_mfma_f32_16x16x32_bf16 v[216:219], v[44:47], v[152:155], v[216:219]
    ds_read_b64_tr_b16 v[28:29], v235 offset:33792
    v_pk_mul_f32 v[68:69], v[68:69], v[88:89] op_sel_hi:[1,0]
    v_mfma_f32_16x16x32_bf16 v[220:223], v[44:47], v[156:159], v[220:223]
    ds_read_b64_tr_b16 v[30:31], v235 offset:34304
    v_pk_mul_f32 v[70:71], v[70:71], v[88:89] op_sel_hi:[1,0]
    s_waitcnt lgkmcnt(7)
    v_mfma_f32_16x16x32_bf16 v[48:51], v[0:3], a[8:11], 0
    ds_read_b64_tr_b16 v[32:33], v230 offset:4096
    v_mfma_f32_16x16x32_bf16 v[52:55], v[0:3], a[12:15], 0
    ds_read_b64_tr_b16 v[34:35], v230 offset:4608
    v_cvt_pk_bf16_f32 v64, 0, v64
    v_mfma_f32_16x16x32_bf16 v[56:59], v[4:7], a[8:11], 0
    ds_read_b64_tr_b16 v[36:37], v231 offset:4096
    v_cvt_pk_bf16_f32 v65, 0, v65
    v_mfma_f32_16x16x32_bf16 v[60:63], v[4:7], a[12:15], 0
    ds_read_b64_tr_b16 v[38:39], v231 offset:4608
    v_cvt_pk_bf16_f32 v66, 0, v66
    v_mfma_f32_16x16x32_bf16 v[48:51], v[8:11], a[24:27], v[48:51]
    ds_read_b64_tr_b16 v[40:41], v230 offset:5120
    v_cvt_pk_bf16_f32 v67, 0, v67
    v_mfma_f32_16x16x32_bf16 v[52:55], v[8:11], a[28:31], v[52:55]
    ds_read_b64_tr_b16 v[42:43], v230 offset:5632
    v_cvt_pk_bf16_f32 v68, 0, v68
    v_mfma_f32_16x16x32_bf16 v[56:59], v[12:15], a[24:27], v[56:59]
    ds_read_b64_tr_b16 v[44:45], v231 offset:5120
    v_cvt_pk_bf16_f32 v69, 0, v69
    v_mfma_f32_16x16x32_bf16 v[60:63], v[12:15], a[28:31], v[60:63]
    ds_read_b64_tr_b16 v[46:47], v231 offset:5632
    v_cvt_pk_bf16_f32 v70, 0, v70
    s_waitcnt lgkmcnt(7)
    v_mfma_f32_16x16x32_bf16 v[48:51], v[16:19], a[40:43], v[48:51]
    ds_read_b64_tr_b16 v[0:1], v230 offset:12288
    v_mfma_f32_16x16x32_bf16 v[52:55], v[16:19], a[44:47], v[52:55]
    ds_read_b64_tr_b16 v[2:3], v230 offset:12800
    s_waitcnt vmcnt(0)
    v_mfma_f32_16x16x32_bf16 v[56:59], v[20:23], a[40:43], v[56:59]
    ds_read_b64_tr_b16 v[4:5], v231 offset:12288
    v_cmp_eq_u32 vcc, 1, v178
    s_cmp_eq_u64 vcc, exec
    s_cbranch_scc0 gated_mix__ssm_conv_s4__glu_gated_bilinear__prompt_kernel_slow6
gated_mix__ssm_conv_s4__glu_gated_bilinear__prompt_kernel_back6:
    v_mfma_f32_16x16x32_bf16 v[60:63], v[20:23], a[44:47], v[60:63]
    ds_read_b64_tr_b16 v[6:7], v231 offset:12800
    v_cvt_pk_bf16_f32 v71, 0, v71
    v_mfma_f32_16x16x32_bf16 v[48:51], v[24:27], a[56:59], v[48:51]
    ds_read_b64_tr_b16 v[8:9], v230 offset:13312
    buffer_load_dwordx4 v[160:163], v250, s[36:39], s5 offen offset:0 sc1
    v_mfma_f32_16x16x32_bf16 v[52:55], v[24:27], a[60:63], v[52:55]
    ds_read_b64_tr_b16 v[10:11], v230 offset:13824
    v_lshlrev_b32 v72, 16, v80
    v_mfma_f32_16x16x32_bf16 v[56:59], v[28:31], a[56:59], v[56:59]
    ds_read_b64_tr_b16 v[12:13], v231 offset:13312
    v_and_b32 v73, s31, v80
    v_mfma_f32_16x16x32_bf16 v[60:63], v[28:31], a[60:63], v[60:63]
    ds_read_b64_tr_b16 v[14:15], v231 offset:13824
    buffer_load_dwordx4 v[164:167], v250, s[36:39], s5 offen offset:1024 sc1
    s_waitcnt lgkmcnt(7)
    v_mfma_f32_16x16x32_bf16 v[48:51], v[32:35], a[72:75], v[48:51]
    ds_read_b64_tr_b16 v[16:17], v226 offset:0
    v_mfma_f32_16x16x32_bf16 v[52:55], v[32:35], a[76:79], v[52:55]
    ds_read_b64_tr_b16 v[18:19], v226 offset:512
    v_lshlrev_b32 v74, 16, v81
    v_mfma_f32_16x16x32_bf16 v[56:59], v[36:39], a[72:75], v[56:59]
    ds_read_b64_tr_b16 v[20:21], v227 offset:0
    v_and_b32 v75, s31, v81
    v_mfma_f32_16x16x32_bf16 v[60:63], v[36:39], a[76:79], v[60:63]
    ds_read_b64_tr_b16 v[22:23], v227 offset:512
    buffer_load_dwordx4 v[168:171], v250, s[36:39], s70 offen offset:0 sc1
    v_mfma_f32_16x16x32_bf16 v[48:51], v[40:43], a[88:91], v[48:51]
    ds_read_b64_tr_b16 v[24:25], v226 offset:1024
    v_lshlrev_b32 v76, 16, v82
    v_mfma_f32_16x16x32_bf16 v[52:55], v[40:43], a[92:95], v[52:55]
    ds_read_b64_tr_b16 v[26:27], v226 offset:1536
    v_and_b32 v77, s31, v82
    v_mfma_f32_16x16x32_bf16 v[56:59], v[44:47], a[88:91], v[56:59]
    ds_read_b64_tr_b16 v[28:29], v227 offset:1024
    v_lshlrev_b32 v78, 16, v83
    v_mfma_f32_16x16x32_bf16 v[60:63], v[44:47], a[92:95], v[60:63]
    ds_read_b64_tr_b16 v[30:31], v227 offset:1536
    buffer_load_dwordx4 v[172:175], v250, s[36:39], s70 offen offset:1024 sc1
    s_waitcnt lgkmcnt(7)
    v_mfma_f32_16x16x32_bf16 v[48:51], v[0:3], a[104:107], v[48:51]
    ds_read_b64_tr_b16 v[32:33], v226 offset:8192
    v_mfma_f32_16x16x32_bf16 v[52:55], v[0:3], a[108:111], v[52:55]
    ds_read_b64_tr_b16 v[34:35], v226 offset:8704
    v_and_b32 v79, s31, v83
    v_mfma_f32_16x16x32_bf16 v[56:59], v[4:7], a[104:107], v[56:59]
    ds_read_b64_tr_b16 v[36:37], v227 offset:8192
    v_pk_mul_f32 v[72:73], v[72:73], v[90:91] op_sel_hi:[1,0]
    v_mfma_f32_16x16x32_bf16 v[60:63], v[4:7], a[108:111], v[60:63]
    ds_read_b64_tr_b16 v[38:39], v227 offset:8704
    buffer_load_dwordx4 v[184:187], v250, s[36:39], s6 offen offset:0 sc1
    v_mfma_f32_16x16x32_bf16 v[48:51], v[8:11], a[120:123], v[48:51]
    ds_read_b64_tr_b16 v[40:41], v226 offset:9216
    v_pk_mul_f32 v[74:75], v[74:75], v[90:91] op_sel_hi:[1,0]
    v_mfma_f32_16x16x32_bf16 v[52:55], v[8:11], a[124:127], v[52:55]
    ds_read_b64_tr_b16 v[42:43], v226 offset:9728
    v_pk_mul_f32 v[76:77], v[76:77], v[90:91] op_sel_hi:[1,0]
    v_mfma_f32_16x16x32_bf16 v[56:59], v[12:15], a[120:123], v[56:59]
    ds_read_b64_tr_b16 v[44:45], v227 offset:9216
    v_pk_mul_f32 v[78:79], v[78:79], v[90:91] op_sel_hi:[1,0]
    v_mfma_f32_16x16x32_bf16 v[60:63], v[12:15], a[124:127], v[60:63]
    ds_read_b64_tr_b16 v[46:47], v227 offset:9728
    buffer_load_dwordx4 v[188:191], v250, s[36:39], s6 offen offset:1024 sc1
    s_waitcnt lgkmcnt(7)
    v_mfma_f32_16x16x32_bf16 v[48:51], v[16:19], a[136:139], v[48:51]
    ds_read_b64_tr_b16 v[0:1], v226 offset:16384
    v_mfma_f32_16x16x32_bf16 v[52:55], v[16:19], a[140:143], v[52:55]
    ds_read_b64_tr_b16 v[2:3], v226 offset:16896
    v_cvt_pk_bf16_f32 v72, 0, v72
    v_mfma_f32_16x16x32_bf16 v[56:59], v[20:23], a[136:139], v[56:59]
    ds_read_b64_tr_b16 v[4:5], v227 offset:16384
    v_cvt_pk_bf16_f32 v73, 0, v73
    v_mfma_f32_16x16x32_bf16 v[60:63], v[20:23], a[140:143], v[60:63]
    ds_read_b64_tr_b16 v[6:7], v227 offset:16896
    buffer_load_dwordx4 v[192:195], v250, s[36:39], s6 offen offset:2048 sc1
    v_mfma_f32_16x16x32_bf16 v[48:51], v[24:27], a[152:155], v[48:51]
    ds_read_b64_tr_b16 v[8:9], v226 offset:17408
    v_cvt_pk_bf16_f32 v74, 0, v74
    v_mfma_f32_16x16x32_bf16 v[52:55], v[24:27], a[156:159], v[52:55]
    ds_read_b64_tr_b16 v[10:11], v226 offset:17920
    v_cvt_pk_bf16_f32 v75, 0, v75
    v_mfma_f32_16x16x32_bf16 v[56:59], v[28:31], a[152:155], v[56:59]
    ds_read_b64_tr_b16 v[12:13], v227 offset:17408
    v_cvt_pk_bf16_f32 v76, 0, v76
    v_mfma_f32_16x16x32_bf16 v[60:63], v[28:31], a[156:159], v[60:63]
    ds_read_b64_tr_b16 v[14:15], v227 offset:17920
    buffer_load_dwordx4 v[196:199], v250, s[36:39], s6 offen offset:3072 sc1
    s_waitcnt lgkmcnt(7)
    v_mfma_f32_16x16x32_bf16 v[48:51], v[32:35], a[168:171], v[48:51]
    ds_read_b64_tr_b16 v[16:17], v226 offset:24576
    v_mfma_f32_16x16x32_bf16 v[52:55], v[32:35], a[172:175], v[52:55]
    ds_read_b64_tr_b16 v[18:19], v226 offset:25088
    v_cvt_pk_bf16_f32 v77, 0, v77
    v_mfma_f32_16x16x32_bf16 v[56:59], v[36:39], a[168:171], v[56:59]
    ds_read_b64_tr_b16 v[20:21], v227 offset:24576
    v_cvt_pk_bf16_f32 v78, 0, v78
    v_mfma_f32_16x16x32_bf16 v[60:63], v[36:39], a[172:175], v[60:63]
    ds_read_b64_tr_b16 v[22:23], v227 offset:25088
    v_cvt_pk_bf16_f32 v79, 0, v79
    v_mfma_f32_16x16x32_bf16 v[48:51], v[40:43], a[184:187], v[48:51]
    ds_read_b64_tr_b16 v[24:25], v226 offset:25600
    v_mfma_f32_16x16x32_bf16 v[52:55], v[40:43], a[188:191], v[52:55]
    ds_read_b64_tr_b16 v[26:27], v226 offset:26112
    v_mfma_f32_16x16x32_bf16 v[56:59], v[44:47], a[184:187], v[56:59]
    ds_read_b64_tr_b16 v[28:29], v227 offset:25600
    v_mfma_f32_16x16x32_bf16 v[60:63], v[44:47], a[188:191], v[60:63]
    ds_read_b64_tr_b16 v[30:31], v227 offset:26112
    v_cvt_pk_bf16_f32 v208, v208, v209
    s_waitcnt lgkmcnt(7)
    v_mfma_f32_16x16x32_bf16 v[48:51], v[0:3], a[200:203], v[48:51]
    ds_read_b64_tr_b16 v[32:33], v226 offset:32768
    v_mfma_f32_16x16x32_bf16 v[52:55], v[0:3], a[204:207], v[52:55]
    ds_read_b64_tr_b16 v[34:35], v226 offset:33280
    v_cvt_pk_bf16_f32 v209, v210, v211
    v_mfma_f32_16x16x32_bf16 v[56:59], v[4:7], a[200:203], v[56:59]
    ds_read_b64_tr_b16 v[36:37], v227 offset:32768
    v_cvt_pk_bf16_f32 v210, v216, v217
    v_mfma_f32_16x16x32_bf16 v[60:63], v[4:7], a[204:207], v[60:63]
    ds_read_b64_tr_b16 v[38:39], v227 offset:33280
    v_cvt_pk_bf16_f32 v211, v218, v219
    v_mfma_f32_16x16x32_bf16 v[48:51], v[8:11], a[216:219], v[48:51]
    ds_read_b64_tr_b16 v[40:41], v226 offset:33792
    buffer_store_dwordx4 v[208:211], v250, s[36:39], s46 offen offset:0 sc1
    v_mfma_f32_16x16x32_bf16 v[52:55], v[8:11], a[220:223], v[52:55]
    ds_read_b64_tr_b16 v[42:43], v226 offset:34304
    v_cvt_pk_bf16_f32 v212, v212, v213
    v_mfma_f32_16x16x32_bf16 v[56:59], v[12:15], a[216:219], v[56:59]
    ds_read_b64_tr_b16 v[44:45], v227 offset:33792
    v_cvt_pk_bf16_f32 v213, v214, v215
    v_mfma_f32_16x16x32_bf16 v[60:63], v[12:15], a[220:223], v[60:63]
    ds_read_b64_tr_b16 v[46:47], v227 offset:34304
    v_cvt_pk_bf16_f32 v214, v220, v221
    s_waitcnt lgkmcnt(7)
    v_mfma_f32_16x16x32_bf16 v[48:51], v[16:19], a[232:235], v[48:51]
    ds_read_b64_tr_b16 v[0:1], v226 offset:40960
    v_mfma_f32_16x16x32_bf16 v[52:55], v[16:19], a[236:239], v[52:55]
    ds_read_b64_tr_b16 v[2:3], v226 offset:41472
    v_cvt_pk_bf16_f32 v215, v222, v223
    v_mfma_f32_16x16x32_bf16 v[56:59], v[20:23], a[232:235], v[56:59]
    ds_read_b64_tr_b16 v[4:5], v227 offset:40960
    buffer_store_dwordx4 v[212:215], v250, s[36:39], s46 offen offset:1024 sc1
    v_mfma_f32_16x16x32_bf16 v[60:63], v[20:23], a[236:239], v[60:63]
    ds_read_b64_tr_b16 v[6:7], v227 offset:41472
    v_mfma_f32_16x16x32_bf16 v[48:51], v[24:27], a[248:251], v[48:51]
    ds_read_b64_tr_b16 v[8:9], v226 offset:41984
    v_mfma_f32_16x16x32_bf16 v[52:55], v[24:27], a[252:255], v[52:55]
    ds_read_b64_tr_b16 v[10:11], v226 offset:42496
    v_mfma_f32_16x16x32_bf16 v[56:59], v[28:31], a[248:251], v[56:59]
    ds_read_b64_tr_b16 v[12:13], v227 offset:41984
    v_mfma_f32_16x16x32_bf16 v[60:63], v[28:31], a[252:255], v[60:63]
    ds_read_b64_tr_b16 v[14:15], v227 offset:42496
    s_waitcnt lgkmcnt(7)
    v_mfma_f32_16x16x32_bf16 v[48:51], v[32:35], a[0:3], v[48:51]
    ds_read_b64_tr_b16 v[16:17], v226 offset:49152
    v_mfma_f32_16x16x32_bf16 v[52:55], v[32:35], a[4:7], v[52:55]
    ds_read_b64_tr_b16 v[18:19], v226 offset:49664
    v_mfma_f32_16x16x32_bf16 v[56:59], v[36:39], a[0:3], v[56:59]
    ds_read_b64_tr_b16 v[20:21], v227 offset:49152
    v_mfma_f32_16x16x32_bf16 v[60:63], v[36:39], a[4:7], v[60:63]
    ds_read_b64_tr_b16 v[22:23], v227 offset:49664
    v_mfma_f32_16x16x32_bf16 v[48:51], v[40:43], a[16:19], v[48:51]
    ds_read_b64_tr_b16 v[24:25], v226 offset:50176
    v_mfma_f32_16x16x32_bf16 v[52:55], v[40:43], a[20:23], v[52:55]
    ds_read_b64_tr_b16 v[26:27], v226 offset:50688
    v_mfma_f32_16x16x32_bf16 v[56:59], v[44:47], a[16:19], v[56:59]
    ds_read_b64_tr_b16 v[28:29], v227 offset:50176
    v_mfma_f32_16x16x32_bf16 v[60:63], v[44:47], a[20:23], v[60:63]
    ds_read_b64_tr_b16 v[30:31], v227 offset:50688
    s_waitcnt lgkmcnt(7)
    v_mfma_f32_16x16x32_bf16 v[48:51], v[0:3], a[32:35], v[48:51]
    ds_read_b64_tr_b16 v[32:33], v226 offset:57344
    v_mfma_f32_16x16x32_bf16 v[52:55], v[0:3], a[36:39], v[52:55]
    ds_read_b64_tr_b16 v[34:35], v226 offset:57856
    s_waitcnt vmcnt(2)
    v_mfma_f32_16x16x32_bf16 v[56:59], v[4:7], a[32:35], v[56:59]
    ds_read_b64_tr_b16 v[36:37], v227 offset:57344
    v_lshlrev_b32 v96, 16, v160
    v_mfma_f32_16x16x32_bf16 v[60:63], v[4:7], a[36:39], v[60:63]
    ds_read_b64_tr_b16 v[38:39], v227 offset:57856
    v_and_b32 v97, s31, v160
    v_mfma_f32_16x16x32_bf16 v[48:51], v[8:11], a[48:51], v[48:51]
    ds_read_b64_tr_b16 v[40:41], v226 offset:58368
    v_lshlrev_b32 v98, 16, v161
    v_mfma_f32_16x16x32_bf16 v[52:55], v[8:11], a[52:55], v[52:55]
    ds_read_b64_tr_b16 v[42:43], v226 offset:58880
    v_and_b32 v99, s31, v161
    v_mfma_f32_16x16x32_bf16 v[56:59], v[12:15], a[48:51], v[56:59]
    ds_read_b64_tr_b16 v[44:45], v227 offset:58368
    v_lshlrev_b32 v100, 16, v162
    v_mfma_f32_16x16x32_bf16 v[60:63], v[12:15], a[52:55], v[60:63]
    ds_read_b64_tr_b16 v[46:47], v227 offset:58880
    v_and_b32 v101, s31, v162
    s_waitcnt lgkmcnt(7)
    v_mfma_f32_16x16x32_bf16 v[48:51], v[16:19], a[64:67], v[48:51]
    ds_read_b64_tr_b16 v[0:1], v230 offset:20480
    v_mfma_f32_16x16x32_bf16 v[52:55], v[16:19], a[68:71], v[52:55]
    ds_read_b64_tr_b16 v[2:3], v230 offset:20992
    v_lshlrev_b32 v102, 16, v163
    v_mfma_f32_16x16x32_bf16 v[56:59], v[20:23], a[64:67], v[56:59]
    ds_read_b64_tr_b16 v[4:5], v231 offset:20480
    v_and_b32 v103, s31, v163
    v_mfma_f32_16x16x32_bf16 v[60:63], v[20:23], a[68:71], v[60:63]
    ds_read_b64_tr_b16 v[6:7], v231 offset:20992
    v_lshlrev_b32 v104, 16, v164
    v_mfma_f32_16x16x32_bf16 v[48:51], v[24:27], a[80:83], v[48:51]
    ds_read_b64_tr_b16 v[8:9], v230 offset:21504
    v_and_b32 v105, s31, v164
    v_mfma_f32_16x16x32_bf16 v[52:55], v[24:27], a[84:87], v[52:55]
    ds_read_b64_tr_b16 v[10:11], v230 offset:22016
    v_lshlrev_b32 v106, 16, v165
    v_mfma_f32_16x16x32_bf16 v[56:59], v[28:31], a[80:83], v[56:59]
    ds_read_b64_tr_b16 v[12:13], v231 offset:21504
    v_and_b32 v107, s31, v165
    v_mfma_f32_16x16x32_bf16 v[60:63], v[28:31], a[84:87], v[60:63]
    ds_read_b64_tr_b16 v[14:15], v231 offset:22016
    v_lshlrev_b32 v108, 16, v166
    s_waitcnt lgkmcnt(7)
    v_mfma_f32_16x16x32_bf16 v[48:51], v[32:35], a[96:99], v[48:51]
    ds_read_b64_tr_b16 v[16:17], v230 offset:28672
    v_mfma_f32_16x16x32_bf16 v[52:55], v[32:35], a[100:103], v[52:55]
    ds_read_b64_tr_b16 v[18:19], v230 offset:29184
    v_and_b32 v109, s31, v166
    v_mfma_f32_16x16x32_bf16 v[56:59], v[36:39], a[96:99], v[56:59]
    ds_read_b64_tr_b16 v[20:21], v231 offset:28672
    v_lshlrev_b32 v110, 16, v167
    v_mfma_f32_16x16x32_bf16 v[60:63], v[36:39], a[100:103], v[60:63]
    ds_read_b64_tr_b16 v[22:23], v231 offset:29184
    v_and_b32 v111, s31, v167
    v_mfma_f32_16x16x32_bf16 v[48:51], v[40:43], a[112:115], v[48:51]
    ds_read_b64_tr_b16 v[24:25], v230 offset:29696
    v_lshlrev_b32 v80, 16, v184
    v_mfma_f32_16x16x32_bf16 v[52:55], v[40:43], a[116:119], v[52:55]
    ds_read_b64_tr_b16 v[26:27], v230 offset:30208
    v_and_b32 v81, s31, v184
    v_mfma_f32_16x16x32_bf16 v[56:59], v[44:47], a[112:115], v[56:59]
    ds_read_b64_tr_b16 v[28:29], v231 offset:29696
    v_lshlrev_b32 v82, 16, v185
    v_mfma_f32_16x16x32_bf16 v[60:63], v[44:47], a[116:119], v[60:63]
    ds_read_b64_tr_b16 v[30:31], v231 offset:30208
    v_and_b32 v83, s31, v185
    s_waitcnt lgkmcnt(7)
    v_mfma_f32_16x16x32_bf16 v[48:51], v[0:3], a[128:131], v[48:51]
    ds_read_b64_tr_b16 v[32:33], v230 offset:36864
    v_mfma_f32_16x16x32_bf16 v[52:55], v[0:3], a[132:135], v[52:55]
    ds_read_b64_tr_b16 v[34:35], v230 offset:37376
    buffer_load_dwordx4 v[176:179], v250, s[36:39], s11 offen offset:0 sc1
    v_mfma_f32_16x16x32_bf16 v[56:59], v[4:7], a[128:131], v[56:59]
    ds_read_b64_tr_b16 v[36:37], v231 offset:36864
    v_lshlrev_b32 v84, 16, v186
    v_mfma_f32_16x16x32_bf16 v[60:63], v[4:7], a[132:135], v[60:63]
    ds_read_b64_tr_b16 v[38:39], v231 offset:37376
    buffer_load_dwordx4 v[180:183], v250, s[36:39], s11 offen offset:1024 sc1
    v_mfma_f32_16x16x32_bf16 v[48:51], v[8:11], a[144:147], v[48:51]
    ds_read_b64_tr_b16 v[40:41], v230 offset:37888
    v_and_b32 v85, s31, v186
    v_mfma_f32_16x16x32_bf16 v[52:55], v[8:11], a[148:151], v[52:55]
    ds_read_b64_tr_b16 v[42:43], v230 offset:38400
    v_lshlrev_b32 v86, 16, v187
    v_mfma_f32_16x16x32_bf16 v[56:59], v[12:15], a[144:147], v[56:59]
    ds_read_b64_tr_b16 v[44:45], v231 offset:37888
    v_and_b32 v87, s31, v187
    v_mfma_f32_16x16x32_bf16 v[60:63], v[12:15], a[148:151], v[60:63]
    ds_read_b64_tr_b16 v[46:47], v231 offset:38400
    v_dot2_f32_bf16 v96, v168, s96, v96
    s_waitcnt lgkmcnt(7)
    v_mfma_f32_16x16x32_bf16 v[48:51], v[16:19], a[160:163], v[48:51]
    ds_read_b64_tr_b16 v[0:1], v230 offset:45056
    v_mfma_f32_16x16x32_bf16 v[52:55], v[16:19], a[164:167], v[52:55]
    ds_read_b64_tr_b16 v[2:3], v230 offset:45568
    v_dot2_f32_bf16 v97, v168, s19, v97
    v_mfma_f32_16x16x32_bf16 v[56:59], v[20:23], a[160:163], v[56:59]
    ds_read_b64_tr_b16 v[4:5], v231 offset:45056
    v_dot2_f32_bf16 v98, v169, s96, v98
    v_mfma_f32_16x16x32_bf16 v[60:63], v[20:23], a[164:167], v[60:63]
    ds_read_b64_tr_b16 v[6:7], v231 offset:45568
    v_dot2_f32_bf16 v99, v169, s19, v99
    v_mfma_f32_16x16x32_bf16 v[48:51], v[24:27], a[176:179], v[48:51]
    ds_read_b64_tr_b16 v[8:9], v230 offset:46080
    v_dot2_f32_bf16 v100, v170, s96, v100
    v_mfma_f32_16x16x32_bf16 v[52:55], v[24:27], a[180:183], v[52:55]
    ds_read_b64_tr_b16 v[10:11], v230 offset:46592
    v_dot2_f32_bf16 v101, v170, s19, v101
    v_mfma_f32_16x16x32_bf16 v[56:59], v[28:31], a[176:179], v[56:59]
    ds_read_b64_tr_b16 v[12:13], v231 offset:46080
    v_dot2_f32_bf16 v102, v171, s96, v102
    v_mfma_f32_16x16x32_bf16 v[60:63], v[28:31], a[180:183], v[60:63]
    ds_read_b64_tr_b16 v[14:15], v231 offset:46592
    v_dot2_f32_bf16 v103, v171, s19, v103
    s_waitcnt lgkmcnt(7)
    v_mfma_f32_16x16x32_bf16 v[48:51], v[32:35], a[192:195], v[48:51]
    ds_read_b64_tr_b16 v[16:17], v230 offset:53248
    v_mfma_f32_16x16x32_bf16 v[52:55], v[32:35], a[196:199], v[52:55]
    ds_read_b64_tr_b16 v[18:19], v230 offset:53760
    v_dot2_f32_bf16 v104, v172, s96, v104
    v_mfma_f32_16x16x32_bf16 v[56:59], v[36:39], a[192:195], v[56:59]
    ds_read_b64_tr_b16 v[20:21], v231 offset:53248
    v_dot2_f32_bf16 v105, v172, s19, v105
    v_mfma_f32_16x16x32_bf16 v[60:63], v[36:39], a[196:199], v[60:63]
    ds_read_b64_tr_b16 v[22:23], v231 offset:53760
    v_dot2_f32_bf16 v106, v173, s96, v106
    v_mfma_f32_16x16x32_bf16 v[48:51], v[40:43], a[208:211], v[48:51]
    ds_read_b64_tr_b16 v[24:25], v230 offset:54272
    v_dot2_f32_bf16 v107, v173, s19, v107
    v_mfma_f32_16x16x32_bf16 v[52:55], v[40:43], a[212:215], v[52:55]
    ds_read_b64_tr_b16 v[26:27], v230 offset:54784
    v_dot2_f32_bf16 v108, v174, s96, v108
    v_mfma_f32_16x16x32_bf16 v[56:59], v[44:47], a[208:211], v[56:59]
    ds_read_b64_tr_b16 v[28:29], v231 offset:54272
    v_dot2_f32_bf16 v109, v174, s19, v109
    v_mfma_f32_16x16x32_bf16 v[60:63], v[44:47], a[212:215], v[60:63]
    ds_read_b64_tr_b16 v[30:31], v231 offset:54784
    v_dot2_f32_bf16 v110, v175, s96, v110
    s_waitcnt lgkmcnt(7)
    v_mfma_f32_16x16x32_bf16 v[48:51], v[0:3], a[224:227], v[48:51]
    ds_read_b64_tr_b16 v[32:33], v234 offset:0
    v_mfma_f32_16x16x32_bf16 v[52:55], v[0:3], a[228:231], v[52:55]
    ds_read_b64_tr_b16 v[34:35], v234 offset:512
    v_dot2_f32_bf16 v111, v175, s19, v111
    v_mfma_f32_16x16x32_bf16 v[56:59], v[4:7], a[224:227], v[56:59]
    ds_read_b64_tr_b16 v[36:37], v235 offset:0
    v_dot2_f32_bf16 v80, v188, s96, v80
    v_mfma_f32_16x16x32_bf16 v[60:63], v[4:7], a[228:231], v[60:63]
    ds_read_b64_tr_b16 v[38:39], v235 offset:512
    v_dot2_f32_bf16 v81, v188, s19, v81
    v_mfma_f32_16x16x32_bf16 v[48:51], v[8:11], a[240:243], v[48:51]
    ds_read_b64_tr_b16 v[40:41], v234 offset:1024
    v_dot2_f32_bf16 v82, v189, s96, v82
    v_mfma_f32_16x16x32_bf16 v[52:55], v[8:11], a[244:247], v[52:55]
    ds_read_b64_tr_b16 v[42:43], v234 offset:1536
    v_dot2_f32_bf16 v83, v189, s19, v83
    v_mfma_f32_16x16x32_bf16 v[56:59], v[12:15], a[240:243], v[56:59]
    ds_read_b64_tr_b16 v[44:45], v235 offset:1024
    v_dot2_f32_bf16 v84, v190, s96, v84
    v_mfma_f32_16x16x32_bf16 v[60:63], v[12:15], a[244:247], v[60:63]
    ds_read_b64_tr_b16 v[46:47], v235 offset:1536
    v_dot2_f32_bf16 v85, v190, s19, v85
    s_waitcnt lgkmcnt(7)
    v_mfma_f32_16x16x32_bf16 v[48:51], v[16:19], v[128:131], v[48:51]
    v_dot2_f32_bf16 v86, v191, s96, v86
    v_mfma_f32_16x16x32_bf16 v[52:55], v[16:19], v[132:135], v[52:55]
    v_dot2_f32_bf16 v87, v191, s19, v87
    v_dot2_f32_bf16 v80, v192, s96, v80
    v_mfma_f32_16x16x32_bf16 v[56:59], v[20:23], v[128:131], v[56:59]
    v_dot2_f32_bf16 v81, v192, s19, v81
    v_dot2_f32_bf16 v82, v193, s96, v82
    v_mfma_f32_16x16x32_bf16 v[60:63], v[20:23], v[132:135], v[60:63]
    v_dot2_f32_bf16 v83, v193, s19, v83
    v_dot2_f32_bf16 v84, v194, s96, v84
    v_mfma_f32_16x16x32_bf16 v[48:51], v[24:27], v[136:139], v[48:51]
    v_dot2_f32_bf16 v85, v194, s19, v85
    v_dot2_f32_bf16 v86, v195, s96, v86
    v_mfma_f32_16x16x32_bf16 v[52:55], v[24:27], v[140:143], v[52:55]
    v_dot2_f32_bf16 v87, v195, s19, v87
    v_dot2_f32_bf16 v80, v196, s96, v80
    v_mfma_f32_16x16x32_bf16 v[56:59], v[28:31], v[136:139], v[56:59]
    v_dot2_f32_bf16 v81, v196, s19, v81
    v_dot2_f32_bf16 v82, v197, s96, v82
    v_mfma_f32_16x16x32_bf16 v[60:63], v[28:31], v[140:143], v[60:63]
    v_dot2_f32_bf16 v83, v197, s19, v83
    v_dot2_f32_bf16 v84, v198, s96, v84
    s_waitcnt lgkmcnt(0)
    v_mfma_f32_16x16x32_bf16 v[48:51], v[32:35], v[144:147], v[48:51]
    v_dot2_f32_bf16 v85, v198, s19, v85
    v_mfma_f32_16x16x32_bf16 v[52:55], v[32:35], v[148:151], v[52:55]
    v_dot2_f32_bf16 v86, v199, s96, v86
    v_dot2_f32_bf16 v87, v199, s19, v87
    v_mfma_f32_16x16x32_bf16 v[56:59], v[36:39], v[144:147], v[56:59]
    v_mfma_f32_16x16x32_bf16 v[60:63], v[36:39], v[148:151], v[60:63]
    v_permlane32_swap_b32 v80, v84
    v_mfma_f32_16x16x32_bf16 v[48:51], v[40:43], v[152:155], v[48:51]
    v_permlane32_swap_b32 v81, v85
    v_mfma_f32_16x16x32_bf16 v[52:55], v[40:43], v[156:159], v[52:55]
    v_permlane32_swap_b32 v82, v86
    v_mfma_f32_16x16x32_bf16 v[56:59], v[44:47], v[152:155], v[56:59]
    v_permlane32_swap_b32 v83, v87
    v_mfma_f32_16x16x32_bf16 v[60:63], v[44:47], v[156:159], v[60:63]
    v_pk_add_f32 v[80:81], v[80:81], v[84:85]
    v_pk_add_f32 v[82:83], v[82:83], v[86:87]
    s_nop 1
    s_nop 1
    v_permlane16_swap_b32 v80, v82
    v_permlane16_swap_b32 v81, v83
    v_add_f32 v80, v80, v82
    v_add_f32 v81, v81, v83
    v_cvt_pk_bf16_f32 v80, 0, v80
    v_cvt_pk_bf16_f32 v81, 0, v81
    v_mul_f32 v80, v80, v93
    v_mul_f32 v81, v81, v93
    v_cvt_pk_bf16_f32 v80, 0, v80
    v_cvt_pk_bf16_f32 v81, 0, v81
    v_add_f32 v80, v80, v94
    v_add_f32 v81, v81, v95
    v_cvt_pk_bf16_f32 v82, v80, v81
    buffer_store_dword v82, v247, s[24:27], s47 offen
    s_waitcnt vmcnt(1)
    v_max3_u32 v80, v176, v177, v178
    v_max3_u32 v80, v80, v179, v180
    v_max3_u32 v80, v80, v181, v182
    v_max_u32 v80, v80, v183
    v_cmp_ne_u32 vcc, -1, v80
    s_cmp_eq_u64 vcc, exec
    s_cbranch_scc0 gated_mix__ssm_conv_s4__glu_gated_bilinear__prompt_kernel_slow8
gated_mix__ssm_conv_s4__glu_gated_bilinear__prompt_kernel_back8:
    v_dot2_f32_bf16 v96, v176, s96, v96
    v_dot2_f32_bf16 v97, v176, s19, v97
    v_dot2_f32_bf16 v98, v177, s96, v98
    v_dot2_f32_bf16 v99, v177, s19, v99
    v_dot2_f32_bf16 v100, v178, s96, v100
    v_dot2_f32_bf16 v101, v178, s19, v101
    v_dot2_f32_bf16 v102, v179, s96, v102
    v_dot2_f32_bf16 v103, v179, s19, v103
    v_dot2_f32_bf16 v104, v180, s96, v104
    v_dot2_f32_bf16 v105, v180, s19, v105
    v_dot2_f32_bf16 v106, v181, s96, v106
    v_dot2_f32_bf16 v107, v181, s19, v107
    v_dot2_f32_bf16 v108, v182, s96, v108
    v_dot2_f32_bf16 v109, v182, s19, v109
    v_dot2_f32_bf16 v110, v183, s96, v110
    v_dot2_f32_bf16 v111, v183, s19, v111
    v_pk_add_f32 v[96:97], v[96:97], v[48:49]
    v_pk_add_f32 v[98:99], v[98:99], v[50:51]
    v_pk_add_f32 v[100:101], v[100:101], v[56:57]
    v_pk_add_f32 v[102:103], v[102:103], v[58:59]
    v_cvt_pk_bf16_f32 v96, 0, v96
    v_cvt_pk_bf16_f32 v97, 0, v97
    v_cvt_pk_bf16_f32 v98, 0, v98
    v_cvt_pk_bf16_f32 v99, 0, v99
    v_cvt_pk_bf16_f32 v100, 0, v100
    v_cvt_pk_bf16_f32 v101, 0, v101
    v_cvt_pk_bf16_f32 v102, 0, v102
    v_cvt_pk_bf16_f32 v103, 0, v103
    v_pk_mul_f32 v[96:97], v[96:97], v[88:89] op_sel:[0,1] op_sel_hi:[1,1]
    v_pk_mul_f32 v[98:99], v[98:99], v[88:89] op_sel:[0,1] op_sel_hi:[1,1]
    v_pk_mul_f32 v[100:101], v[100:101], v[88:89] op_sel:[0,1] op_sel_hi:[1,1]
    v_pk_mul_f32 v[102:103], v[102:103], v[88:89] op_sel:[0,1] op_sel_hi:[1,1]
    v_cvt_pk_bf16_f32 v96, 0, v96
    v_cvt_pk_bf16_f32 v97, 0, v97
    v_cvt_pk_bf16_f32 v98, 0, v98
    v_cvt_pk_bf16_f32 v99, 0, v99
    v_cvt_pk_bf16_f32 v100, 0, v100
    v_cvt_pk_bf16_f32 v101, 0, v101
    v_cvt_pk_bf16_f32 v102, 0, v102
    v_cvt_pk_bf16_f32 v103, 0, v103
    v_pk_add_f32 v[96:97], v[96:97], v[64:65]
    v_pk_add_f32 v[98:99], v[98:99], v[66:67]
    v_pk_add_f32 v[100:101], v[100:101], v[68:69]
    v_pk_add_f32 v[102:103], v[102:103], v[70:71]
    v_cvt_pk_bf16_f32 v64, v96, v97
    v_cvt_pk_bf16_f32 v65, v98, v99
    v_cvt_pk_bf16_f32 v66, v100, v101
    v_cvt_pk_bf16_f32 v67, v102, v103
    s_nop 1
    v_permlane16_swap_b32 v64, v66
    v_permlane16_swap_b32 v65, v67
    buffer_store_dwordx4 v[64:67], v245, s[24:27], s65 offen
    v_pk_add_f32 v[104:105], v[104:105], v[52:53]
    v_pk_add_f32 v[106:107], v[106:107], v[54:55]
    v_pk_add_f32 v[108:109], v[108:109], v[60:61]
    v_pk_add_f32 v[110:111], v[110:111], v[62:63]
    v_cvt_pk_bf16_f32 v104, 0, v104
    v_cvt_pk_bf16_f32 v105, 0, v105
    v_cvt_pk_bf16_f32 v106, 0, v106
    v_cvt_pk_bf16_f32 v107, 0, v107
    v_cvt_pk_bf16_f32 v108, 0, v108
    v_cvt_pk_bf16_f32 v109, 0, v109
    v_cvt_pk_bf16_f32 v110, 0, v110
    v_cvt_pk_bf16_f32 v111, 0, v111
    v_pk_mul_f32 v[104:105], v[104:105], v[90:91] op_sel:[0,1] op_sel_hi:[1,1]
    v_pk_mul_f32 v[106:107], v[106:107], v[90:91] op_sel:[0,1] op_sel_hi:[1,1]
    v_pk_mul_f32 v[108:109], v[108:109], v[90:91] op_sel:[0,1] op_sel_hi:[1,1]
    v_pk_mul_f32 v[110:111], v[110:111], v[90:91] op_sel:[0,1] op_sel_hi:[1,1]
    v_cvt_pk_bf16_f32 v104, 0, v104
    v_cvt_pk_bf16_f32 v105, 0, v105
    v_cvt_pk_bf16_f32 v106, 0, v106
    v_cvt_pk_bf16_f32 v107, 0, v107
    v_cvt_pk_bf16_f32 v108, 0, v108
    v_cvt_pk_bf16_f32 v109, 0, v109
    v_cvt_pk_bf16_f32 v110, 0, v110
    v_cvt_pk_bf16_f32 v111, 0, v111
    v_pk_add_f32 v[104:105], v[104:105], v[72:73]
    v_pk_add_f32 v[106:107], v[106:107], v[74:75]
    v_pk_add_f32 v[108:109], v[108:109], v[76:77]
    v_pk_add_f32 v[110:111], v[110:111], v[78:79]
    v_cvt_pk_bf16_f32 v72, v104, v105
    v_cvt_pk_bf16_f32 v73, v106, v107
    v_cvt_pk_bf16_f32 v74, v108, v109
    v_cvt_pk_bf16_f32 v75, v110, v111
    s_nop 1
    v_permlane16_swap_b32 v72, v74
    v_permlane16_swap_b32 v73, v75
    buffer_store_dwordx4 v[72:75], v245, s[24:27], s68 offen
    s_endpgm
gated_mix__ssm_conv_s4__glu_gated_bilinear__prompt_kernel_slow1:
    s_mov_b32 s76, 20000
gated_mix__ssm_conv_s4__glu_gated_bilinear__prompt_kernel_slowl1:
    buffer_load_dwordx4 v[236:239], off, s[44:47], 0 sc1
    s_sub_u32 s76, s76, 1
    s_cmp_eq_u32 s76, 0
    s_waitcnt vmcnt(0)
    s_cbranch_scc1 gated_mix__ssm_conv_s4__glu_gated_bilinear__prompt_kernel_back1
    v_and_b32 v236, v236, v237
    v_and_b32 v238, v238, v239
    v_and_b32 v236, v236, v238
    v_cmp_eq_u32 vcc, 0x01010101, v236
    s_cmp_eq_u64 vcc, exec
    s_cbranch_scc0 gated_mix__ssm_conv_s4__glu_gated_bilinear__prompt_kernel_slowl1
    s_branch gated_mix__ssm_conv_s4__glu_gated_bilinear__prompt_kernel_back1
gated_mix__ssm_conv_s4__glu_gated_bilinear__prompt_kernel_slow2:
    s_mov_b32 s76, 20000
gated_mix__ssm_conv_s4__glu_gated_bilinear__prompt_kernel_slowl2:
    buffer_load_dwordx4 v[242:245], v250, s[36:39], s77 offen sc1
    s_sub_u32 s76, s76, 1
    s_cmp_eq_u32 s76, 0
    s_waitcnt vmcnt(0)
    s_cbranch_scc1 gated_mix__ssm_conv_s4__glu_gated_bilinear__prompt_kernel_back2
    v_and_b32 v242, v242, v243
    v_and_b32 v244, v244, v245
    v_and_b32 v242, v242, v244
    v_cmp_eq_u32 vcc, 1, v242
    s_cmp_eq_u64 vcc, exec
    s_cbranch_scc0 gated_mix__ssm_conv_s4__glu_gated_bilinear__prompt_kernel_slowl2
    s_branch gated_mix__ssm_conv_s4__glu_gated_bilinear__prompt_kernel_back2
gated_mix__ssm_conv_s4__glu_gated_bilinear__prompt_kernel_slow3:
    s_mov_b32 s76, 20000
gated_mix__ssm_conv_s4__glu_gated_bilinear__prompt_kernel_slowl3:
    buffer_load_dword v255, v253, s[36:39], s48 offen sc1
    s_sub_u32 s76, s76, 1
    s_cmp_eq_u32 s76, 0
    s_waitcnt vmcnt(0)
    s_cbranch_scc1 gated_mix__ssm_conv_s4__glu_gated_bilinear__prompt_kernel_back3
    v_cmp_le_u32 vcc, 2, v255
    s_cmp_eq_u64 vcc, exec
    s_cbranch_scc0 gated_mix__ssm_conv_s4__glu_gated_bilinear__prompt_kernel_slowl3
    s_branch gated_mix__ssm_conv_s4__glu_gated_bilinear__prompt_kernel_back3
gated_mix__ssm_conv_s4__glu_gated_bilinear__prompt_kernel_slow4:
    s_mov_b32 s76, 20000
gated_mix__ssm_conv_s4__glu_gated_bilinear__prompt_kernel_slowl4:
    buffer_load_dword v207, v253, s[36:39], s48 offen sc1
    s_sub_u32 s76, s76, 1
    s_cmp_eq_u32 s76, 0
    s_waitcnt vmcnt(0)
    s_cbranch_scc1 gated_mix__ssm_conv_s4__glu_gated_bilinear__prompt_kernel_back4
    v_cmp_le_u32 vcc, 3, v207
    s_cmp_eq_u64 vcc, exec
    s_cbranch_scc0 gated_mix__ssm_conv_s4__glu_gated_bilinear__prompt_kernel_slowl4
    s_branch gated_mix__ssm_conv_s4__glu_gated_bilinear__prompt_kernel_back4
gated_mix__ssm_conv_s4__glu_gated_bilinear__prompt_kernel_slow5:
    s_mov_b32 s76, 20000
gated_mix__ssm_conv_s4__glu_gated_bilinear__prompt_kernel_slowl5:
    buffer_load_dword v207, v253, s[36:39], s48 offen sc1
    s_sub_u32 s76, s76, 1
    s_cmp_eq_u32 s76, 0
    s_waitcnt vmcnt(0)
    s_cbranch_scc1 gated_mix__ssm_conv_s4__glu_gated_bilinear__prompt_kernel_back5
    v_cmp_le_u32 vcc, 4, v207
    s_cmp_eq_u64 vcc, exec
    s_cbranch_scc0 gated_mix__ssm_conv_s4__glu_gated_bilinear__prompt_kernel_slowl5
    s_branch gated_mix__ssm_conv_s4__glu_gated_bilinear__prompt_kernel_back5
gated_mix__ssm_conv_s4__glu_gated_bilinear__prompt_kernel_slow6:
    s_mov_b32 s76, 20000
gated_mix__ssm_conv_s4__glu_gated_bilinear__prompt_kernel_slowl6:
    buffer_load_dword v178, v176, s[36:39], s43 offen sc1
    s_sub_u32 s76, s76, 1
    s_cmp_eq_u32 s76, 0
    s_waitcnt vmcnt(0)
    s_cbranch_scc1 gated_mix__ssm_conv_s4__glu_gated_bilinear__prompt_kernel_back6
    v_cmp_eq_u32 vcc, 1, v178
    s_cmp_eq_u64 vcc, exec
    s_cbranch_scc0 gated_mix__ssm_conv_s4__glu_gated_bilinear__prompt_kernel_slowl6
    s_branch gated_mix__ssm_conv_s4__glu_gated_bilinear__prompt_kernel_back6
gated_mix__ssm_conv_s4__glu_gated_bilinear__prompt_kernel_slow7:
    s_mov_b32 s76, 20000
gated_mix__ssm_conv_s4__glu_gated_bilinear__prompt_kernel_slowl7:
    buffer_load_dword v207, v248, s[36:39], s69 offen offset:4 sc1
    s_sub_u32 s76, s76, 1
    s_cmp_eq_u32 s76, 0
    s_waitcnt vmcnt(0)
    s_cbranch_scc1 gated_mix__ssm_conv_s4__glu_gated_bilinear__prompt_kernel_back7
    v_cmp_le_u32 vcc, 1, v207
    s_cmp_eq_u64 vcc, exec
    s_cbranch_scc0 gated_mix__ssm_conv_s4__glu_gated_bilinear__prompt_kernel_slowl7
    s_branch gated_mix__ssm_conv_s4__glu_gated_bilinear__prompt_kernel_back7
gated_mix__ssm_conv_s4__glu_gated_bilinear__prompt_kernel_slow8:
    s_mov_b32 s76, 20000
gated_mix__ssm_conv_s4__glu_gated_bilinear__prompt_kernel_slowl8:
    buffer_load_dwordx4 v[176:179], v250, s[36:39], s11 offen offset:0 sc1
    buffer_load_dwordx4 v[180:183], v250, s[36:39], s11 offen offset:1024 sc1
    s_sub_u32 s76, s76, 1
    s_cmp_eq_u32 s76, 0
    s_waitcnt vmcnt(0)
    s_cbranch_scc1 gated_mix__ssm_conv_s4__glu_gated_bilinear__prompt_kernel_back8
    v_max3_u32 v80, v176, v177, v178
    v_max3_u32 v80, v80, v179, v180
    v_max3_u32 v80, v80, v181, v182
    v_max_u32 v80, v80, v183
    v_cmp_ne_u32 vcc, -1, v80
    s_cmp_eq_u64 vcc, exec
    s_cbranch_scc0 gated_mix__ssm_conv_s4__glu_gated_bilinear__prompt_kernel_slowl8
    s_branch gated_mix__ssm_conv_s4__glu_gated_bilinear__prompt_kernel_back8
gated_mix__ssm_conv_s4__glu_gated_bilinear__prompt_kernel_end:
    s_endpgm
.section .rodata,"a"
.p2align 6
.amdhsa_kernel gated_mix__ssm_conv_s4__glu_gated_bilinear__prompt_kernel
  .amdhsa_next_free_vgpr 512
  .amdhsa_next_free_sgpr 102
  .amdhsa_accum_offset 256
  .amdhsa_group_segment_fixed_size 0
  .amdhsa_kernarg_size 136
  .amdhsa_user_sgpr_count 2
  .amdhsa_user_sgpr_kernarg_segment_ptr 1
  .amdhsa_system_sgpr_workgroup_id_x 1
  .amdhsa_float_denorm_mode_32 3
  .amdhsa_float_denorm_mode_16_64 3
.end_amdhsa_kernel
```
